```python
import torch

def _softmax(x, axis=-1):
    return torch.softmax(x, dim=axis)

def _gelu(x):
    return torch.nn.functional.gelu(x, approximate='tanh')

def _silu(x):
    return torch.nn.functional.silu(x)

def _sigmoid(x):
    return torch.sigmoid(x)

def _layernorm(x, axis=-1, eps=1e-05):
    m = x.mean(dim=axis, keepdim=True)
    v = x.var(dim=axis, keepdim=True, unbiased=False)
    return (x - m) / torch.sqrt(v + eps)

def _scatter_add(tgt, idx, src, axis=0):
    return tgt.clone().index_add_(axis, idx, src)

def _segment_sum(src, seg, n):
    out = torch.zeros((n,) + src.shape[1:], dtype=src.dtype)
    return out.index_add_(0, seg, src)

def _pad(x, pw):
    flat = tuple((v for pair in reversed(pw) for v in pair))
    return torch.nn.functional.pad(x, flat)
kernel_name = 'gated_mix__grouped_kv_mqa__mixer_gmlp__prompt'

def setup_inputs():

    _w = lambda a: (lambda t: t.to(torch.bfloat16) if t.is_floating_point() else t)(torch.as_tensor(a))

    def _A_setup():
        B, S, D, H = (1, 2048, 640, 32)
        Dh = D // H
        return {'x': _w((lambda *s: torch.randn(*s, dtype=torch.bfloat16) * 0.05)(B, S, D)), 'wq': _w((lambda *s: torch.randn(*s, dtype=torch.bfloat16) * 1.6)(D, H * Dh)), 'wk': _w((lambda *s: torch.randn(*s, dtype=torch.bfloat16) * 1.6)(D, Dh)), 'wv': _w((lambda *s: torch.randn(*s, dtype=torch.bfloat16) * 0.2)(D, Dh)), 'wo': _w((lambda *s: torch.randn(*s, dtype=torch.bfloat16) * 0.2)(H * Dh, D))}
    _A_in = _A_setup()

    def _B_setup():
        B, S, D, F = (1, 2048, 640, 1728)
        Fh = F // 2
        return {'x': _w((lambda *s: torch.randn(*s, dtype=torch.bfloat16) * 0.05)(B, S, D)), 'w_in': _w((lambda *s: torch.randn(*s, dtype=torch.bfloat16) * 0.8)(D, 2 * Fh)), 'w_sp': _w(0.01 * (lambda *s: torch.randn(*s, dtype=torch.bfloat16) * 0.8)(S, S)), 'b_sp': _w(1.0 + 0.01 * (lambda *s: torch.randn(*s, dtype=torch.bfloat16) * 0.05)(S)), 'w_out': _w((lambda *s: torch.randn(*s, dtype=torch.bfloat16) * 0.05)(Fh, D))}
    _B_in = _B_setup()
    return {'A_x': _A_in['x'], 'A_wq': _A_in['wq'], 'A_wk': _A_in['wk'], 'A_wv': _A_in['wv'], 'A_wo': _A_in['wo'], 'B_x': _B_in['x'], 'B_w_in': _B_in['w_in'], 'B_w_sp': _B_in['w_sp'], 'B_b_sp': _B_in['b_sp'], 'B_w_out': _B_in['w_out'], 'gate_w': _w((lambda *s: torch.randn(*s, dtype=torch.bfloat16) * 0.05)(640) * 16.0)}

def reference(A_x, A_wq, A_wk, A_wv, A_wo, B_x, B_w_in, B_w_sp, B_b_sp, B_w_out, gate_w):

    def _A_ref(x, wq, wk, wv, wo):
        B, S, D = x.shape
        H = 32
        Dh = D // H
        q = (lambda x, *d: x.permute(*d))((x @ wq).reshape(B, S, H, Dh), 0, 2, 1, 3)
        k = x @ wk
        v = x @ wv
        scores = torch.einsum('bhqd,bkd->bhqk', q, k) * Dh ** (-0.5)
        p = _softmax(scores, axis=-1)
        o = torch.einsum('bhqk,bkd->bhqd', p, v)
        return (lambda x, *d: x.permute(*d))(o, 0, 2, 1, 3).reshape(B, S, H * Dh) @ wo

    def _B_ref(x, w_in, w_sp, b_sp, w_out):
        B, S, D = x.shape
        F = w_in.shape[-1]
        Fh = F // 2
        z = _gelu(torch.einsum('bsd,df->bsf', x, w_in))
        z1 = z[..., :Fh].clone()
        z2 = _layernorm(z[..., Fh:], axis=-1)
        g = torch.einsum('ts,bsf->btf', w_sp, z2) + b_sp[None, :, None]
        return torch.einsum('bsf,fd->bsd', z1 * g, w_out)
    x = A_x
    g = _sigmoid((x * gate_w).sum(-1, keepdims=True))
    a = _A_ref(x, A_wq, A_wk, A_wv, A_wo)
    b = _B_ref(x, B_w_in, B_w_sp, B_b_sp, B_w_out)
    return g * a + (1 - g) * b
```

```asm
; @launch grid=(256,1,1) block=(512,1,1) lds=163840
.amdgcn_target "amdgcn-amd-amdhsa--gfx950"
.text
.globl gated_mix__grouped_kv_mqa__mixer_gmlp__prompt_kernel
.p2align 8
.type gated_mix__grouped_kv_mqa__mixer_gmlp__prompt_kernel,@function
gated_mix__grouped_kv_mqa__mixer_gmlp__prompt_kernel:
    s_cmp_ge_u32 s2, 256
    s_cbranch_scc1 K1_EXIT
    s_load_dwordx8 s[8:15], s[0:1], 0
    s_load_dwordx4 s[16:19], s[0:1], 48
    s_load_dwordx4 s[20:23], s[0:1], 96
    s_load_dwordx2 s[50:51], s[0:1], 80
    s_getpc_b64 s[56:57]
K1_PC:
    s_mov_b32 s58, TEXT_END-K1_PC
    s_mov_b32 s59, 0x00020000
    s_lshr_b32 s5, s2, 3
    s_lshl_b32 s5, s5, 12
    v_lshrrev_b32 v4, 5, v0
    v_lshlrev_b32 v4, 24, v4
    v_lshl_add_u32 v4, v0, 7, v4
    v_add_u32 v4, s5, v4
    buffer_load_dword v15, v4, s[56:59], 0 offen
    s_and_b32 s3, s2, 7
    s_lshr_b32 s4, s2, 3
    s_and_b32 s24, s3, 1
    s_lshl_b32 s24, s24, 3
    s_and_b32 s5, s4, 7
    s_add_u32 s24, s24, s5
    s_lshr_b32 s25, s3, 1
    s_lshl_b32 s25, s25, 2
    s_lshr_b32 s6, s4, 3
    s_add_u32 s25, s25, s6
    s_mov_b32 s40, 0x7654dcba
    s_mov_b32 s41, 0x98fe3210
    s_lshl_b32 s25, s25, 2
    s_lshr_b64 s[40:41], s[40:41], s25
    s_and_b32 s25, s40, 15
    s_add_u32 s5, s5, s6
    s_and_b32 s5, s5, 3
    s_mul_i32 s5, s5, 10
    s_lshr_b32 s67, s5, 2
    v_lshrrev_b32 v5, 6, v0
    v_and_b32 v1, 63, v0
    v_readfirstlane_b32 s49, v5
    v_and_b32 v2, 31, v0
    v_bfe_u32 v3, v0, 5, 1
    v_lshlrev_b32 v173, 4, v1
    s_and_b32 s26, s49, 3
    s_lshl_b32 s27, s24, 2
    s_add_u32 s27, s27, s26
    s_mul_i32 s53, s26, 16384
    s_add_u32 s53, s53, 92160
    s_lshl_b32 s62, s67, 7
    s_mov_b32 s66, s62
    s_mul_i32 s5, s24, 6
    s_add_u32 s5, s5, s25
    s_lshl_b32 s5, s5, 2
    s_add_u32 s5, s5, s26
    s_lshl_b32 s5, s5, 8
    s_add_u32 s5, s5, 2938880
    v_lshl_add_u32 v7, v2, 3, s5
    s_lshl_b32 s5, s27, 4
    s_add_u32 s5, s5, s25
    s_lshl_b32 s5, s5, 2
    s_add_u32 s98, s5, 3096576
    s_mov_b32 s97, 0
    s_mov_b32 s96, 0x40000
    s_cmp_lt_u32 s49, 4
    s_cbranch_scc1 K1_COMPUTE
    s_lshl_b32 s5, s27, 5
    v_lshrrev_b32 v4, 3, v1
    v_add_u32 v4, s5, v4
    s_movk_i32 s5, 1280
    v_mul_lo_u32 v4, v4, s5
    v_lshrrev_b32 v6, 4, v1
    v_and_b32 v8, 7, v1
    v_xor_b32 v6, v6, v8
    v_lshl_add_u32 v168, v6, 4, v4
    v_xor_b32 v169, 64, v168
    s_mul_i32 s52, s26, 5120
    s_mul_i32 s54, s26, 640
    v_add_u32 v149, s54, v173
    s_add_u32 s54, s54, 20480
    s_cmp_lt_u32 s25, 4
    s_cselect_b32 s60, 19, 17
    s_movk_i32 s61, 3456
    s_cselect_b32 s61, 1280, s61
    s_movk_i32 s5, 288
    s_cselect_b32 s5, 320, s5
    s_cselect_b32 s6, 0, 4
    s_sub_u32 s6, s25, s6
    s_mul_i32 s5, s5, s6
    s_lshl_b32 s48, s61, 6
    s_lshl_b32 s6, s26, 4
    s_mul_i32 s6, s6, s61
    s_add_u32 s5, s5, s6
    s_mul_i32 s63, s67, s48
    s_mul_i32 s64, s67, 2560
    s_movk_i32 s6, 3277
    v_add_u32 v4, 0, v1
    v_mul_u32_u24 v13, s6, v4
    v_lshrrev_b32 v13, 16, v13
    v_mul_u32_u24 v14, 20, v13
    v_sub_u32 v4, v4, v14
    v_min_u32 v4, s60, v4
    v_mul_u32_u24 v13, s61, v13
    v_lshl_add_u32 v4, v4, 4, v13
    v_add_u32 v144, s5, v4
    v_add_u32 v4, 64, v1
    v_mul_u32_u24 v13, s6, v4
    v_lshrrev_b32 v13, 16, v13
    v_mul_u32_u24 v14, 20, v13
    v_sub_u32 v4, v4, v14
    v_min_u32 v4, s60, v4
    v_mul_u32_u24 v13, s61, v13
    v_lshl_add_u32 v4, v4, 4, v13
    v_add_u32 v145, s5, v4
    v_add_u32 v4, 128, v1
    v_mul_u32_u24 v13, s6, v4
    v_lshrrev_b32 v13, 16, v13
    v_mul_u32_u24 v14, 20, v13
    v_sub_u32 v4, v4, v14
    v_min_u32 v4, s60, v4
    v_mul_u32_u24 v13, s61, v13
    v_lshl_add_u32 v4, v4, 4, v13
    v_add_u32 v146, s5, v4
    v_add_u32 v4, 192, v1
    v_mul_u32_u24 v13, s6, v4
    v_lshrrev_b32 v13, 16, v13
    v_mul_u32_u24 v14, 20, v13
    v_sub_u32 v4, v4, v14
    v_min_u32 v4, s60, v4
    v_mul_u32_u24 v13, s61, v13
    v_lshl_add_u32 v4, v4, 4, v13
    v_add_u32 v147, s5, v4
    v_add_u32 v4, 256, v1
    v_mul_u32_u24 v13, s6, v4
    v_lshrrev_b32 v13, 16, v13
    v_mul_u32_u24 v14, 20, v13
    v_sub_u32 v4, v4, v14
    v_min_u32 v4, s60, v4
    v_mul_u32_u24 v13, s61, v13
    v_lshl_add_u32 v4, v4, 4, v13
    v_add_u32 v148, s5, v4
    s_waitcnt lgkmcnt(0)
    s_mov_b32 s28, s8
    s_mov_b32 s29, s9
    s_mov_b32 s30, 2621440
    s_mov_b32 s31, 0x00020000
    s_cmp_lt_u32 s25, 4
    s_cselect_b32 s40, s10, s16
    s_cselect_b32 s41, s11, s17
    s_mul_i32 s42, s61, 640
    s_mov_b32 s43, 0x00020000
    s_cmp_lt_u32 s25, 6
    s_cselect_b32 s44, s12, s14
    s_cselect_b32 s45, s13, s15
    s_sub_u32 s5, s25, 4
    s_cmp_lt_u32 s5, 4
    s_cselect_b32 s46, 25600, 0
    s_mov_b32 s47, 0x00020000
    s_mov_b32 s32, s22
    s_mov_b32 s33, s23
    s_mov_b32 s34, 23068672
    s_mov_b32 s35, 0x00020000
    s_mov_b32 s36, s50
    s_mov_b32 s37, s51
    s_mov_b32 s38, 1280
    s_mov_b32 s39, 0x00020000
    s_cmp_lg_u32 s25, 9
    s_cbranch_scc1 K1_NOGATE
    s_cmp_gt_u32 s26, 1
    s_cbranch_scc1 K1_NOGATE
    s_lshl_b32 s5, s26, 10
    s_add_u32 m0, s5, 157696
    v_add_u32 v4, s5, v173
    buffer_load_dwordx4 v4, s[36:39], 0 offen lds
K1_NOGATE:
    s_add_u32 m0, s53, 0
    s_add_u32 s65, s62, 0
    buffer_load_dwordx4 v168, s[28:31], s65 offen lds
    s_add_u32 m0, s53, 1024
    s_add_u32 s65, s62, 10240
    buffer_load_dwordx4 v169, s[28:31], s65 offen lds
    s_add_u32 m0, s53, 2048
    s_add_u32 s65, s62, 20480
    buffer_load_dwordx4 v168, s[28:31], s65 offen lds
    s_add_u32 m0, s53, 3072
    s_add_u32 s65, s62, 30720
    buffer_load_dwordx4 v169, s[28:31], s65 offen lds
    s_add_u32 m0, s52, 0
    s_nop 0
    buffer_load_dwordx4 v144, s[40:43], s63 offen lds
    s_add_u32 m0, s52, 1024
    s_nop 0
    buffer_load_dwordx4 v145, s[40:43], s63 offen lds
    s_add_u32 m0, s52, 2048
    s_nop 0
    buffer_load_dwordx4 v146, s[40:43], s63 offen lds
    s_add_u32 m0, s52, 3072
    s_nop 0
    buffer_load_dwordx4 v147, s[40:43], s63 offen lds
    s_add_u32 m0, s52, 4096
    s_nop 0
    buffer_load_dwordx4 v148, s[40:43], s63 offen lds
    s_add_u32 m0, s54, 0
    s_mov_b32 exec_hi, 0xff
    buffer_load_dwordx4 v149, s[44:47], s64 offen lds
    s_mov_b32 exec_hi, -1
    s_add_u32 s62, s62, 128
    s_add_u32 s63, s63, s48
    s_add_u32 s64, s64, 2560
    s_cmp_eq_u32 s62, 1280
    s_cselect_b32 s62, 0, s62
    s_cselect_b32 s63, 0, s63
    s_cselect_b32 s64, 0, s64
    s_add_u32 m0, s53, 4096
    s_add_u32 s65, s62, 0
    buffer_load_dwordx4 v168, s[28:31], s65 offen lds
    s_add_u32 m0, s53, 5120
    s_add_u32 s65, s62, 10240
    buffer_load_dwordx4 v169, s[28:31], s65 offen lds
    s_add_u32 m0, s53, 6144
    s_add_u32 s65, s62, 20480
    buffer_load_dwordx4 v168, s[28:31], s65 offen lds
    s_add_u32 m0, s53, 7168
    s_add_u32 s65, s62, 30720
    buffer_load_dwordx4 v169, s[28:31], s65 offen lds
    s_add_u32 m0, s52, 23040
    s_nop 0
    buffer_load_dwordx4 v144, s[40:43], s63 offen lds
    s_add_u32 m0, s52, 24064
    s_nop 0
    buffer_load_dwordx4 v145, s[40:43], s63 offen lds
    s_add_u32 m0, s52, 25088
    s_nop 0
    buffer_load_dwordx4 v146, s[40:43], s63 offen lds
    s_add_u32 m0, s52, 26112
    s_nop 0
    buffer_load_dwordx4 v147, s[40:43], s63 offen lds
    s_add_u32 m0, s52, 27136
    s_nop 0
    buffer_load_dwordx4 v148, s[40:43], s63 offen lds
    s_add_u32 m0, s54, 23040
    s_mov_b32 exec_hi, 0xff
    buffer_load_dwordx4 v149, s[44:47], s64 offen lds
    s_mov_b32 exec_hi, -1
    v_bfe_u32 v4, v2, 1, 3
    v_xor_b32 v4, v4, v3
    v_lshlrev_b32 v4, 4, v4
    v_lshl_add_u32 v4, v2, 7, v4
    v_xor_b32 v164, 0, v4
    v_add_u32 v164, s53, v164
    v_xor_b32 v165, 32, v4
    v_add_u32 v165, s53, v165
    v_xor_b32 v166, 64, v4
    v_add_u32 v166, s53, v166
    v_xor_b32 v167, 96, v4
    v_add_u32 v167, s53, v167
    v_lshlrev_b32 v172, 4, v3
    v_add_u32 v172, 157696, v172
    v_add_u32 v171, s66, v172
    v_mov_b32 v170, 0
    s_waitcnt vmcnt(10)
    s_barrier
    s_add_u32 s62, s62, 128
    s_add_u32 s63, s63, s48
    s_add_u32 s64, s64, 2560
    s_cmp_eq_u32 s62, 1280
    s_cselect_b32 s62, 0, s62
    s_cselect_b32 s63, 0, s63
    s_cselect_b32 s64, 0, s64
    s_add_u32 m0, s53, 8192
    s_add_u32 s65, s62, 0
    buffer_load_dwordx4 v168, s[28:31], s65 offen lds
    s_add_u32 m0, s53, 9216
    s_add_u32 s65, s62, 10240
    buffer_load_dwordx4 v169, s[28:31], s65 offen lds
    s_add_u32 m0, s53, 10240
    s_add_u32 s65, s62, 20480
    buffer_load_dwordx4 v168, s[28:31], s65 offen lds
    s_add_u32 m0, s53, 11264
    s_add_u32 s65, s62, 30720
    buffer_load_dwordx4 v169, s[28:31], s65 offen lds
    s_add_u32 m0, s52, 46080
    s_nop 0
    buffer_load_dwordx4 v144, s[40:43], s63 offen lds
    s_add_u32 m0, s52, 47104
    s_nop 0
    buffer_load_dwordx4 v145, s[40:43], s63 offen lds
    s_add_u32 m0, s52, 48128
    s_nop 0
    buffer_load_dwordx4 v146, s[40:43], s63 offen lds
    s_add_u32 m0, s52, 49152
    s_nop 0
    buffer_load_dwordx4 v147, s[40:43], s63 offen lds
    s_add_u32 m0, s52, 50176
    s_nop 0
    buffer_load_dwordx4 v148, s[40:43], s63 offen lds
    s_add_u32 m0, s54, 46080
    s_mov_b32 exec_hi, 0xff
    buffer_load_dwordx4 v149, s[44:47], s64 offen lds
    s_mov_b32 exec_hi, -1
    s_cmp_lg_u32 s25, 9
    s_cbranch_scc1 K1_NG0
    ds_read_b128 v[16:19], v164 offset:0
    ds_read_b128 v[32:35], v171 offset:0
    ds_read_b128 v[20:23], v165 offset:0
    ds_read_b128 v[36:39], v171 offset:32
    ds_read_b128 v[24:27], v166 offset:0
    ds_read_b128 v[40:43], v171 offset:64
    ds_read_b128 v[28:31], v167 offset:0
    ds_read_b128 v[44:47], v171 offset:96
    s_add_u32 s66, s66, 128
    s_cmp_eq_u32 s66, 1280
    s_cselect_b32 s66, 0, s66
    v_add_u32 v171, s66, v172
    s_waitcnt lgkmcnt(0)
    v_dot2c_f32_bf16 v170, v16, v32
    v_dot2c_f32_bf16 v170, v17, v33
    v_dot2c_f32_bf16 v170, v18, v34
    v_dot2c_f32_bf16 v170, v19, v35
    v_dot2c_f32_bf16 v170, v20, v36
    v_dot2c_f32_bf16 v170, v21, v37
    v_dot2c_f32_bf16 v170, v22, v38
    v_dot2c_f32_bf16 v170, v23, v39
    v_dot2c_f32_bf16 v170, v24, v40
    v_dot2c_f32_bf16 v170, v25, v41
    v_dot2c_f32_bf16 v170, v26, v42
    v_dot2c_f32_bf16 v170, v27, v43
    v_dot2c_f32_bf16 v170, v28, v44
    v_dot2c_f32_bf16 v170, v29, v45
    v_dot2c_f32_bf16 v170, v30, v46
    v_dot2c_f32_bf16 v170, v31, v47
K1_NG0:
    s_waitcnt vmcnt(10)
    s_barrier
    s_add_u32 s62, s62, 128
    s_add_u32 s63, s63, s48
    s_add_u32 s64, s64, 2560
    s_cmp_eq_u32 s62, 1280
    s_cselect_b32 s62, 0, s62
    s_cselect_b32 s63, 0, s63
    s_cselect_b32 s64, 0, s64
    s_add_u32 m0, s53, 12288
    s_add_u32 s65, s62, 0
    buffer_load_dwordx4 v168, s[28:31], s65 offen lds
    s_add_u32 m0, s53, 13312
    s_add_u32 s65, s62, 10240
    buffer_load_dwordx4 v169, s[28:31], s65 offen lds
    s_add_u32 m0, s53, 14336
    s_add_u32 s65, s62, 20480
    buffer_load_dwordx4 v168, s[28:31], s65 offen lds
    s_add_u32 m0, s53, 15360
    s_add_u32 s65, s62, 30720
    buffer_load_dwordx4 v169, s[28:31], s65 offen lds
    s_add_u32 m0, s52, 69120
    s_nop 0
    buffer_load_dwordx4 v144, s[40:43], s63 offen lds
    s_add_u32 m0, s52, 70144
    s_nop 0
    buffer_load_dwordx4 v145, s[40:43], s63 offen lds
    s_add_u32 m0, s52, 71168
    s_nop 0
    buffer_load_dwordx4 v146, s[40:43], s63 offen lds
    s_add_u32 m0, s52, 72192
    s_nop 0
    buffer_load_dwordx4 v147, s[40:43], s63 offen lds
    s_add_u32 m0, s52, 73216
    s_nop 0
    buffer_load_dwordx4 v148, s[40:43], s63 offen lds
    s_add_u32 m0, s54, 69120
    s_mov_b32 exec_hi, 0xff
    buffer_load_dwordx4 v149, s[44:47], s64 offen lds
    s_mov_b32 exec_hi, -1
    s_cmp_lg_u32 s25, 9
    s_cbranch_scc1 K1_NG1
    ds_read_b128 v[16:19], v164 offset:4096
    ds_read_b128 v[32:35], v171 offset:0
    ds_read_b128 v[20:23], v165 offset:4096
    ds_read_b128 v[36:39], v171 offset:32
    ds_read_b128 v[24:27], v166 offset:4096
    ds_read_b128 v[40:43], v171 offset:64
    ds_read_b128 v[28:31], v167 offset:4096
    ds_read_b128 v[44:47], v171 offset:96
    s_add_u32 s66, s66, 128
    s_cmp_eq_u32 s66, 1280
    s_cselect_b32 s66, 0, s66
    v_add_u32 v171, s66, v172
    s_waitcnt lgkmcnt(0)
    v_dot2c_f32_bf16 v170, v16, v32
    v_dot2c_f32_bf16 v170, v17, v33
    v_dot2c_f32_bf16 v170, v18, v34
    v_dot2c_f32_bf16 v170, v19, v35
    v_dot2c_f32_bf16 v170, v20, v36
    v_dot2c_f32_bf16 v170, v21, v37
    v_dot2c_f32_bf16 v170, v22, v38
    v_dot2c_f32_bf16 v170, v23, v39
    v_dot2c_f32_bf16 v170, v24, v40
    v_dot2c_f32_bf16 v170, v25, v41
    v_dot2c_f32_bf16 v170, v26, v42
    v_dot2c_f32_bf16 v170, v27, v43
    v_dot2c_f32_bf16 v170, v28, v44
    v_dot2c_f32_bf16 v170, v29, v45
    v_dot2c_f32_bf16 v170, v30, v46
    v_dot2c_f32_bf16 v170, v31, v47
K1_NG1:
    s_waitcnt vmcnt(10)
    s_barrier
    s_add_u32 s62, s62, 128
    s_add_u32 s63, s63, s48
    s_add_u32 s64, s64, 2560
    s_cmp_eq_u32 s62, 1280
    s_cselect_b32 s62, 0, s62
    s_cselect_b32 s63, 0, s63
    s_cselect_b32 s64, 0, s64
    s_add_u32 m0, s53, 0
    s_add_u32 s65, s62, 0
    buffer_load_dwordx4 v168, s[28:31], s65 offen lds
    s_add_u32 m0, s53, 1024
    s_add_u32 s65, s62, 10240
    buffer_load_dwordx4 v169, s[28:31], s65 offen lds
    s_add_u32 m0, s53, 2048
    s_add_u32 s65, s62, 20480
    buffer_load_dwordx4 v168, s[28:31], s65 offen lds
    s_add_u32 m0, s53, 3072
    s_add_u32 s65, s62, 30720
    buffer_load_dwordx4 v169, s[28:31], s65 offen lds
    s_add_u32 m0, s52, 0
    s_nop 0
    buffer_load_dwordx4 v144, s[40:43], s63 offen lds
    s_add_u32 m0, s52, 1024
    s_nop 0
    buffer_load_dwordx4 v145, s[40:43], s63 offen lds
    s_add_u32 m0, s52, 2048
    s_nop 0
    buffer_load_dwordx4 v146, s[40:43], s63 offen lds
    s_add_u32 m0, s52, 3072
    s_nop 0
    buffer_load_dwordx4 v147, s[40:43], s63 offen lds
    s_add_u32 m0, s52, 4096
    s_nop 0
    buffer_load_dwordx4 v148, s[40:43], s63 offen lds
    s_add_u32 m0, s54, 0
    s_mov_b32 exec_hi, 0xff
    buffer_load_dwordx4 v149, s[44:47], s64 offen lds
    s_mov_b32 exec_hi, -1
    s_cmp_lg_u32 s25, 9
    s_cbranch_scc1 K1_NG2
    ds_read_b128 v[16:19], v164 offset:8192
    ds_read_b128 v[32:35], v171 offset:0
    ds_read_b128 v[20:23], v165 offset:8192
    ds_read_b128 v[36:39], v171 offset:32
    ds_read_b128 v[24:27], v166 offset:8192
    ds_read_b128 v[40:43], v171 offset:64
    ds_read_b128 v[28:31], v167 offset:8192
    ds_read_b128 v[44:47], v171 offset:96
    s_add_u32 s66, s66, 128
    s_cmp_eq_u32 s66, 1280
    s_cselect_b32 s66, 0, s66
    v_add_u32 v171, s66, v172
    s_waitcnt lgkmcnt(0)
    v_dot2c_f32_bf16 v170, v16, v32
    v_dot2c_f32_bf16 v170, v17, v33
    v_dot2c_f32_bf16 v170, v18, v34
    v_dot2c_f32_bf16 v170, v19, v35
    v_dot2c_f32_bf16 v170, v20, v36
    v_dot2c_f32_bf16 v170, v21, v37
    v_dot2c_f32_bf16 v170, v22, v38
    v_dot2c_f32_bf16 v170, v23, v39
    v_dot2c_f32_bf16 v170, v24, v40
    v_dot2c_f32_bf16 v170, v25, v41
    v_dot2c_f32_bf16 v170, v26, v42
    v_dot2c_f32_bf16 v170, v27, v43
    v_dot2c_f32_bf16 v170, v28, v44
    v_dot2c_f32_bf16 v170, v29, v45
    v_dot2c_f32_bf16 v170, v30, v46
    v_dot2c_f32_bf16 v170, v31, v47
K1_NG2:
    s_waitcnt vmcnt(10)
    s_barrier
    s_add_u32 s62, s62, 128
    s_add_u32 s63, s63, s48
    s_add_u32 s64, s64, 2560
    s_cmp_eq_u32 s62, 1280
    s_cselect_b32 s62, 0, s62
    s_cselect_b32 s63, 0, s63
    s_cselect_b32 s64, 0, s64
    s_add_u32 m0, s53, 4096
    s_add_u32 s65, s62, 0
    buffer_load_dwordx4 v168, s[28:31], s65 offen lds
    s_add_u32 m0, s53, 5120
    s_add_u32 s65, s62, 10240
    buffer_load_dwordx4 v169, s[28:31], s65 offen lds
    s_add_u32 m0, s53, 6144
    s_add_u32 s65, s62, 20480
    buffer_load_dwordx4 v168, s[28:31], s65 offen lds
    s_add_u32 m0, s53, 7168
    s_add_u32 s65, s62, 30720
    buffer_load_dwordx4 v169, s[28:31], s65 offen lds
    s_add_u32 m0, s52, 23040
    s_nop 0
    buffer_load_dwordx4 v144, s[40:43], s63 offen lds
    s_add_u32 m0, s52, 24064
    s_nop 0
    buffer_load_dwordx4 v145, s[40:43], s63 offen lds
    s_add_u32 m0, s52, 25088
    s_nop 0
    buffer_load_dwordx4 v146, s[40:43], s63 offen lds
    s_add_u32 m0, s52, 26112
    s_nop 0
    buffer_load_dwordx4 v147, s[40:43], s63 offen lds
    s_add_u32 m0, s52, 27136
    s_nop 0
    buffer_load_dwordx4 v148, s[40:43], s63 offen lds
    s_add_u32 m0, s54, 23040
    s_mov_b32 exec_hi, 0xff
    buffer_load_dwordx4 v149, s[44:47], s64 offen lds
    s_mov_b32 exec_hi, -1
    s_cmp_lg_u32 s25, 9
    s_cbranch_scc1 K1_NG3
    ds_read_b128 v[16:19], v164 offset:12288
    ds_read_b128 v[32:35], v171 offset:0
    ds_read_b128 v[20:23], v165 offset:12288
    ds_read_b128 v[36:39], v171 offset:32
    ds_read_b128 v[24:27], v166 offset:12288
    ds_read_b128 v[40:43], v171 offset:64
    ds_read_b128 v[28:31], v167 offset:12288
    ds_read_b128 v[44:47], v171 offset:96
    s_add_u32 s66, s66, 128
    s_cmp_eq_u32 s66, 1280
    s_cselect_b32 s66, 0, s66
    v_add_u32 v171, s66, v172
    s_waitcnt lgkmcnt(0)
    v_dot2c_f32_bf16 v170, v16, v32
    v_dot2c_f32_bf16 v170, v17, v33
    v_dot2c_f32_bf16 v170, v18, v34
    v_dot2c_f32_bf16 v170, v19, v35
    v_dot2c_f32_bf16 v170, v20, v36
    v_dot2c_f32_bf16 v170, v21, v37
    v_dot2c_f32_bf16 v170, v22, v38
    v_dot2c_f32_bf16 v170, v23, v39
    v_dot2c_f32_bf16 v170, v24, v40
    v_dot2c_f32_bf16 v170, v25, v41
    v_dot2c_f32_bf16 v170, v26, v42
    v_dot2c_f32_bf16 v170, v27, v43
    v_dot2c_f32_bf16 v170, v28, v44
    v_dot2c_f32_bf16 v170, v29, v45
    v_dot2c_f32_bf16 v170, v30, v46
    v_dot2c_f32_bf16 v170, v31, v47
K1_NG3:
    s_waitcnt vmcnt(10)
    s_barrier
    s_add_u32 s62, s62, 128
    s_add_u32 s63, s63, s48
    s_add_u32 s64, s64, 2560
    s_cmp_eq_u32 s62, 1280
    s_cselect_b32 s62, 0, s62
    s_cselect_b32 s63, 0, s63
    s_cselect_b32 s64, 0, s64
    s_add_u32 m0, s53, 8192
    s_add_u32 s65, s62, 0
    buffer_load_dwordx4 v168, s[28:31], s65 offen lds
    s_add_u32 m0, s53, 9216
    s_add_u32 s65, s62, 10240
    buffer_load_dwordx4 v169, s[28:31], s65 offen lds
    s_add_u32 m0, s53, 10240
    s_add_u32 s65, s62, 20480
    buffer_load_dwordx4 v168, s[28:31], s65 offen lds
    s_add_u32 m0, s53, 11264
    s_add_u32 s65, s62, 30720
    buffer_load_dwordx4 v169, s[28:31], s65 offen lds
    s_add_u32 m0, s52, 46080
    s_nop 0
    buffer_load_dwordx4 v144, s[40:43], s63 offen lds
    s_add_u32 m0, s52, 47104
    s_nop 0
    buffer_load_dwordx4 v145, s[40:43], s63 offen lds
    s_add_u32 m0, s52, 48128
    s_nop 0
    buffer_load_dwordx4 v146, s[40:43], s63 offen lds
    s_add_u32 m0, s52, 49152
    s_nop 0
    buffer_load_dwordx4 v147, s[40:43], s63 offen lds
    s_add_u32 m0, s52, 50176
    s_nop 0
    buffer_load_dwordx4 v148, s[40:43], s63 offen lds
    s_add_u32 m0, s54, 46080
    s_mov_b32 exec_hi, 0xff
    buffer_load_dwordx4 v149, s[44:47], s64 offen lds
    s_mov_b32 exec_hi, -1
    s_cmp_lg_u32 s25, 9
    s_cbranch_scc1 K1_NG4
    ds_read_b128 v[16:19], v164 offset:0
    ds_read_b128 v[32:35], v171 offset:0
    ds_read_b128 v[20:23], v165 offset:0
    ds_read_b128 v[36:39], v171 offset:32
    ds_read_b128 v[24:27], v166 offset:0
    ds_read_b128 v[40:43], v171 offset:64
    ds_read_b128 v[28:31], v167 offset:0
    ds_read_b128 v[44:47], v171 offset:96
    s_add_u32 s66, s66, 128
    s_cmp_eq_u32 s66, 1280
    s_cselect_b32 s66, 0, s66
    v_add_u32 v171, s66, v172
    s_waitcnt lgkmcnt(0)
    v_dot2c_f32_bf16 v170, v16, v32
    v_dot2c_f32_bf16 v170, v17, v33
    v_dot2c_f32_bf16 v170, v18, v34
    v_dot2c_f32_bf16 v170, v19, v35
    v_dot2c_f32_bf16 v170, v20, v36
    v_dot2c_f32_bf16 v170, v21, v37
    v_dot2c_f32_bf16 v170, v22, v38
    v_dot2c_f32_bf16 v170, v23, v39
    v_dot2c_f32_bf16 v170, v24, v40
    v_dot2c_f32_bf16 v170, v25, v41
    v_dot2c_f32_bf16 v170, v26, v42
    v_dot2c_f32_bf16 v170, v27, v43
    v_dot2c_f32_bf16 v170, v28, v44
    v_dot2c_f32_bf16 v170, v29, v45
    v_dot2c_f32_bf16 v170, v30, v46
    v_dot2c_f32_bf16 v170, v31, v47
K1_NG4:
    s_waitcnt vmcnt(10)
    s_barrier
    s_add_u32 s62, s62, 128
    s_add_u32 s63, s63, s48
    s_add_u32 s64, s64, 2560
    s_cmp_eq_u32 s62, 1280
    s_cselect_b32 s62, 0, s62
    s_cselect_b32 s63, 0, s63
    s_cselect_b32 s64, 0, s64
    s_add_u32 m0, s53, 12288
    s_add_u32 s65, s62, 0
    buffer_load_dwordx4 v168, s[28:31], s65 offen lds
    s_add_u32 m0, s53, 13312
    s_add_u32 s65, s62, 10240
    buffer_load_dwordx4 v169, s[28:31], s65 offen lds
    s_add_u32 m0, s53, 14336
    s_add_u32 s65, s62, 20480
    buffer_load_dwordx4 v168, s[28:31], s65 offen lds
    s_add_u32 m0, s53, 15360
    s_add_u32 s65, s62, 30720
    buffer_load_dwordx4 v169, s[28:31], s65 offen lds
    s_add_u32 m0, s52, 69120
    s_nop 0
    buffer_load_dwordx4 v144, s[40:43], s63 offen lds
    s_add_u32 m0, s52, 70144
    s_nop 0
    buffer_load_dwordx4 v145, s[40:43], s63 offen lds
    s_add_u32 m0, s52, 71168
    s_nop 0
    buffer_load_dwordx4 v146, s[40:43], s63 offen lds
    s_add_u32 m0, s52, 72192
    s_nop 0
    buffer_load_dwordx4 v147, s[40:43], s63 offen lds
    s_add_u32 m0, s52, 73216
    s_nop 0
    buffer_load_dwordx4 v148, s[40:43], s63 offen lds
    s_add_u32 m0, s54, 69120
    s_mov_b32 exec_hi, 0xff
    buffer_load_dwordx4 v149, s[44:47], s64 offen lds
    s_mov_b32 exec_hi, -1
    s_cmp_lg_u32 s25, 9
    s_cbranch_scc1 K1_NG5
    ds_read_b128 v[16:19], v164 offset:4096
    ds_read_b128 v[32:35], v171 offset:0
    ds_read_b128 v[20:23], v165 offset:4096
    ds_read_b128 v[36:39], v171 offset:32
    ds_read_b128 v[24:27], v166 offset:4096
    ds_read_b128 v[40:43], v171 offset:64
    ds_read_b128 v[28:31], v167 offset:4096
    ds_read_b128 v[44:47], v171 offset:96
    s_add_u32 s66, s66, 128
    s_cmp_eq_u32 s66, 1280
    s_cselect_b32 s66, 0, s66
    v_add_u32 v171, s66, v172
    s_waitcnt lgkmcnt(0)
    v_dot2c_f32_bf16 v170, v16, v32
    v_dot2c_f32_bf16 v170, v17, v33
    v_dot2c_f32_bf16 v170, v18, v34
    v_dot2c_f32_bf16 v170, v19, v35
    v_dot2c_f32_bf16 v170, v20, v36
    v_dot2c_f32_bf16 v170, v21, v37
    v_dot2c_f32_bf16 v170, v22, v38
    v_dot2c_f32_bf16 v170, v23, v39
    v_dot2c_f32_bf16 v170, v24, v40
    v_dot2c_f32_bf16 v170, v25, v41
    v_dot2c_f32_bf16 v170, v26, v42
    v_dot2c_f32_bf16 v170, v27, v43
    v_dot2c_f32_bf16 v170, v28, v44
    v_dot2c_f32_bf16 v170, v29, v45
    v_dot2c_f32_bf16 v170, v30, v46
    v_dot2c_f32_bf16 v170, v31, v47
K1_NG5:
    s_waitcnt vmcnt(10)
    s_barrier
    s_add_u32 s62, s62, 128
    s_add_u32 s63, s63, s48
    s_add_u32 s64, s64, 2560
    s_cmp_eq_u32 s62, 1280
    s_cselect_b32 s62, 0, s62
    s_cselect_b32 s63, 0, s63
    s_cselect_b32 s64, 0, s64
    s_add_u32 m0, s53, 0
    s_add_u32 s65, s62, 0
    buffer_load_dwordx4 v168, s[28:31], s65 offen lds
    s_add_u32 m0, s53, 1024
    s_add_u32 s65, s62, 10240
    buffer_load_dwordx4 v169, s[28:31], s65 offen lds
    s_add_u32 m0, s53, 2048
    s_add_u32 s65, s62, 20480
    buffer_load_dwordx4 v168, s[28:31], s65 offen lds
    s_add_u32 m0, s53, 3072
    s_add_u32 s65, s62, 30720
    buffer_load_dwordx4 v169, s[28:31], s65 offen lds
    s_add_u32 m0, s52, 0
    s_nop 0
    buffer_load_dwordx4 v144, s[40:43], s63 offen lds
    s_add_u32 m0, s52, 1024
    s_nop 0
    buffer_load_dwordx4 v145, s[40:43], s63 offen lds
    s_add_u32 m0, s52, 2048
    s_nop 0
    buffer_load_dwordx4 v146, s[40:43], s63 offen lds
    s_add_u32 m0, s52, 3072
    s_nop 0
    buffer_load_dwordx4 v147, s[40:43], s63 offen lds
    s_add_u32 m0, s52, 4096
    s_nop 0
    buffer_load_dwordx4 v148, s[40:43], s63 offen lds
    s_add_u32 m0, s54, 0
    s_mov_b32 exec_hi, 0xff
    buffer_load_dwordx4 v149, s[44:47], s64 offen lds
    s_mov_b32 exec_hi, -1
    s_cmp_lg_u32 s25, 9
    s_cbranch_scc1 K1_NG6
    ds_read_b128 v[16:19], v164 offset:8192
    ds_read_b128 v[32:35], v171 offset:0
    ds_read_b128 v[20:23], v165 offset:8192
    ds_read_b128 v[36:39], v171 offset:32
    ds_read_b128 v[24:27], v166 offset:8192
    ds_read_b128 v[40:43], v171 offset:64
    ds_read_b128 v[28:31], v167 offset:8192
    ds_read_b128 v[44:47], v171 offset:96
    s_add_u32 s66, s66, 128
    s_cmp_eq_u32 s66, 1280
    s_cselect_b32 s66, 0, s66
    v_add_u32 v171, s66, v172
    s_waitcnt lgkmcnt(0)
    v_dot2c_f32_bf16 v170, v16, v32
    v_dot2c_f32_bf16 v170, v17, v33
    v_dot2c_f32_bf16 v170, v18, v34
    v_dot2c_f32_bf16 v170, v19, v35
    v_dot2c_f32_bf16 v170, v20, v36
    v_dot2c_f32_bf16 v170, v21, v37
    v_dot2c_f32_bf16 v170, v22, v38
    v_dot2c_f32_bf16 v170, v23, v39
    v_dot2c_f32_bf16 v170, v24, v40
    v_dot2c_f32_bf16 v170, v25, v41
    v_dot2c_f32_bf16 v170, v26, v42
    v_dot2c_f32_bf16 v170, v27, v43
    v_dot2c_f32_bf16 v170, v28, v44
    v_dot2c_f32_bf16 v170, v29, v45
    v_dot2c_f32_bf16 v170, v30, v46
    v_dot2c_f32_bf16 v170, v31, v47
K1_NG6:
    s_waitcnt vmcnt(10)
    s_barrier
    v_mov_b32 v80, 0
    global_load_dword v81, v80, s[20:21] sc1
    s_add_u32 s62, s62, 128
    s_add_u32 s63, s63, s48
    s_add_u32 s64, s64, 2560
    s_cmp_eq_u32 s62, 1280
    s_cselect_b32 s62, 0, s62
    s_cselect_b32 s63, 0, s63
    s_cselect_b32 s64, 0, s64
    s_add_u32 m0, s53, 4096
    s_add_u32 s65, s62, 0
    buffer_load_dwordx4 v168, s[28:31], s65 offen lds
    s_add_u32 m0, s53, 5120
    s_add_u32 s65, s62, 10240
    buffer_load_dwordx4 v169, s[28:31], s65 offen lds
    s_add_u32 m0, s53, 6144
    s_add_u32 s65, s62, 20480
    buffer_load_dwordx4 v168, s[28:31], s65 offen lds
    s_add_u32 m0, s53, 7168
    s_add_u32 s65, s62, 30720
    buffer_load_dwordx4 v169, s[28:31], s65 offen lds
    s_add_u32 m0, s52, 23040
    s_nop 0
    buffer_load_dwordx4 v144, s[40:43], s63 offen lds
    s_add_u32 m0, s52, 24064
    s_nop 0
    buffer_load_dwordx4 v145, s[40:43], s63 offen lds
    s_add_u32 m0, s52, 25088
    s_nop 0
    buffer_load_dwordx4 v146, s[40:43], s63 offen lds
    s_add_u32 m0, s52, 26112
    s_nop 0
    buffer_load_dwordx4 v147, s[40:43], s63 offen lds
    s_add_u32 m0, s52, 27136
    s_nop 0
    buffer_load_dwordx4 v148, s[40:43], s63 offen lds
    s_add_u32 m0, s54, 23040
    s_mov_b32 exec_hi, 0xff
    buffer_load_dwordx4 v149, s[44:47], s64 offen lds
    s_mov_b32 exec_hi, -1
    s_cmp_lg_u32 s25, 9
    s_cbranch_scc1 K1_NG7
    ds_read_b128 v[16:19], v164 offset:12288
    ds_read_b128 v[32:35], v171 offset:0
    ds_read_b128 v[20:23], v165 offset:12288
    ds_read_b128 v[36:39], v171 offset:32
    ds_read_b128 v[24:27], v166 offset:12288
    ds_read_b128 v[40:43], v171 offset:64
    ds_read_b128 v[28:31], v167 offset:12288
    ds_read_b128 v[44:47], v171 offset:96
    s_add_u32 s66, s66, 128
    s_cmp_eq_u32 s66, 1280
    s_cselect_b32 s66, 0, s66
    v_add_u32 v171, s66, v172
    s_waitcnt lgkmcnt(0)
    v_dot2c_f32_bf16 v170, v16, v32
    v_dot2c_f32_bf16 v170, v17, v33
    v_dot2c_f32_bf16 v170, v18, v34
    v_dot2c_f32_bf16 v170, v19, v35
    v_dot2c_f32_bf16 v170, v20, v36
    v_dot2c_f32_bf16 v170, v21, v37
    v_dot2c_f32_bf16 v170, v22, v38
    v_dot2c_f32_bf16 v170, v23, v39
    v_dot2c_f32_bf16 v170, v24, v40
    v_dot2c_f32_bf16 v170, v25, v41
    v_dot2c_f32_bf16 v170, v26, v42
    v_dot2c_f32_bf16 v170, v27, v43
    v_dot2c_f32_bf16 v170, v28, v44
    v_dot2c_f32_bf16 v170, v29, v45
    v_dot2c_f32_bf16 v170, v30, v46
    v_dot2c_f32_bf16 v170, v31, v47
K1_NG7:
    s_waitcnt vmcnt(10)
    s_barrier
    s_cmp_lg_u32 s25, 9
    s_cbranch_scc1 K1_NG8
    ds_read_b128 v[16:19], v164 offset:0
    ds_read_b128 v[32:35], v171 offset:0
    ds_read_b128 v[20:23], v165 offset:0
    ds_read_b128 v[36:39], v171 offset:32
    ds_read_b128 v[24:27], v166 offset:0
    ds_read_b128 v[40:43], v171 offset:64
    ds_read_b128 v[28:31], v167 offset:0
    ds_read_b128 v[44:47], v171 offset:96
    s_add_u32 s66, s66, 128
    s_cmp_eq_u32 s66, 1280
    s_cselect_b32 s66, 0, s66
    v_add_u32 v171, s66, v172
    s_waitcnt lgkmcnt(0)
    v_dot2c_f32_bf16 v170, v16, v32
    v_dot2c_f32_bf16 v170, v17, v33
    v_dot2c_f32_bf16 v170, v18, v34
    v_dot2c_f32_bf16 v170, v19, v35
    v_dot2c_f32_bf16 v170, v20, v36
    v_dot2c_f32_bf16 v170, v21, v37
    v_dot2c_f32_bf16 v170, v22, v38
    v_dot2c_f32_bf16 v170, v23, v39
    v_dot2c_f32_bf16 v170, v24, v40
    v_dot2c_f32_bf16 v170, v25, v41
    v_dot2c_f32_bf16 v170, v26, v42
    v_dot2c_f32_bf16 v170, v27, v43
    v_dot2c_f32_bf16 v170, v28, v44
    v_dot2c_f32_bf16 v170, v29, v45
    v_dot2c_f32_bf16 v170, v30, v46
    v_dot2c_f32_bf16 v170, v31, v47
K1_NG8:
    s_waitcnt vmcnt(0)
    s_barrier
    s_cmp_lg_u32 s25, 9
    s_cbranch_scc1 K1_NG9
    ds_read_b128 v[16:19], v164 offset:4096
    ds_read_b128 v[32:35], v171 offset:0
    ds_read_b128 v[20:23], v165 offset:4096
    ds_read_b128 v[36:39], v171 offset:32
    ds_read_b128 v[24:27], v166 offset:4096
    ds_read_b128 v[40:43], v171 offset:64
    ds_read_b128 v[28:31], v167 offset:4096
    ds_read_b128 v[44:47], v171 offset:96
    s_add_u32 s66, s66, 128
    s_cmp_eq_u32 s66, 1280
    s_cselect_b32 s66, 0, s66
    v_add_u32 v171, s66, v172
    s_waitcnt lgkmcnt(0)
    v_dot2c_f32_bf16 v170, v16, v32
    v_dot2c_f32_bf16 v170, v17, v33
    v_dot2c_f32_bf16 v170, v18, v34
    v_dot2c_f32_bf16 v170, v19, v35
    v_dot2c_f32_bf16 v170, v20, v36
    v_dot2c_f32_bf16 v170, v21, v37
    v_dot2c_f32_bf16 v170, v22, v38
    v_dot2c_f32_bf16 v170, v23, v39
    v_dot2c_f32_bf16 v170, v24, v40
    v_dot2c_f32_bf16 v170, v25, v41
    v_dot2c_f32_bf16 v170, v26, v42
    v_dot2c_f32_bf16 v170, v27, v43
    v_dot2c_f32_bf16 v170, v28, v44
    v_dot2c_f32_bf16 v170, v29, v45
    v_dot2c_f32_bf16 v170, v30, v46
    v_dot2c_f32_bf16 v170, v31, v47
K1_NG9:
    s_cmp_lg_u32 s25, 9
    s_cbranch_scc1 K1_NOGST
    s_nop 3
    v_mov_b32 v4, v170
    s_nop 1
    v_permlane32_swap_b32 v4, v170
    s_nop 1
    v_add_f32 v4, v4, v170
    v_mul_f32 v4, 0xbfb8aa3b, v4
    v_exp_f32 v4, v4
    s_lshl_b32 s5, s27, 7
    v_add_f32 v4, 1.0, v4
    v_rcp_f32 v4, v4
    s_add_u32 s5, s5, 2883584
    v_lshl_add_u32 v5, v2, 2, s5
    buffer_store_dword v4, v5, s[32:35], 0 offen sc1
    s_waitcnt vmcnt(0)
K1_NOGST:
    s_mov_b32 s36, s18
    s_mov_b32 s37, s19
    s_mov_b32 s38, 8388608
    s_mov_b32 s39, 0x00020000
    s_lshl_b32 s5, s4, 2
    s_add_u32 s5, s5, s26
    s_lshl_b32 s5, s5, 13
    s_lshl_b32 s6, s3, 20
    s_add_u32 s5, s5, s6
    v_and_b32 v8, 3, v1
    v_lshrrev_b32 v9, 2, v1
    v_lshlrev_b32 v8, 11, v8
    v_lshl_add_u32 v8, v9, 7, v8
    v_add_u32 v8, s5, v8
    s_mov_b32 exec_lo, 0xffffffff
    s_mov_b32 exec_hi, 0x0
    buffer_load_dword v214, v8, s[36:39], 0 offen
    s_mov_b64 exec, -1
    s_barrier
    s_mov_b32 s31, 0
    s_branch T_SETUP
K1_COMPUTE:
    s_mov_b32 s31, 0
    s_lshl_b32 s5, s27, 5
    v_add_u32 v6, s5, v2
    v_bfe_u32 v4, v1, 2, 2
    v_lshl_add_u32 v4, v3, 3, v4
    v_mul_u32_u24 v4, 320, v4
    v_bfe_u32 v8, v1, 4, 1
    v_and_b32 v9, 1, v1
    v_bfe_u32 v10, v1, 1, 1
    v_lshl_add_u32 v9, v9, 1, v10
    s_cmp_lt_u32 s25, 4
    s_cselect_b32 s5, 40, 32
    v_mul_u32_u24 v10, s5, v8
    v_add_u32 v10, v10, v4
    v_lshl_add_u32 v160, v9, 3, v10
    v_add_u32 v161, 46080, v160
    v_lshl_add_u32 v10, v8, 2, v9
    v_mul_u32_u24 v10, 40, v10
    v_add3_u32 v162, v10, v4, 32
    v_add_u32 v163, 46080, v162
    v_add_u32 v11, 256, v160
    v_mov_b32 v12, 320
    v_bfe_u32 v13, v1, 2, 2
    v_lshl_add_u32 v13, v3, 3, v13
    v_mul_u32_u24 v13, 40, v13
    s_and_b32 s5, s25, 1
    s_cmp_eq_u32 s5, 1
    s_cselect_b32 s5, 0, 8
    s_cselect_b32 s6, 32, 0
    v_mad_u32_u24 v13, v9, s5, v13
    s_add_u32 s6, s6, 20480
    v_add_u32 v13, s6, v13
    s_sub_u32 s5, s25, 4
    s_cmp_lt_u32 s5, 4
    s_cselect_b32 s40, 0xffff0000, 0
    s_mov_b32 s41, s40
    v_mov_b32 v14, 40
    v_cndmask_b32 v11, v11, v13, s[40:41]
    v_cndmask_b32 v12, v12, v14, s[40:41]
    v_mad_u32_u24 v144, v12, 0, v11
    v_add_u32 v152, 46080, v144
    v_mad_u32_u24 v145, v12, 4, v11
    v_add_u32 v153, 46080, v145
    v_mad_u32_u24 v146, v12, 16, v11
    v_add_u32 v154, 46080, v146
    v_mad_u32_u24 v147, v12, 20, v11
    v_add_u32 v155, 46080, v147
    v_mad_u32_u24 v148, v12, 32, v11
    v_add_u32 v156, 46080, v148
    v_mad_u32_u24 v149, v12, 36, v11
    v_add_u32 v157, 46080, v149
    v_mad_u32_u24 v150, v12, 48, v11
    v_add_u32 v158, 46080, v150
    v_mad_u32_u24 v151, v12, 52, v11
    v_add_u32 v159, 46080, v151
    v_bfe_u32 v4, v2, 1, 3
    v_xor_b32 v4, v4, v3
    v_lshlrev_b32 v4, 4, v4
    v_lshl_add_u32 v4, v2, 7, v4
    v_xor_b32 v164, 0, v4
    v_add_u32 v164, s53, v164
    v_xor_b32 v165, 32, v4
    v_add_u32 v165, s53, v165
    v_xor_b32 v166, 64, v4
    v_add_u32 v166, s53, v166
    v_xor_b32 v167, 96, v4
    v_add_u32 v167, s53, v167
    v_lshlrev_b32 v172, 4, v3
    v_add_u32 v172, 157696, v172
    v_add_u32 v171, s66, v172
    v_mov_b32 v170, 0
    v_mov_b32 v180, 0xc0135761
    v_mov_b32 v181, 0xc0135761
    v_mov_b32 v182, 0xbdd2d3e8
    v_mov_b32 v183, 0xbdd2d3e8
    v_mov_b32 v8, s98
    s_lshl_b32 s5, s27, 2
    s_add_u32 s5, s5, s25
    s_lshl_b32 s5, s5, 2
    s_add_u32 s99, s5, 3100656
    s_sub_u32 s5, s25, 4
    s_cmp_lt_u32 s5, 4
    s_cselect_b32 s99, s99, s98
    v_writelane_b32 v8, s99, 1
    s_lshl_b32 s40, s3, 2
    s_lshr_b32 s5, s4, 3
    s_add_u32 s40, s40, s5
    s_and_b32 s41, s4, 7
    s_lshl_b32 s5, s41, 5
    s_add_u32 s5, s5, s40
    s_lshl_b32 s6, s40, 3
    s_add_u32 s6, s6, s41
    s_add_u32 s6, s6, 256
    s_cmp_lt_u32 s26, 2
    s_cselect_b32 s5, s5, s6
    s_lshl_b32 s5, s5, 1
    s_and_b32 s6, s26, 1
    s_add_u32 s5, s5, s6
    s_lshl_b32 s5, s5, 4
    s_add_u32 s5, s5, 3080192
    v_mov_b32 v11, s5
    v_mov_b32 v96, 0
    v_mov_b32 v97, 0
    v_mov_b32 v98, 0
    v_mov_b32 v99, 0
    v_mov_b32 v9, 0
    v_mov_b32 v10, 1
    s_waitcnt lgkmcnt(0)
    s_mov_b32 s32, s22
    s_mov_b32 s33, s23
    s_mov_b32 s34, 23068672
    s_mov_b32 s35, 0x00020000
    s_mov_b64 exec, 3
    buffer_store_dword v9, v8, s[32:35], 0 offen sc1
    s_mov_b64 exec, 1
    buffer_store_dwordx4 v[96:99], v11, s[32:35], 0 offen sc1
    s_mov_b64 exec, -1
    s_cmp_lt_u32 s25, 10
    s_cbranch_scc1 K1_NOCLR
    v_mov_b32 v12, 0
    v_mov_b32 v13, -1
    buffer_store_dwordx2 v[12:13], v7, s[32:35], 0 offen sc1
K1_NOCLR:
    s_waitcnt vmcnt(0)
    s_cmp_lt_u32 s25, 4
    s_cbranch_scc1 K1_LOOP_Q
    s_barrier
    s_cmp_lg_u32 s26, 0
    s_cbranch_scc1 K1_NOC1_1
    s_mov_b64 exec, 1
    global_atomic_add v9, v10, s[20:21] sc1
    s_mov_b64 exec, -1
K1_NOC1_1:
    ds_read_b128 v[136:139], v164 offset:0
    ds_read_b64_tr_b16 v[96:97], v160 offset:0
    ds_read_b64_tr_b16 v[98:99], v160 offset:1280
    ds_read_b64_tr_b16 v[100:101], v160 offset:64
    ds_read_b64_tr_b16 v[102:103], v160 offset:1344
    ds_read_b64_tr_b16 v[104:105], v160 offset:128
    ds_read_b64_tr_b16 v[106:107], v160 offset:1408
    ds_read_b64_tr_b16 v[108:109], v160 offset:192
    ds_read_b64_tr_b16 v[110:111], v160 offset:1472
    ds_read_b64_tr_b16 v[112:113], v144 offset:0
    ds_read_b64_tr_b16 v[114:115], v145 offset:0
    s_waitcnt lgkmcnt(8)
    v_mfma_f32_32x32x16_bf16 v[16:31], v[96:99], v[136:139], 0
    ds_read_b128 v[140:143], v165 offset:0
    ds_read_b64_tr_b16 v[116:117], v160 offset:5120
    ds_read_b64_tr_b16 v[118:119], v160 offset:6400
    s_waitcnt lgkmcnt(9)
    v_mfma_f32_32x32x16_bf16 v[32:47], v[100:103], v[136:139], 0
    ds_read_b64_tr_b16 v[120:121], v160 offset:5184
    ds_read_b64_tr_b16 v[122:123], v160 offset:6464
    s_waitcnt lgkmcnt(9)
    v_mfma_f32_32x32x16_bf16 v[48:63], v[104:107], v[136:139], 0
    ds_read_b64_tr_b16 v[124:125], v160 offset:5248
    ds_read_b64_tr_b16 v[126:127], v160 offset:6528
    s_waitcnt lgkmcnt(9)
    v_mfma_f32_32x32x16_bf16 v[64:79], v[108:111], v[136:139], 0
    ds_read_b64_tr_b16 v[128:129], v160 offset:5312
    ds_read_b64_tr_b16 v[130:131], v160 offset:6592
    s_waitcnt lgkmcnt(9)
    v_mfma_f32_32x32x16_bf16 v[80:95], v[112:115], v[136:139], 0
    ds_read_b64_tr_b16 v[132:133], v146 offset:0
    ds_read_b64_tr_b16 v[134:135], v147 offset:0
    s_waitcnt lgkmcnt(8)
    v_mfma_f32_32x32x16_bf16 v[16:31], v[116:119], v[140:143], v[16:31]
    ds_read_b128 v[136:139], v166 offset:0
    ds_read_b64_tr_b16 v[96:97], v160 offset:10240
    ds_read_b64_tr_b16 v[98:99], v160 offset:11520
    s_waitcnt lgkmcnt(9)
    v_mfma_f32_32x32x16_bf16 v[32:47], v[120:123], v[140:143], v[32:47]
    ds_read_b64_tr_b16 v[100:101], v160 offset:10304
    ds_read_b64_tr_b16 v[102:103], v160 offset:11584
    s_waitcnt lgkmcnt(9)
    v_mfma_f32_32x32x16_bf16 v[48:63], v[124:127], v[140:143], v[48:63]
    ds_read_b64_tr_b16 v[104:105], v160 offset:10368
    ds_read_b64_tr_b16 v[106:107], v160 offset:11648
    s_waitcnt lgkmcnt(9)
    v_mfma_f32_32x32x16_bf16 v[64:79], v[128:131], v[140:143], v[64:79]
    ds_read_b64_tr_b16 v[108:109], v160 offset:10432
    ds_read_b64_tr_b16 v[110:111], v160 offset:11712
    s_waitcnt lgkmcnt(9)
    v_mfma_f32_32x32x16_bf16 v[80:95], v[132:135], v[140:143], v[80:95]
    ds_read_b64_tr_b16 v[112:113], v148 offset:0
    ds_read_b64_tr_b16 v[114:115], v149 offset:0
    s_waitcnt lgkmcnt(8)
    v_mfma_f32_32x32x16_bf16 v[16:31], v[96:99], v[136:139], v[16:31]
    ds_read_b128 v[140:143], v167 offset:0
    ds_read_b64_tr_b16 v[116:117], v160 offset:15360
    ds_read_b64_tr_b16 v[118:119], v160 offset:16640
    s_waitcnt lgkmcnt(9)
    v_mfma_f32_32x32x16_bf16 v[32:47], v[100:103], v[136:139], v[32:47]
    ds_read_b64_tr_b16 v[120:121], v160 offset:15424
    ds_read_b64_tr_b16 v[122:123], v160 offset:16704
    s_waitcnt lgkmcnt(9)
    v_mfma_f32_32x32x16_bf16 v[48:63], v[104:107], v[136:139], v[48:63]
    ds_read_b64_tr_b16 v[124:125], v160 offset:15488
    ds_read_b64_tr_b16 v[126:127], v160 offset:16768
    s_waitcnt lgkmcnt(9)
    v_mfma_f32_32x32x16_bf16 v[64:79], v[108:111], v[136:139], v[64:79]
    ds_read_b64_tr_b16 v[128:129], v160 offset:15552
    ds_read_b64_tr_b16 v[130:131], v160 offset:16832
    s_waitcnt lgkmcnt(9)
    v_mfma_f32_32x32x16_bf16 v[80:95], v[112:115], v[136:139], v[80:95]
    ds_read_b64_tr_b16 v[132:133], v150 offset:0
    ds_read_b64_tr_b16 v[134:135], v151 offset:0
    s_barrier
    s_waitcnt lgkmcnt(8)
    v_mfma_f32_32x32x16_bf16 v[16:31], v[116:119], v[140:143], v[16:31]
    ds_read_b128 v[136:139], v164 offset:4096
    ds_read_b64_tr_b16 v[96:97], v160 offset:23040
    ds_read_b64_tr_b16 v[98:99], v160 offset:24320
    s_waitcnt lgkmcnt(9)
    v_mfma_f32_32x32x16_bf16 v[32:47], v[120:123], v[140:143], v[32:47]
    ds_read_b64_tr_b16 v[100:101], v160 offset:23104
    ds_read_b64_tr_b16 v[102:103], v160 offset:24384
    s_waitcnt lgkmcnt(9)
    v_mfma_f32_32x32x16_bf16 v[48:63], v[124:127], v[140:143], v[48:63]
    ds_read_b64_tr_b16 v[104:105], v160 offset:23168
    ds_read_b64_tr_b16 v[106:107], v160 offset:24448
    s_waitcnt lgkmcnt(9)
    v_mfma_f32_32x32x16_bf16 v[64:79], v[128:131], v[140:143], v[64:79]
    ds_read_b64_tr_b16 v[108:109], v160 offset:23232
    ds_read_b64_tr_b16 v[110:111], v160 offset:24512
    s_waitcnt lgkmcnt(9)
    v_mfma_f32_32x32x16_bf16 v[80:95], v[132:135], v[140:143], v[80:95]
    ds_read_b64_tr_b16 v[112:113], v144 offset:23040
    ds_read_b64_tr_b16 v[114:115], v145 offset:23040
    s_waitcnt lgkmcnt(8)
    v_mfma_f32_32x32x16_bf16 v[16:31], v[96:99], v[136:139], v[16:31]
    ds_read_b128 v[140:143], v165 offset:4096
    ds_read_b64_tr_b16 v[116:117], v160 offset:28160
    ds_read_b64_tr_b16 v[118:119], v160 offset:29440
    s_waitcnt lgkmcnt(9)
    v_mfma_f32_32x32x16_bf16 v[32:47], v[100:103], v[136:139], v[32:47]
    ds_read_b64_tr_b16 v[120:121], v160 offset:28224
    ds_read_b64_tr_b16 v[122:123], v160 offset:29504
    s_waitcnt lgkmcnt(9)
    v_mfma_f32_32x32x16_bf16 v[48:63], v[104:107], v[136:139], v[48:63]
    ds_read_b64_tr_b16 v[124:125], v160 offset:28288
    ds_read_b64_tr_b16 v[126:127], v160 offset:29568
    s_waitcnt lgkmcnt(9)
    v_mfma_f32_32x32x16_bf16 v[64:79], v[108:111], v[136:139], v[64:79]
    ds_read_b64_tr_b16 v[128:129], v160 offset:28352
    ds_read_b64_tr_b16 v[130:131], v160 offset:29632
    s_waitcnt lgkmcnt(9)
    v_mfma_f32_32x32x16_bf16 v[80:95], v[112:115], v[136:139], v[80:95]
    ds_read_b64_tr_b16 v[132:133], v146 offset:23040
    ds_read_b64_tr_b16 v[134:135], v147 offset:23040
    s_waitcnt lgkmcnt(8)
    v_mfma_f32_32x32x16_bf16 v[16:31], v[116:119], v[140:143], v[16:31]
    ds_read_b128 v[136:139], v166 offset:4096
    ds_read_b64_tr_b16 v[96:97], v160 offset:33280
    ds_read_b64_tr_b16 v[98:99], v160 offset:34560
    s_waitcnt lgkmcnt(9)
    v_mfma_f32_32x32x16_bf16 v[32:47], v[120:123], v[140:143], v[32:47]
    ds_read_b64_tr_b16 v[100:101], v160 offset:33344
    ds_read_b64_tr_b16 v[102:103], v160 offset:34624
    s_waitcnt lgkmcnt(9)
    v_mfma_f32_32x32x16_bf16 v[48:63], v[124:127], v[140:143], v[48:63]
    ds_read_b64_tr_b16 v[104:105], v160 offset:33408
    ds_read_b64_tr_b16 v[106:107], v160 offset:34688
    s_waitcnt lgkmcnt(9)
    v_mfma_f32_32x32x16_bf16 v[64:79], v[128:131], v[140:143], v[64:79]
    ds_read_b64_tr_b16 v[108:109], v160 offset:33472
    ds_read_b64_tr_b16 v[110:111], v160 offset:34752
    s_waitcnt lgkmcnt(9)
    v_mfma_f32_32x32x16_bf16 v[80:95], v[132:135], v[140:143], v[80:95]
    ds_read_b64_tr_b16 v[112:113], v148 offset:23040
    ds_read_b64_tr_b16 v[114:115], v149 offset:23040
    s_waitcnt lgkmcnt(8)
    v_mfma_f32_32x32x16_bf16 v[16:31], v[96:99], v[136:139], v[16:31]
    ds_read_b128 v[140:143], v167 offset:4096
    ds_read_b64_tr_b16 v[116:117], v160 offset:38400
    ds_read_b64_tr_b16 v[118:119], v160 offset:39680
    s_waitcnt lgkmcnt(9)
    v_mfma_f32_32x32x16_bf16 v[32:47], v[100:103], v[136:139], v[32:47]
    ds_read_b64_tr_b16 v[120:121], v160 offset:38464
    ds_read_b64_tr_b16 v[122:123], v160 offset:39744
    s_waitcnt lgkmcnt(9)
    v_mfma_f32_32x32x16_bf16 v[48:63], v[104:107], v[136:139], v[48:63]
    ds_read_b64_tr_b16 v[124:125], v160 offset:38528
    ds_read_b64_tr_b16 v[126:127], v160 offset:39808
    s_waitcnt lgkmcnt(9)
    v_mfma_f32_32x32x16_bf16 v[64:79], v[108:111], v[136:139], v[64:79]
    ds_read_b64_tr_b16 v[128:129], v160 offset:38592
    ds_read_b64_tr_b16 v[130:131], v160 offset:39872
    s_waitcnt lgkmcnt(9)
    v_mfma_f32_32x32x16_bf16 v[80:95], v[112:115], v[136:139], v[80:95]
    ds_read_b64_tr_b16 v[132:133], v150 offset:23040
    ds_read_b64_tr_b16 v[134:135], v151 offset:23040
    s_barrier
    s_waitcnt lgkmcnt(8)
    v_mfma_f32_32x32x16_bf16 v[16:31], v[116:119], v[140:143], v[16:31]
    ds_read_b128 v[136:139], v164 offset:8192
    ds_read_b64_tr_b16 v[96:97], v161 offset:0
    ds_read_b64_tr_b16 v[98:99], v161 offset:1280
    s_waitcnt lgkmcnt(9)
    v_mfma_f32_32x32x16_bf16 v[32:47], v[120:123], v[140:143], v[32:47]
    ds_read_b64_tr_b16 v[100:101], v161 offset:64
    ds_read_b64_tr_b16 v[102:103], v161 offset:1344
    s_waitcnt lgkmcnt(9)
    v_mfma_f32_32x32x16_bf16 v[48:63], v[124:127], v[140:143], v[48:63]
    ds_read_b64_tr_b16 v[104:105], v161 offset:128
    ds_read_b64_tr_b16 v[106:107], v161 offset:1408
    s_waitcnt lgkmcnt(9)
    v_mfma_f32_32x32x16_bf16 v[64:79], v[128:131], v[140:143], v[64:79]
    ds_read_b64_tr_b16 v[108:109], v161 offset:192
    ds_read_b64_tr_b16 v[110:111], v161 offset:1472
    s_waitcnt lgkmcnt(9)
    v_mfma_f32_32x32x16_bf16 v[80:95], v[132:135], v[140:143], v[80:95]
    ds_read_b64_tr_b16 v[112:113], v152 offset:0
    ds_read_b64_tr_b16 v[114:115], v153 offset:0
    s_waitcnt lgkmcnt(8)
    v_mfma_f32_32x32x16_bf16 v[16:31], v[96:99], v[136:139], v[16:31]
    ds_read_b128 v[140:143], v165 offset:8192
    ds_read_b64_tr_b16 v[116:117], v161 offset:5120
    ds_read_b64_tr_b16 v[118:119], v161 offset:6400
    s_waitcnt lgkmcnt(9)
    v_mfma_f32_32x32x16_bf16 v[32:47], v[100:103], v[136:139], v[32:47]
    ds_read_b64_tr_b16 v[120:121], v161 offset:5184
    ds_read_b64_tr_b16 v[122:123], v161 offset:6464
    s_waitcnt lgkmcnt(9)
    v_mfma_f32_32x32x16_bf16 v[48:63], v[104:107], v[136:139], v[48:63]
    ds_read_b64_tr_b16 v[124:125], v161 offset:5248
    ds_read_b64_tr_b16 v[126:127], v161 offset:6528
    s_waitcnt lgkmcnt(9)
    v_mfma_f32_32x32x16_bf16 v[64:79], v[108:111], v[136:139], v[64:79]
    ds_read_b64_tr_b16 v[128:129], v161 offset:5312
    ds_read_b64_tr_b16 v[130:131], v161 offset:6592
    s_waitcnt lgkmcnt(9)
    v_mfma_f32_32x32x16_bf16 v[80:95], v[112:115], v[136:139], v[80:95]
    ds_read_b64_tr_b16 v[132:133], v154 offset:0
    ds_read_b64_tr_b16 v[134:135], v155 offset:0
    s_waitcnt lgkmcnt(8)
    v_mfma_f32_32x32x16_bf16 v[16:31], v[116:119], v[140:143], v[16:31]
    ds_read_b128 v[136:139], v166 offset:8192
    ds_read_b64_tr_b16 v[96:97], v161 offset:10240
    ds_read_b64_tr_b16 v[98:99], v161 offset:11520
    s_waitcnt lgkmcnt(9)
    v_mfma_f32_32x32x16_bf16 v[32:47], v[120:123], v[140:143], v[32:47]
    ds_read_b64_tr_b16 v[100:101], v161 offset:10304
    ds_read_b64_tr_b16 v[102:103], v161 offset:11584
    s_waitcnt lgkmcnt(9)
    v_mfma_f32_32x32x16_bf16 v[48:63], v[124:127], v[140:143], v[48:63]
    ds_read_b64_tr_b16 v[104:105], v161 offset:10368
    ds_read_b64_tr_b16 v[106:107], v161 offset:11648
    s_waitcnt lgkmcnt(9)
    v_mfma_f32_32x32x16_bf16 v[64:79], v[128:131], v[140:143], v[64:79]
    ds_read_b64_tr_b16 v[108:109], v161 offset:10432
    ds_read_b64_tr_b16 v[110:111], v161 offset:11712
    s_waitcnt lgkmcnt(9)
    v_mfma_f32_32x32x16_bf16 v[80:95], v[132:135], v[140:143], v[80:95]
    ds_read_b64_tr_b16 v[112:113], v156 offset:0
    ds_read_b64_tr_b16 v[114:115], v157 offset:0
    s_waitcnt lgkmcnt(8)
    v_mfma_f32_32x32x16_bf16 v[16:31], v[96:99], v[136:139], v[16:31]
    ds_read_b128 v[140:143], v167 offset:8192
    ds_read_b64_tr_b16 v[116:117], v161 offset:15360
    ds_read_b64_tr_b16 v[118:119], v161 offset:16640
    s_waitcnt lgkmcnt(9)
    v_mfma_f32_32x32x16_bf16 v[32:47], v[100:103], v[136:139], v[32:47]
    ds_read_b64_tr_b16 v[120:121], v161 offset:15424
    ds_read_b64_tr_b16 v[122:123], v161 offset:16704
    s_waitcnt lgkmcnt(9)
    v_mfma_f32_32x32x16_bf16 v[48:63], v[104:107], v[136:139], v[48:63]
    ds_read_b64_tr_b16 v[124:125], v161 offset:15488
    ds_read_b64_tr_b16 v[126:127], v161 offset:16768
    s_waitcnt lgkmcnt(9)
    v_mfma_f32_32x32x16_bf16 v[64:79], v[108:111], v[136:139], v[64:79]
    ds_read_b64_tr_b16 v[128:129], v161 offset:15552
    ds_read_b64_tr_b16 v[130:131], v161 offset:16832
    s_waitcnt lgkmcnt(9)
    v_mfma_f32_32x32x16_bf16 v[80:95], v[112:115], v[136:139], v[80:95]
    ds_read_b64_tr_b16 v[132:133], v158 offset:0
    ds_read_b64_tr_b16 v[134:135], v159 offset:0
    s_barrier
    s_waitcnt lgkmcnt(8)
    v_mfma_f32_32x32x16_bf16 v[16:31], v[116:119], v[140:143], v[16:31]
    ds_read_b128 v[136:139], v164 offset:12288
    ds_read_b64_tr_b16 v[96:97], v161 offset:23040
    ds_read_b64_tr_b16 v[98:99], v161 offset:24320
    s_waitcnt lgkmcnt(9)
    v_mfma_f32_32x32x16_bf16 v[32:47], v[120:123], v[140:143], v[32:47]
    ds_read_b64_tr_b16 v[100:101], v161 offset:23104
    ds_read_b64_tr_b16 v[102:103], v161 offset:24384
    s_waitcnt lgkmcnt(9)
    v_mfma_f32_32x32x16_bf16 v[48:63], v[124:127], v[140:143], v[48:63]
    ds_read_b64_tr_b16 v[104:105], v161 offset:23168
    ds_read_b64_tr_b16 v[106:107], v161 offset:24448
    s_waitcnt lgkmcnt(9)
    v_mfma_f32_32x32x16_bf16 v[64:79], v[128:131], v[140:143], v[64:79]
    ds_read_b64_tr_b16 v[108:109], v161 offset:23232
    ds_read_b64_tr_b16 v[110:111], v161 offset:24512
    s_waitcnt lgkmcnt(9)
    v_mfma_f32_32x32x16_bf16 v[80:95], v[132:135], v[140:143], v[80:95]
    ds_read_b64_tr_b16 v[112:113], v152 offset:23040
    ds_read_b64_tr_b16 v[114:115], v153 offset:23040
    s_waitcnt lgkmcnt(8)
    v_mfma_f32_32x32x16_bf16 v[16:31], v[96:99], v[136:139], v[16:31]
    ds_read_b128 v[140:143], v165 offset:12288
    ds_read_b64_tr_b16 v[116:117], v161 offset:28160
    ds_read_b64_tr_b16 v[118:119], v161 offset:29440
    s_waitcnt lgkmcnt(9)
    v_mfma_f32_32x32x16_bf16 v[32:47], v[100:103], v[136:139], v[32:47]
    ds_read_b64_tr_b16 v[120:121], v161 offset:28224
    ds_read_b64_tr_b16 v[122:123], v161 offset:29504
    s_waitcnt lgkmcnt(9)
    v_mfma_f32_32x32x16_bf16 v[48:63], v[104:107], v[136:139], v[48:63]
    ds_read_b64_tr_b16 v[124:125], v161 offset:28288
    ds_read_b64_tr_b16 v[126:127], v161 offset:29568
    s_waitcnt lgkmcnt(9)
    v_mfma_f32_32x32x16_bf16 v[64:79], v[108:111], v[136:139], v[64:79]
    ds_read_b64_tr_b16 v[128:129], v161 offset:28352
    ds_read_b64_tr_b16 v[130:131], v161 offset:29632
    s_waitcnt lgkmcnt(9)
    v_mfma_f32_32x32x16_bf16 v[80:95], v[112:115], v[136:139], v[80:95]
    ds_read_b64_tr_b16 v[132:133], v154 offset:23040
    ds_read_b64_tr_b16 v[134:135], v155 offset:23040
    s_waitcnt lgkmcnt(8)
    v_mfma_f32_32x32x16_bf16 v[16:31], v[116:119], v[140:143], v[16:31]
    ds_read_b128 v[136:139], v166 offset:12288
    ds_read_b64_tr_b16 v[96:97], v161 offset:33280
    ds_read_b64_tr_b16 v[98:99], v161 offset:34560
    s_waitcnt lgkmcnt(9)
    v_mfma_f32_32x32x16_bf16 v[32:47], v[120:123], v[140:143], v[32:47]
    ds_read_b64_tr_b16 v[100:101], v161 offset:33344
    ds_read_b64_tr_b16 v[102:103], v161 offset:34624
    s_waitcnt lgkmcnt(9)
    v_mfma_f32_32x32x16_bf16 v[48:63], v[124:127], v[140:143], v[48:63]
    ds_read_b64_tr_b16 v[104:105], v161 offset:33408
    ds_read_b64_tr_b16 v[106:107], v161 offset:34688
    s_waitcnt lgkmcnt(9)
    v_mfma_f32_32x32x16_bf16 v[64:79], v[128:131], v[140:143], v[64:79]
    ds_read_b64_tr_b16 v[108:109], v161 offset:33472
    ds_read_b64_tr_b16 v[110:111], v161 offset:34752
    s_waitcnt lgkmcnt(9)
    v_mfma_f32_32x32x16_bf16 v[80:95], v[132:135], v[140:143], v[80:95]
    ds_read_b64_tr_b16 v[112:113], v156 offset:23040
    ds_read_b64_tr_b16 v[114:115], v157 offset:23040
    s_waitcnt lgkmcnt(8)
    v_mfma_f32_32x32x16_bf16 v[16:31], v[96:99], v[136:139], v[16:31]
    ds_read_b128 v[140:143], v167 offset:12288
    ds_read_b64_tr_b16 v[116:117], v161 offset:38400
    ds_read_b64_tr_b16 v[118:119], v161 offset:39680
    s_waitcnt lgkmcnt(9)
    v_mfma_f32_32x32x16_bf16 v[32:47], v[100:103], v[136:139], v[32:47]
    ds_read_b64_tr_b16 v[120:121], v161 offset:38464
    ds_read_b64_tr_b16 v[122:123], v161 offset:39744
    s_waitcnt lgkmcnt(9)
    v_mfma_f32_32x32x16_bf16 v[48:63], v[104:107], v[136:139], v[48:63]
    ds_read_b64_tr_b16 v[124:125], v161 offset:38528
    ds_read_b64_tr_b16 v[126:127], v161 offset:39808
    s_waitcnt lgkmcnt(9)
    v_mfma_f32_32x32x16_bf16 v[64:79], v[108:111], v[136:139], v[64:79]
    ds_read_b64_tr_b16 v[128:129], v161 offset:38592
    ds_read_b64_tr_b16 v[130:131], v161 offset:39872
    s_waitcnt lgkmcnt(9)
    v_mfma_f32_32x32x16_bf16 v[80:95], v[112:115], v[136:139], v[80:95]
    ds_read_b64_tr_b16 v[132:133], v158 offset:23040
    ds_read_b64_tr_b16 v[134:135], v159 offset:23040
    s_barrier
    s_waitcnt lgkmcnt(8)
    v_mfma_f32_32x32x16_bf16 v[16:31], v[116:119], v[140:143], v[16:31]
    ds_read_b128 v[136:139], v164 offset:0
    ds_read_b64_tr_b16 v[96:97], v160 offset:0
    ds_read_b64_tr_b16 v[98:99], v160 offset:1280
    s_waitcnt lgkmcnt(9)
    v_mfma_f32_32x32x16_bf16 v[32:47], v[120:123], v[140:143], v[32:47]
    ds_read_b64_tr_b16 v[100:101], v160 offset:64
    ds_read_b64_tr_b16 v[102:103], v160 offset:1344
    s_waitcnt lgkmcnt(9)
    v_mfma_f32_32x32x16_bf16 v[48:63], v[124:127], v[140:143], v[48:63]
    ds_read_b64_tr_b16 v[104:105], v160 offset:128
    ds_read_b64_tr_b16 v[106:107], v160 offset:1408
    s_waitcnt lgkmcnt(9)
    v_mfma_f32_32x32x16_bf16 v[64:79], v[128:131], v[140:143], v[64:79]
    ds_read_b64_tr_b16 v[108:109], v160 offset:192
    ds_read_b64_tr_b16 v[110:111], v160 offset:1472
    s_waitcnt lgkmcnt(9)
    v_mfma_f32_32x32x16_bf16 v[80:95], v[132:135], v[140:143], v[80:95]
    ds_read_b64_tr_b16 v[112:113], v144 offset:0
    ds_read_b64_tr_b16 v[114:115], v145 offset:0
    s_waitcnt lgkmcnt(8)
    v_mfma_f32_32x32x16_bf16 v[16:31], v[96:99], v[136:139], v[16:31]
    ds_read_b128 v[140:143], v165 offset:0
    ds_read_b64_tr_b16 v[116:117], v160 offset:5120
    ds_read_b64_tr_b16 v[118:119], v160 offset:6400
    s_waitcnt lgkmcnt(9)
    v_mfma_f32_32x32x16_bf16 v[32:47], v[100:103], v[136:139], v[32:47]
    ds_read_b64_tr_b16 v[120:121], v160 offset:5184
    ds_read_b64_tr_b16 v[122:123], v160 offset:6464
    s_waitcnt lgkmcnt(9)
    v_mfma_f32_32x32x16_bf16 v[48:63], v[104:107], v[136:139], v[48:63]
    ds_read_b64_tr_b16 v[124:125], v160 offset:5248
    ds_read_b64_tr_b16 v[126:127], v160 offset:6528
    s_waitcnt lgkmcnt(9)
    v_mfma_f32_32x32x16_bf16 v[64:79], v[108:111], v[136:139], v[64:79]
    ds_read_b64_tr_b16 v[128:129], v160 offset:5312
    ds_read_b64_tr_b16 v[130:131], v160 offset:6592
    s_waitcnt lgkmcnt(9)
    v_mfma_f32_32x32x16_bf16 v[80:95], v[112:115], v[136:139], v[80:95]
    ds_read_b64_tr_b16 v[132:133], v146 offset:0
    ds_read_b64_tr_b16 v[134:135], v147 offset:0
    s_waitcnt lgkmcnt(8)
    v_mfma_f32_32x32x16_bf16 v[16:31], v[116:119], v[140:143], v[16:31]
    ds_read_b128 v[136:139], v166 offset:0
    ds_read_b64_tr_b16 v[96:97], v160 offset:10240
    ds_read_b64_tr_b16 v[98:99], v160 offset:11520
    s_waitcnt lgkmcnt(9)
    v_mfma_f32_32x32x16_bf16 v[32:47], v[120:123], v[140:143], v[32:47]
    ds_read_b64_tr_b16 v[100:101], v160 offset:10304
    ds_read_b64_tr_b16 v[102:103], v160 offset:11584
    s_waitcnt lgkmcnt(9)
    v_mfma_f32_32x32x16_bf16 v[48:63], v[124:127], v[140:143], v[48:63]
    ds_read_b64_tr_b16 v[104:105], v160 offset:10368
    ds_read_b64_tr_b16 v[106:107], v160 offset:11648
    s_waitcnt lgkmcnt(9)
    v_mfma_f32_32x32x16_bf16 v[64:79], v[128:131], v[140:143], v[64:79]
    ds_read_b64_tr_b16 v[108:109], v160 offset:10432
    ds_read_b64_tr_b16 v[110:111], v160 offset:11712
    s_waitcnt lgkmcnt(9)
    v_mfma_f32_32x32x16_bf16 v[80:95], v[132:135], v[140:143], v[80:95]
    ds_read_b64_tr_b16 v[112:113], v148 offset:0
    ds_read_b64_tr_b16 v[114:115], v149 offset:0
    s_waitcnt lgkmcnt(8)
    v_mfma_f32_32x32x16_bf16 v[16:31], v[96:99], v[136:139], v[16:31]
    ds_read_b128 v[140:143], v167 offset:0
    ds_read_b64_tr_b16 v[116:117], v160 offset:15360
    ds_read_b64_tr_b16 v[118:119], v160 offset:16640
    s_waitcnt lgkmcnt(9)
    v_mfma_f32_32x32x16_bf16 v[32:47], v[100:103], v[136:139], v[32:47]
    ds_read_b64_tr_b16 v[120:121], v160 offset:15424
    ds_read_b64_tr_b16 v[122:123], v160 offset:16704
    s_waitcnt lgkmcnt(9)
    v_mfma_f32_32x32x16_bf16 v[48:63], v[104:107], v[136:139], v[48:63]
    ds_read_b64_tr_b16 v[124:125], v160 offset:15488
    ds_read_b64_tr_b16 v[126:127], v160 offset:16768
    s_waitcnt lgkmcnt(9)
    v_mfma_f32_32x32x16_bf16 v[64:79], v[108:111], v[136:139], v[64:79]
    ds_read_b64_tr_b16 v[128:129], v160 offset:15552
    ds_read_b64_tr_b16 v[130:131], v160 offset:16832
    s_waitcnt lgkmcnt(9)
    v_mfma_f32_32x32x16_bf16 v[80:95], v[112:115], v[136:139], v[80:95]
    ds_read_b64_tr_b16 v[132:133], v150 offset:0
    ds_read_b64_tr_b16 v[134:135], v151 offset:0
    s_barrier
    s_waitcnt lgkmcnt(8)
    v_mfma_f32_32x32x16_bf16 v[16:31], v[116:119], v[140:143], v[16:31]
    ds_read_b128 v[136:139], v164 offset:4096
    ds_read_b64_tr_b16 v[96:97], v160 offset:23040
    ds_read_b64_tr_b16 v[98:99], v160 offset:24320
    s_waitcnt lgkmcnt(9)
    v_mfma_f32_32x32x16_bf16 v[32:47], v[120:123], v[140:143], v[32:47]
    ds_read_b64_tr_b16 v[100:101], v160 offset:23104
    ds_read_b64_tr_b16 v[102:103], v160 offset:24384
    s_waitcnt lgkmcnt(9)
    v_mfma_f32_32x32x16_bf16 v[48:63], v[124:127], v[140:143], v[48:63]
    ds_read_b64_tr_b16 v[104:105], v160 offset:23168
    ds_read_b64_tr_b16 v[106:107], v160 offset:24448
    s_waitcnt lgkmcnt(9)
    v_mfma_f32_32x32x16_bf16 v[64:79], v[128:131], v[140:143], v[64:79]
    ds_read_b64_tr_b16 v[108:109], v160 offset:23232
    ds_read_b64_tr_b16 v[110:111], v160 offset:24512
    s_waitcnt lgkmcnt(9)
    v_mfma_f32_32x32x16_bf16 v[80:95], v[132:135], v[140:143], v[80:95]
    ds_read_b64_tr_b16 v[112:113], v144 offset:23040
    ds_read_b64_tr_b16 v[114:115], v145 offset:23040
    s_waitcnt lgkmcnt(8)
    v_mfma_f32_32x32x16_bf16 v[16:31], v[96:99], v[136:139], v[16:31]
    ds_read_b128 v[140:143], v165 offset:4096
    ds_read_b64_tr_b16 v[116:117], v160 offset:28160
    ds_read_b64_tr_b16 v[118:119], v160 offset:29440
    s_waitcnt lgkmcnt(9)
    v_mfma_f32_32x32x16_bf16 v[32:47], v[100:103], v[136:139], v[32:47]
    ds_read_b64_tr_b16 v[120:121], v160 offset:28224
    ds_read_b64_tr_b16 v[122:123], v160 offset:29504
    s_waitcnt lgkmcnt(9)
    v_mfma_f32_32x32x16_bf16 v[48:63], v[104:107], v[136:139], v[48:63]
    ds_read_b64_tr_b16 v[124:125], v160 offset:28288
    ds_read_b64_tr_b16 v[126:127], v160 offset:29568
    s_waitcnt lgkmcnt(9)
    v_mfma_f32_32x32x16_bf16 v[64:79], v[108:111], v[136:139], v[64:79]
    ds_read_b64_tr_b16 v[128:129], v160 offset:28352
    ds_read_b64_tr_b16 v[130:131], v160 offset:29632
    s_waitcnt lgkmcnt(9)
    v_mfma_f32_32x32x16_bf16 v[80:95], v[112:115], v[136:139], v[80:95]
    ds_read_b64_tr_b16 v[132:133], v146 offset:23040
    ds_read_b64_tr_b16 v[134:135], v147 offset:23040
    s_waitcnt lgkmcnt(8)
    v_mfma_f32_32x32x16_bf16 v[16:31], v[116:119], v[140:143], v[16:31]
    ds_read_b128 v[136:139], v166 offset:4096
    ds_read_b64_tr_b16 v[96:97], v160 offset:33280
    ds_read_b64_tr_b16 v[98:99], v160 offset:34560
    s_waitcnt lgkmcnt(9)
    v_mfma_f32_32x32x16_bf16 v[32:47], v[120:123], v[140:143], v[32:47]
    ds_read_b64_tr_b16 v[100:101], v160 offset:33344
    ds_read_b64_tr_b16 v[102:103], v160 offset:34624
    s_waitcnt lgkmcnt(9)
    v_mfma_f32_32x32x16_bf16 v[48:63], v[124:127], v[140:143], v[48:63]
    ds_read_b64_tr_b16 v[104:105], v160 offset:33408
    ds_read_b64_tr_b16 v[106:107], v160 offset:34688
    s_waitcnt lgkmcnt(9)
    v_mfma_f32_32x32x16_bf16 v[64:79], v[128:131], v[140:143], v[64:79]
    ds_read_b64_tr_b16 v[108:109], v160 offset:33472
    ds_read_b64_tr_b16 v[110:111], v160 offset:34752
    s_waitcnt lgkmcnt(9)
    v_mfma_f32_32x32x16_bf16 v[80:95], v[132:135], v[140:143], v[80:95]
    ds_read_b64_tr_b16 v[112:113], v148 offset:23040
    ds_read_b64_tr_b16 v[114:115], v149 offset:23040
    s_waitcnt lgkmcnt(8)
    v_mfma_f32_32x32x16_bf16 v[16:31], v[96:99], v[136:139], v[16:31]
    ds_read_b128 v[140:143], v167 offset:4096
    ds_read_b64_tr_b16 v[116:117], v160 offset:38400
    ds_read_b64_tr_b16 v[118:119], v160 offset:39680
    s_waitcnt lgkmcnt(9)
    v_mfma_f32_32x32x16_bf16 v[32:47], v[100:103], v[136:139], v[32:47]
    ds_read_b64_tr_b16 v[120:121], v160 offset:38464
    ds_read_b64_tr_b16 v[122:123], v160 offset:39744
    s_waitcnt lgkmcnt(9)
    v_mfma_f32_32x32x16_bf16 v[48:63], v[104:107], v[136:139], v[48:63]
    ds_read_b64_tr_b16 v[124:125], v160 offset:38528
    ds_read_b64_tr_b16 v[126:127], v160 offset:39808
    s_waitcnt lgkmcnt(9)
    v_mfma_f32_32x32x16_bf16 v[64:79], v[108:111], v[136:139], v[64:79]
    ds_read_b64_tr_b16 v[128:129], v160 offset:38592
    ds_read_b64_tr_b16 v[130:131], v160 offset:39872
    s_waitcnt lgkmcnt(9)
    v_mfma_f32_32x32x16_bf16 v[80:95], v[112:115], v[136:139], v[80:95]
    ds_read_b64_tr_b16 v[132:133], v150 offset:23040
    ds_read_b64_tr_b16 v[134:135], v151 offset:23040
    s_barrier
    s_waitcnt lgkmcnt(8)
    v_mfma_f32_32x32x16_bf16 v[16:31], v[116:119], v[140:143], v[16:31]
    ds_read_b128 v[136:139], v164 offset:8192
    ds_read_b64_tr_b16 v[96:97], v161 offset:0
    ds_read_b64_tr_b16 v[98:99], v161 offset:1280
    s_waitcnt lgkmcnt(9)
    v_mfma_f32_32x32x16_bf16 v[32:47], v[120:123], v[140:143], v[32:47]
    ds_read_b64_tr_b16 v[100:101], v161 offset:64
    ds_read_b64_tr_b16 v[102:103], v161 offset:1344
    s_waitcnt lgkmcnt(9)
    v_mfma_f32_32x32x16_bf16 v[48:63], v[124:127], v[140:143], v[48:63]
    ds_read_b64_tr_b16 v[104:105], v161 offset:128
    ds_read_b64_tr_b16 v[106:107], v161 offset:1408
    s_waitcnt lgkmcnt(9)
    v_mfma_f32_32x32x16_bf16 v[64:79], v[128:131], v[140:143], v[64:79]
    ds_read_b64_tr_b16 v[108:109], v161 offset:192
    ds_read_b64_tr_b16 v[110:111], v161 offset:1472
    s_waitcnt lgkmcnt(9)
    v_mfma_f32_32x32x16_bf16 v[80:95], v[132:135], v[140:143], v[80:95]
    ds_read_b64_tr_b16 v[112:113], v152 offset:0
    ds_read_b64_tr_b16 v[114:115], v153 offset:0
    s_waitcnt lgkmcnt(8)
    v_mfma_f32_32x32x16_bf16 v[16:31], v[96:99], v[136:139], v[16:31]
    ds_read_b128 v[140:143], v165 offset:8192
    ds_read_b64_tr_b16 v[116:117], v161 offset:5120
    ds_read_b64_tr_b16 v[118:119], v161 offset:6400
    s_waitcnt lgkmcnt(9)
    v_mfma_f32_32x32x16_bf16 v[32:47], v[100:103], v[136:139], v[32:47]
    ds_read_b64_tr_b16 v[120:121], v161 offset:5184
    ds_read_b64_tr_b16 v[122:123], v161 offset:6464
    s_waitcnt lgkmcnt(9)
    v_mfma_f32_32x32x16_bf16 v[48:63], v[104:107], v[136:139], v[48:63]
    ds_read_b64_tr_b16 v[124:125], v161 offset:5248
    ds_read_b64_tr_b16 v[126:127], v161 offset:6528
    s_waitcnt lgkmcnt(9)
    v_mfma_f32_32x32x16_bf16 v[64:79], v[108:111], v[136:139], v[64:79]
    ds_read_b64_tr_b16 v[128:129], v161 offset:5312
    ds_read_b64_tr_b16 v[130:131], v161 offset:6592
    s_waitcnt lgkmcnt(9)
    v_mfma_f32_32x32x16_bf16 v[80:95], v[112:115], v[136:139], v[80:95]
    ds_read_b64_tr_b16 v[132:133], v154 offset:0
    ds_read_b64_tr_b16 v[134:135], v155 offset:0
    s_waitcnt lgkmcnt(8)
    v_mfma_f32_32x32x16_bf16 v[16:31], v[116:119], v[140:143], v[16:31]
    ds_read_b128 v[136:139], v166 offset:8192
    ds_read_b64_tr_b16 v[96:97], v161 offset:10240
    ds_read_b64_tr_b16 v[98:99], v161 offset:11520
    s_waitcnt lgkmcnt(9)
    v_mfma_f32_32x32x16_bf16 v[32:47], v[120:123], v[140:143], v[32:47]
    ds_read_b64_tr_b16 v[100:101], v161 offset:10304
    ds_read_b64_tr_b16 v[102:103], v161 offset:11584
    s_waitcnt lgkmcnt(9)
    v_mfma_f32_32x32x16_bf16 v[48:63], v[124:127], v[140:143], v[48:63]
    ds_read_b64_tr_b16 v[104:105], v161 offset:10368
    ds_read_b64_tr_b16 v[106:107], v161 offset:11648
    s_waitcnt lgkmcnt(9)
    v_mfma_f32_32x32x16_bf16 v[64:79], v[128:131], v[140:143], v[64:79]
    ds_read_b64_tr_b16 v[108:109], v161 offset:10432
    ds_read_b64_tr_b16 v[110:111], v161 offset:11712
    s_waitcnt lgkmcnt(9)
    v_mfma_f32_32x32x16_bf16 v[80:95], v[132:135], v[140:143], v[80:95]
    ds_read_b64_tr_b16 v[112:113], v156 offset:0
    ds_read_b64_tr_b16 v[114:115], v157 offset:0
    s_waitcnt lgkmcnt(8)
    v_mfma_f32_32x32x16_bf16 v[16:31], v[96:99], v[136:139], v[16:31]
    ds_read_b128 v[140:143], v167 offset:8192
    ds_read_b64_tr_b16 v[116:117], v161 offset:15360
    ds_read_b64_tr_b16 v[118:119], v161 offset:16640
    s_waitcnt lgkmcnt(9)
    v_mfma_f32_32x32x16_bf16 v[32:47], v[100:103], v[136:139], v[32:47]
    ds_read_b64_tr_b16 v[120:121], v161 offset:15424
    ds_read_b64_tr_b16 v[122:123], v161 offset:16704
    s_waitcnt lgkmcnt(9)
    v_mfma_f32_32x32x16_bf16 v[48:63], v[104:107], v[136:139], v[48:63]
    ds_read_b64_tr_b16 v[124:125], v161 offset:15488
    ds_read_b64_tr_b16 v[126:127], v161 offset:16768
    s_waitcnt lgkmcnt(9)
    v_mfma_f32_32x32x16_bf16 v[64:79], v[108:111], v[136:139], v[64:79]
    ds_read_b64_tr_b16 v[128:129], v161 offset:15552
    ds_read_b64_tr_b16 v[130:131], v161 offset:16832
    s_waitcnt lgkmcnt(9)
    v_mfma_f32_32x32x16_bf16 v[80:95], v[112:115], v[136:139], v[80:95]
    ds_read_b64_tr_b16 v[132:133], v158 offset:0
    ds_read_b64_tr_b16 v[134:135], v159 offset:0
    s_barrier
    s_waitcnt lgkmcnt(8)
    v_mfma_f32_32x32x16_bf16 v[16:31], v[116:119], v[140:143], v[16:31]
    ds_read_b128 v[136:139], v164 offset:12288
    ds_read_b64_tr_b16 v[96:97], v161 offset:23040
    ds_read_b64_tr_b16 v[98:99], v161 offset:24320
    s_waitcnt lgkmcnt(9)
    v_mfma_f32_32x32x16_bf16 v[32:47], v[120:123], v[140:143], v[32:47]
    ds_read_b64_tr_b16 v[100:101], v161 offset:23104
    ds_read_b64_tr_b16 v[102:103], v161 offset:24384
    s_waitcnt lgkmcnt(9)
    v_mfma_f32_32x32x16_bf16 v[48:63], v[124:127], v[140:143], v[48:63]
    ds_read_b64_tr_b16 v[104:105], v161 offset:23168
    ds_read_b64_tr_b16 v[106:107], v161 offset:24448
    s_waitcnt lgkmcnt(9)
    v_mfma_f32_32x32x16_bf16 v[64:79], v[128:131], v[140:143], v[64:79]
    ds_read_b64_tr_b16 v[108:109], v161 offset:23232
    ds_read_b64_tr_b16 v[110:111], v161 offset:24512
    s_waitcnt lgkmcnt(9)
    v_mfma_f32_32x32x16_bf16 v[80:95], v[132:135], v[140:143], v[80:95]
    ds_read_b64_tr_b16 v[112:113], v152 offset:23040
    ds_read_b64_tr_b16 v[114:115], v153 offset:23040
    s_waitcnt lgkmcnt(8)
    v_mfma_f32_32x32x16_bf16 v[16:31], v[96:99], v[136:139], v[16:31]
    ds_read_b128 v[140:143], v165 offset:12288
    ds_read_b64_tr_b16 v[116:117], v161 offset:28160
    ds_read_b64_tr_b16 v[118:119], v161 offset:29440
    s_waitcnt lgkmcnt(9)
    v_mfma_f32_32x32x16_bf16 v[32:47], v[100:103], v[136:139], v[32:47]
    ds_read_b64_tr_b16 v[120:121], v161 offset:28224
    ds_read_b64_tr_b16 v[122:123], v161 offset:29504
    s_waitcnt lgkmcnt(9)
    v_mfma_f32_32x32x16_bf16 v[48:63], v[104:107], v[136:139], v[48:63]
    ds_read_b64_tr_b16 v[124:125], v161 offset:28288
    ds_read_b64_tr_b16 v[126:127], v161 offset:29568
    s_waitcnt lgkmcnt(9)
    v_mfma_f32_32x32x16_bf16 v[64:79], v[108:111], v[136:139], v[64:79]
    ds_read_b64_tr_b16 v[128:129], v161 offset:28352
    ds_read_b64_tr_b16 v[130:131], v161 offset:29632
    s_waitcnt lgkmcnt(9)
    v_mfma_f32_32x32x16_bf16 v[80:95], v[112:115], v[136:139], v[80:95]
    ds_read_b64_tr_b16 v[132:133], v154 offset:23040
    ds_read_b64_tr_b16 v[134:135], v155 offset:23040
    s_waitcnt lgkmcnt(8)
    v_mfma_f32_32x32x16_bf16 v[16:31], v[116:119], v[140:143], v[16:31]
    ds_read_b128 v[136:139], v166 offset:12288
    ds_read_b64_tr_b16 v[96:97], v161 offset:33280
    ds_read_b64_tr_b16 v[98:99], v161 offset:34560
    s_waitcnt lgkmcnt(9)
    v_mfma_f32_32x32x16_bf16 v[32:47], v[120:123], v[140:143], v[32:47]
    ds_read_b64_tr_b16 v[100:101], v161 offset:33344
    ds_read_b64_tr_b16 v[102:103], v161 offset:34624
    s_waitcnt lgkmcnt(9)
    v_mfma_f32_32x32x16_bf16 v[48:63], v[124:127], v[140:143], v[48:63]
    ds_read_b64_tr_b16 v[104:105], v161 offset:33408
    ds_read_b64_tr_b16 v[106:107], v161 offset:34688
    s_waitcnt lgkmcnt(9)
    v_mfma_f32_32x32x16_bf16 v[64:79], v[128:131], v[140:143], v[64:79]
    ds_read_b64_tr_b16 v[108:109], v161 offset:33472
    ds_read_b64_tr_b16 v[110:111], v161 offset:34752
    s_waitcnt lgkmcnt(9)
    v_mfma_f32_32x32x16_bf16 v[80:95], v[132:135], v[140:143], v[80:95]
    ds_read_b64_tr_b16 v[112:113], v156 offset:23040
    ds_read_b64_tr_b16 v[114:115], v157 offset:23040
    s_waitcnt lgkmcnt(8)
    v_mfma_f32_32x32x16_bf16 v[16:31], v[96:99], v[136:139], v[16:31]
    ds_read_b128 v[140:143], v167 offset:12288
    ds_read_b64_tr_b16 v[116:117], v161 offset:38400
    ds_read_b64_tr_b16 v[118:119], v161 offset:39680
    s_waitcnt lgkmcnt(9)
    v_mfma_f32_32x32x16_bf16 v[32:47], v[100:103], v[136:139], v[32:47]
    ds_read_b64_tr_b16 v[120:121], v161 offset:38464
    ds_read_b64_tr_b16 v[122:123], v161 offset:39744
    s_waitcnt lgkmcnt(9)
    v_mfma_f32_32x32x16_bf16 v[48:63], v[104:107], v[136:139], v[48:63]
    ds_read_b64_tr_b16 v[124:125], v161 offset:38528
    ds_read_b64_tr_b16 v[126:127], v161 offset:39808
    s_waitcnt lgkmcnt(9)
    v_mfma_f32_32x32x16_bf16 v[64:79], v[108:111], v[136:139], v[64:79]
    ds_read_b64_tr_b16 v[128:129], v161 offset:38592
    ds_read_b64_tr_b16 v[130:131], v161 offset:39872
    s_waitcnt lgkmcnt(9)
    v_mfma_f32_32x32x16_bf16 v[80:95], v[112:115], v[136:139], v[80:95]
    ds_read_b64_tr_b16 v[132:133], v158 offset:23040
    ds_read_b64_tr_b16 v[134:135], v159 offset:23040
    s_barrier
    s_waitcnt lgkmcnt(8)
    v_mfma_f32_32x32x16_bf16 v[16:31], v[116:119], v[140:143], v[16:31]
    ds_read_b128 v[136:139], v164 offset:0
    ds_read_b64_tr_b16 v[96:97], v160 offset:0
    ds_read_b64_tr_b16 v[98:99], v160 offset:1280
    s_waitcnt lgkmcnt(9)
    v_mfma_f32_32x32x16_bf16 v[32:47], v[120:123], v[140:143], v[32:47]
    ds_read_b64_tr_b16 v[100:101], v160 offset:64
    ds_read_b64_tr_b16 v[102:103], v160 offset:1344
    s_waitcnt lgkmcnt(9)
    v_mfma_f32_32x32x16_bf16 v[48:63], v[124:127], v[140:143], v[48:63]
    ds_read_b64_tr_b16 v[104:105], v160 offset:128
    ds_read_b64_tr_b16 v[106:107], v160 offset:1408
    s_waitcnt lgkmcnt(9)
    v_mfma_f32_32x32x16_bf16 v[64:79], v[128:131], v[140:143], v[64:79]
    ds_read_b64_tr_b16 v[108:109], v160 offset:192
    ds_read_b64_tr_b16 v[110:111], v160 offset:1472
    s_waitcnt lgkmcnt(9)
    v_mfma_f32_32x32x16_bf16 v[80:95], v[132:135], v[140:143], v[80:95]
    ds_read_b64_tr_b16 v[112:113], v144 offset:0
    ds_read_b64_tr_b16 v[114:115], v145 offset:0
    s_waitcnt lgkmcnt(8)
    v_mfma_f32_32x32x16_bf16 v[16:31], v[96:99], v[136:139], v[16:31]
    ds_read_b128 v[140:143], v165 offset:0
    ds_read_b64_tr_b16 v[116:117], v160 offset:5120
    ds_read_b64_tr_b16 v[118:119], v160 offset:6400
    s_waitcnt lgkmcnt(9)
    v_mfma_f32_32x32x16_bf16 v[32:47], v[100:103], v[136:139], v[32:47]
    ds_read_b64_tr_b16 v[120:121], v160 offset:5184
    ds_read_b64_tr_b16 v[122:123], v160 offset:6464
    s_waitcnt lgkmcnt(9)
    v_mfma_f32_32x32x16_bf16 v[48:63], v[104:107], v[136:139], v[48:63]
    ds_read_b64_tr_b16 v[124:125], v160 offset:5248
    ds_read_b64_tr_b16 v[126:127], v160 offset:6528
    s_waitcnt lgkmcnt(9)
    v_mfma_f32_32x32x16_bf16 v[64:79], v[108:111], v[136:139], v[64:79]
    ds_read_b64_tr_b16 v[128:129], v160 offset:5312
    ds_read_b64_tr_b16 v[130:131], v160 offset:6592
    s_waitcnt lgkmcnt(9)
    v_mfma_f32_32x32x16_bf16 v[80:95], v[112:115], v[136:139], v[80:95]
    ds_read_b64_tr_b16 v[132:133], v146 offset:0
    ds_read_b64_tr_b16 v[134:135], v147 offset:0
    s_waitcnt lgkmcnt(8)
    v_mfma_f32_32x32x16_bf16 v[16:31], v[116:119], v[140:143], v[16:31]
    ds_read_b128 v[136:139], v166 offset:0
    ds_read_b64_tr_b16 v[96:97], v160 offset:10240
    ds_read_b64_tr_b16 v[98:99], v160 offset:11520
    s_waitcnt lgkmcnt(9)
    v_mfma_f32_32x32x16_bf16 v[32:47], v[120:123], v[140:143], v[32:47]
    ds_read_b64_tr_b16 v[100:101], v160 offset:10304
    ds_read_b64_tr_b16 v[102:103], v160 offset:11584
    s_waitcnt lgkmcnt(9)
    v_mfma_f32_32x32x16_bf16 v[48:63], v[124:127], v[140:143], v[48:63]
    ds_read_b64_tr_b16 v[104:105], v160 offset:10368
    ds_read_b64_tr_b16 v[106:107], v160 offset:11648
    s_waitcnt lgkmcnt(9)
    v_mfma_f32_32x32x16_bf16 v[64:79], v[128:131], v[140:143], v[64:79]
    ds_read_b64_tr_b16 v[108:109], v160 offset:10432
    ds_read_b64_tr_b16 v[110:111], v160 offset:11712
    s_waitcnt lgkmcnt(9)
    v_mfma_f32_32x32x16_bf16 v[80:95], v[132:135], v[140:143], v[80:95]
    ds_read_b64_tr_b16 v[112:113], v148 offset:0
    ds_read_b64_tr_b16 v[114:115], v149 offset:0
    s_waitcnt lgkmcnt(8)
    v_mfma_f32_32x32x16_bf16 v[16:31], v[96:99], v[136:139], v[16:31]
    ds_read_b128 v[140:143], v167 offset:0
    ds_read_b64_tr_b16 v[116:117], v160 offset:15360
    ds_read_b64_tr_b16 v[118:119], v160 offset:16640
    s_waitcnt lgkmcnt(9)
    v_mfma_f32_32x32x16_bf16 v[32:47], v[100:103], v[136:139], v[32:47]
    ds_read_b64_tr_b16 v[120:121], v160 offset:15424
    ds_read_b64_tr_b16 v[122:123], v160 offset:16704
    s_waitcnt lgkmcnt(9)
    v_mfma_f32_32x32x16_bf16 v[48:63], v[104:107], v[136:139], v[48:63]
    ds_read_b64_tr_b16 v[124:125], v160 offset:15488
    ds_read_b64_tr_b16 v[126:127], v160 offset:16768
    s_waitcnt lgkmcnt(9)
    v_mfma_f32_32x32x16_bf16 v[64:79], v[108:111], v[136:139], v[64:79]
    ds_read_b64_tr_b16 v[128:129], v160 offset:15552
    ds_read_b64_tr_b16 v[130:131], v160 offset:16832
    s_waitcnt lgkmcnt(9)
    v_mfma_f32_32x32x16_bf16 v[80:95], v[112:115], v[136:139], v[80:95]
    ds_read_b64_tr_b16 v[132:133], v150 offset:0
    ds_read_b64_tr_b16 v[134:135], v151 offset:0
    s_barrier
    s_waitcnt lgkmcnt(8)
    v_mfma_f32_32x32x16_bf16 v[16:31], v[116:119], v[140:143], v[16:31]
    ds_read_b128 v[136:139], v164 offset:4096
    ds_read_b64_tr_b16 v[96:97], v160 offset:23040
    ds_read_b64_tr_b16 v[98:99], v160 offset:24320
    s_waitcnt lgkmcnt(9)
    v_mfma_f32_32x32x16_bf16 v[32:47], v[120:123], v[140:143], v[32:47]
    ds_read_b64_tr_b16 v[100:101], v160 offset:23104
    ds_read_b64_tr_b16 v[102:103], v160 offset:24384
    s_waitcnt lgkmcnt(9)
    v_mfma_f32_32x32x16_bf16 v[48:63], v[124:127], v[140:143], v[48:63]
    ds_read_b64_tr_b16 v[104:105], v160 offset:23168
    ds_read_b64_tr_b16 v[106:107], v160 offset:24448
    s_waitcnt lgkmcnt(9)
    v_mfma_f32_32x32x16_bf16 v[64:79], v[128:131], v[140:143], v[64:79]
    ds_read_b64_tr_b16 v[108:109], v160 offset:23232
    ds_read_b64_tr_b16 v[110:111], v160 offset:24512
    s_waitcnt lgkmcnt(9)
    v_mfma_f32_32x32x16_bf16 v[80:95], v[132:135], v[140:143], v[80:95]
    ds_read_b64_tr_b16 v[112:113], v144 offset:23040
    ds_read_b64_tr_b16 v[114:115], v145 offset:23040
    s_waitcnt lgkmcnt(8)
    v_mfma_f32_32x32x16_bf16 v[16:31], v[96:99], v[136:139], v[16:31]
    ds_read_b128 v[140:143], v165 offset:4096
    ds_read_b64_tr_b16 v[116:117], v160 offset:28160
    ds_read_b64_tr_b16 v[118:119], v160 offset:29440
    s_waitcnt lgkmcnt(9)
    v_mfma_f32_32x32x16_bf16 v[32:47], v[100:103], v[136:139], v[32:47]
    ds_read_b64_tr_b16 v[120:121], v160 offset:28224
    ds_read_b64_tr_b16 v[122:123], v160 offset:29504
    s_waitcnt lgkmcnt(9)
    v_mfma_f32_32x32x16_bf16 v[48:63], v[104:107], v[136:139], v[48:63]
    ds_read_b64_tr_b16 v[124:125], v160 offset:28288
    ds_read_b64_tr_b16 v[126:127], v160 offset:29568
    s_waitcnt lgkmcnt(9)
    v_mfma_f32_32x32x16_bf16 v[64:79], v[108:111], v[136:139], v[64:79]
    ds_read_b64_tr_b16 v[128:129], v160 offset:28352
    ds_read_b64_tr_b16 v[130:131], v160 offset:29632
    s_waitcnt lgkmcnt(9)
    v_mfma_f32_32x32x16_bf16 v[80:95], v[112:115], v[136:139], v[80:95]
    ds_read_b64_tr_b16 v[132:133], v146 offset:23040
    ds_read_b64_tr_b16 v[134:135], v147 offset:23040
    s_waitcnt lgkmcnt(8)
    v_mfma_f32_32x32x16_bf16 v[16:31], v[116:119], v[140:143], v[16:31]
    ds_read_b128 v[136:139], v166 offset:4096
    ds_read_b64_tr_b16 v[96:97], v160 offset:33280
    ds_read_b64_tr_b16 v[98:99], v160 offset:34560
    s_waitcnt lgkmcnt(9)
    v_mfma_f32_32x32x16_bf16 v[32:47], v[120:123], v[140:143], v[32:47]
    ds_read_b64_tr_b16 v[100:101], v160 offset:33344
    ds_read_b64_tr_b16 v[102:103], v160 offset:34624
    s_waitcnt lgkmcnt(9)
    v_mfma_f32_32x32x16_bf16 v[48:63], v[124:127], v[140:143], v[48:63]
    ds_read_b64_tr_b16 v[104:105], v160 offset:33408
    ds_read_b64_tr_b16 v[106:107], v160 offset:34688
    s_waitcnt lgkmcnt(9)
    v_mfma_f32_32x32x16_bf16 v[64:79], v[128:131], v[140:143], v[64:79]
    ds_read_b64_tr_b16 v[108:109], v160 offset:33472
    ds_read_b64_tr_b16 v[110:111], v160 offset:34752
    s_waitcnt lgkmcnt(9)
    v_mfma_f32_32x32x16_bf16 v[80:95], v[132:135], v[140:143], v[80:95]
    ds_read_b64_tr_b16 v[112:113], v148 offset:23040
    ds_read_b64_tr_b16 v[114:115], v149 offset:23040
    s_waitcnt lgkmcnt(8)
    v_mfma_f32_32x32x16_bf16 v[16:31], v[96:99], v[136:139], v[16:31]
    ds_read_b128 v[140:143], v167 offset:4096
    ds_read_b64_tr_b16 v[116:117], v160 offset:38400
    ds_read_b64_tr_b16 v[118:119], v160 offset:39680
    s_waitcnt lgkmcnt(9)
    v_mfma_f32_32x32x16_bf16 v[32:47], v[100:103], v[136:139], v[32:47]
    ds_read_b64_tr_b16 v[120:121], v160 offset:38464
    ds_read_b64_tr_b16 v[122:123], v160 offset:39744
    s_waitcnt lgkmcnt(9)
    v_mfma_f32_32x32x16_bf16 v[48:63], v[104:107], v[136:139], v[48:63]
    ds_read_b64_tr_b16 v[124:125], v160 offset:38528
    ds_read_b64_tr_b16 v[126:127], v160 offset:39808
    s_waitcnt lgkmcnt(9)
    v_mfma_f32_32x32x16_bf16 v[64:79], v[108:111], v[136:139], v[64:79]
    ds_read_b64_tr_b16 v[128:129], v160 offset:38592
    ds_read_b64_tr_b16 v[130:131], v160 offset:39872
    s_waitcnt lgkmcnt(9)
    v_mfma_f32_32x32x16_bf16 v[80:95], v[112:115], v[136:139], v[80:95]
    ds_read_b64_tr_b16 v[132:133], v150 offset:23040
    ds_read_b64_tr_b16 v[134:135], v151 offset:23040
    s_waitcnt lgkmcnt(8)
    v_mfma_f32_32x32x16_bf16 v[16:31], v[116:119], v[140:143], v[16:31]
    s_waitcnt lgkmcnt(6)
    v_mfma_f32_32x32x16_bf16 v[32:47], v[120:123], v[140:143], v[32:47]
    s_waitcnt lgkmcnt(4)
    v_mfma_f32_32x32x16_bf16 v[48:63], v[124:127], v[140:143], v[48:63]
    s_waitcnt lgkmcnt(2)
    v_mfma_f32_32x32x16_bf16 v[64:79], v[128:131], v[140:143], v[64:79]
    s_waitcnt lgkmcnt(0)
    v_mfma_f32_32x32x16_bf16 v[80:95], v[132:135], v[140:143], v[80:95]
    s_barrier
    s_nop 2
    s_cmp_ge_u32 s25, 10
    s_cbranch_scc1 K1_EPI_Z2
    s_cmp_gt_u32 s25, 7
    s_cbranch_scc1 K1_Z1
    s_mul_i32 s5, s27, 2560
    s_add_u32 s5, s5, 2621440
    v_and_b32 v8, 19, v2
    v_and_b32 v9, 4, v2
    v_lshl_or_b32 v8, v9, 1, v8
    v_bfe_u32 v9, v2, 3, 1
    v_lshl_or_b32 v8, v9, 2, v8
    v_mul_u32_u24 v14, 48, v2
    v_lshl_add_u32 v14, v3, 4, v14
    v_add_u32 v14, s53, v14
    v_lshrrev_b32 v13, 4, v1
    v_bfe_u32 v12, v1, 2, 2
    v_lshl_add_u32 v12, v13, 3, v12
    v_mul_u32_u24 v12, 48, v12
    v_and_b32 v11, 1, v1
    v_lshl_add_u32 v12, v11, 4, v12
    v_bfe_u32 v11, v1, 1, 1
    v_lshl_add_u32 v12, v11, 3, v12
    v_add_u32 v12, s53, v12
    v_mul_u32_u24 v11, 320, v13
    v_and_b32 v13, 15, v1
    v_lshl_add_u32 v11, v13, 4, v11
    v_cvt_pk_bf16_f32 v244, v88, v89
    v_cvt_pk_bf16_f32 v245, v90, v91
    v_cvt_pk_bf16_f32 v246, v92, v93
    v_cvt_pk_bf16_f32 v247, v94, v95
    s_cmp_ge_u32 s25, 6
    s_cbranch_scc1 K1_SPV
    s_cmp_eq_u32 s25, 5
    s_cbranch_scc1 K1_SP5
    v_lshl_add_u32 v9, v3, 5, v8
    v_lshlrev_b32 v9, 4, v9
    buffer_store_dwordx4 v[244:247], v9, s[32:35], s5 offen sc1
    s_branch K1_Z1
K1_SP5:
    v_lshlrev_b32 v9, 3, v8
    s_mov_b32 exec_hi, 0
    buffer_store_dwordx2 v[244:245], v9, s[32:35], s5 offen offset:1024 sc1
    s_mov_b64 exec, -1
    s_branch K1_Z1
K1_SPV:
    ds_write_b128 v14, v[244:247]
    ds_read_b64_tr_b16 v[248:249], v12
    ds_read_b64_tr_b16 v[250:251], v12 offset:192
    s_cmp_eq_u32 s25, 6
    s_cselect_b32 s6, 0, 256
    s_add_u32 s5, s5, s6
    s_cmp_eq_u32 s25, 6
    s_cselect_b32 exec_lo, -1, 0x000f000f
    s_mov_b32 exec_hi, exec_lo
    s_waitcnt lgkmcnt(0)
    buffer_store_dwordx4 v[248:251], v11, s[32:35], s5 offen offset:1280 sc1
    s_mov_b64 exec, -1
K1_Z1:
    s_mul_i32 s5, s27, 54
    s_sub_u32 s6, s25, 4
    s_mul_i32 s6, s6, 9
    s_add_u32 s5, s5, s6
    s_lshl_b32 s5, s5, 10
    s_add_u32 s5, s5, 3145728
    s_mov_b32 s97, s5
    v_mov_b32 v8, s99
    v_pk_mul_f32 v[220:221], v[16:17], v[16:17]
    v_pk_mul_f32 v[222:223], v[18:19], v[18:19]
    v_pk_mul_f32 v[224:225], v[20:21], v[20:21]
    v_pk_mul_f32 v[226:227], v[22:23], v[22:23]
    v_pk_fma_f32 v[220:221], v[220:221], v[182:183], v[180:181]
    v_pk_fma_f32 v[222:223], v[222:223], v[182:183], v[180:181]
    v_pk_fma_f32 v[224:225], v[224:225], v[182:183], v[180:181]
    v_pk_fma_f32 v[226:227], v[226:227], v[182:183], v[180:181]
    v_pk_mul_f32 v[220:221], v[220:221], v[16:17]
    v_pk_mul_f32 v[222:223], v[222:223], v[18:19]
    v_pk_mul_f32 v[224:225], v[224:225], v[20:21]
    v_pk_mul_f32 v[226:227], v[226:227], v[22:23]
    v_exp_f32 v220, v220
    v_exp_f32 v221, v221
    v_exp_f32 v222, v222
    v_exp_f32 v223, v223
    v_exp_f32 v224, v224
    v_exp_f32 v225, v225
    v_exp_f32 v226, v226
    v_exp_f32 v227, v227
    v_pk_add_f32 v[220:221], v[220:221], 1.0 op_sel_hi:[1,0]
    v_pk_add_f32 v[222:223], v[222:223], 1.0 op_sel_hi:[1,0]
    v_pk_add_f32 v[224:225], v[224:225], 1.0 op_sel_hi:[1,0]
    v_pk_add_f32 v[226:227], v[226:227], 1.0 op_sel_hi:[1,0]
    v_rcp_f32 v220, v220
    v_rcp_f32 v221, v221
    v_rcp_f32 v222, v222
    v_rcp_f32 v223, v223
    v_rcp_f32 v224, v224
    v_rcp_f32 v225, v225
    v_rcp_f32 v226, v226
    v_rcp_f32 v227, v227
    v_pk_mul_f32 v[16:17], v[16:17], v[220:221]
    v_pk_mul_f32 v[18:19], v[18:19], v[222:223]
    v_pk_mul_f32 v[20:21], v[20:21], v[224:225]
    v_pk_mul_f32 v[22:23], v[22:23], v[226:227]
    v_cvt_pk_bf16_f32 v128, v16, v17
    v_cvt_pk_bf16_f32 v129, v18, v19
    v_cvt_pk_bf16_f32 v130, v20, v21
    v_cvt_pk_bf16_f32 v131, v22, v23
    v_pk_mul_f32 v[220:221], v[24:25], v[24:25]
    v_pk_mul_f32 v[222:223], v[26:27], v[26:27]
    v_pk_mul_f32 v[224:225], v[28:29], v[28:29]
    v_pk_mul_f32 v[226:227], v[30:31], v[30:31]
    v_pk_fma_f32 v[220:221], v[220:221], v[182:183], v[180:181]
    v_pk_fma_f32 v[222:223], v[222:223], v[182:183], v[180:181]
    v_pk_fma_f32 v[224:225], v[224:225], v[182:183], v[180:181]
    v_pk_fma_f32 v[226:227], v[226:227], v[182:183], v[180:181]
    v_pk_mul_f32 v[220:221], v[220:221], v[24:25]
    v_pk_mul_f32 v[222:223], v[222:223], v[26:27]
    v_pk_mul_f32 v[224:225], v[224:225], v[28:29]
    v_pk_mul_f32 v[226:227], v[226:227], v[30:31]
    v_exp_f32 v220, v220
    v_exp_f32 v221, v221
    v_exp_f32 v222, v222
    v_exp_f32 v223, v223
    v_exp_f32 v224, v224
    v_exp_f32 v225, v225
    v_exp_f32 v226, v226
    v_exp_f32 v227, v227
    v_pk_add_f32 v[220:221], v[220:221], 1.0 op_sel_hi:[1,0]
    v_pk_add_f32 v[222:223], v[222:223], 1.0 op_sel_hi:[1,0]
    v_pk_add_f32 v[224:225], v[224:225], 1.0 op_sel_hi:[1,0]
    v_pk_add_f32 v[226:227], v[226:227], 1.0 op_sel_hi:[1,0]
    v_rcp_f32 v220, v220
    v_rcp_f32 v221, v221
    v_rcp_f32 v222, v222
    v_rcp_f32 v223, v223
    v_rcp_f32 v224, v224
    v_rcp_f32 v225, v225
    v_rcp_f32 v226, v226
    v_rcp_f32 v227, v227
    v_pk_mul_f32 v[24:25], v[24:25], v[220:221]
    v_pk_mul_f32 v[26:27], v[26:27], v[222:223]
    v_pk_mul_f32 v[28:29], v[28:29], v[224:225]
    v_pk_mul_f32 v[30:31], v[30:31], v[226:227]
    v_cvt_pk_bf16_f32 v132, v24, v25
    v_cvt_pk_bf16_f32 v133, v26, v27
    v_cvt_pk_bf16_f32 v134, v28, v29
    v_cvt_pk_bf16_f32 v135, v30, v31
    v_pk_mul_f32 v[220:221], v[32:33], v[32:33]
    v_pk_mul_f32 v[222:223], v[34:35], v[34:35]
    v_pk_mul_f32 v[224:225], v[36:37], v[36:37]
    v_pk_mul_f32 v[226:227], v[38:39], v[38:39]
    v_pk_fma_f32 v[220:221], v[220:221], v[182:183], v[180:181]
    v_pk_fma_f32 v[222:223], v[222:223], v[182:183], v[180:181]
    v_pk_fma_f32 v[224:225], v[224:225], v[182:183], v[180:181]
    v_pk_fma_f32 v[226:227], v[226:227], v[182:183], v[180:181]
    v_pk_mul_f32 v[220:221], v[220:221], v[32:33]
    v_pk_mul_f32 v[222:223], v[222:223], v[34:35]
    v_pk_mul_f32 v[224:225], v[224:225], v[36:37]
    v_pk_mul_f32 v[226:227], v[226:227], v[38:39]
    v_exp_f32 v220, v220
    v_exp_f32 v221, v221
    v_exp_f32 v222, v222
    v_exp_f32 v223, v223
    v_exp_f32 v224, v224
    v_exp_f32 v225, v225
    v_exp_f32 v226, v226
    v_exp_f32 v227, v227
    v_pk_add_f32 v[220:221], v[220:221], 1.0 op_sel_hi:[1,0]
    v_pk_add_f32 v[222:223], v[222:223], 1.0 op_sel_hi:[1,0]
    v_pk_add_f32 v[224:225], v[224:225], 1.0 op_sel_hi:[1,0]
    v_pk_add_f32 v[226:227], v[226:227], 1.0 op_sel_hi:[1,0]
    v_rcp_f32 v220, v220
    v_rcp_f32 v221, v221
    v_rcp_f32 v222, v222
    v_rcp_f32 v223, v223
    v_rcp_f32 v224, v224
    v_rcp_f32 v225, v225
    v_rcp_f32 v226, v226
    v_rcp_f32 v227, v227
    v_pk_mul_f32 v[32:33], v[32:33], v[220:221]
    v_pk_mul_f32 v[34:35], v[34:35], v[222:223]
    v_pk_mul_f32 v[36:37], v[36:37], v[224:225]
    v_pk_mul_f32 v[38:39], v[38:39], v[226:227]
    v_cvt_pk_bf16_f32 v136, v32, v33
    v_cvt_pk_bf16_f32 v137, v34, v35
    v_cvt_pk_bf16_f32 v138, v36, v37
    v_cvt_pk_bf16_f32 v139, v38, v39
    s_cmp_gt_u32 s25, 7
    s_cbranch_scc1 K1_NOKVF
    s_waitcnt vmcnt(0)
    s_mov_b64 exec, 1
    buffer_store_dword v10, v8, s[32:35], 0 offen sc1
    s_mov_b64 exec, -1
K1_NOKVF:
    v_pk_mul_f32 v[220:221], v[40:41], v[40:41]
    v_pk_mul_f32 v[222:223], v[42:43], v[42:43]
    v_pk_mul_f32 v[224:225], v[44:45], v[44:45]
    v_pk_mul_f32 v[226:227], v[46:47], v[46:47]
    v_pk_fma_f32 v[220:221], v[220:221], v[182:183], v[180:181]
    v_pk_fma_f32 v[222:223], v[222:223], v[182:183], v[180:181]
    v_pk_fma_f32 v[224:225], v[224:225], v[182:183], v[180:181]
    v_pk_fma_f32 v[226:227], v[226:227], v[182:183], v[180:181]
    v_pk_mul_f32 v[220:221], v[220:221], v[40:41]
    v_pk_mul_f32 v[222:223], v[222:223], v[42:43]
    v_pk_mul_f32 v[224:225], v[224:225], v[44:45]
    v_pk_mul_f32 v[226:227], v[226:227], v[46:47]
    v_exp_f32 v220, v220
    v_exp_f32 v221, v221
    v_exp_f32 v222, v222
    v_exp_f32 v223, v223
    v_exp_f32 v224, v224
    v_exp_f32 v225, v225
    v_exp_f32 v226, v226
    v_exp_f32 v227, v227
    v_pk_add_f32 v[220:221], v[220:221], 1.0 op_sel_hi:[1,0]
    v_pk_add_f32 v[222:223], v[222:223], 1.0 op_sel_hi:[1,0]
    v_pk_add_f32 v[224:225], v[224:225], 1.0 op_sel_hi:[1,0]
    v_pk_add_f32 v[226:227], v[226:227], 1.0 op_sel_hi:[1,0]
    v_rcp_f32 v220, v220
    v_rcp_f32 v221, v221
    v_rcp_f32 v222, v222
    v_rcp_f32 v223, v223
    v_rcp_f32 v224, v224
    v_rcp_f32 v225, v225
    v_rcp_f32 v226, v226
    v_rcp_f32 v227, v227
    v_pk_mul_f32 v[40:41], v[40:41], v[220:221]
    v_pk_mul_f32 v[42:43], v[42:43], v[222:223]
    v_pk_mul_f32 v[44:45], v[44:45], v[224:225]
    v_pk_mul_f32 v[46:47], v[46:47], v[226:227]
    v_cvt_pk_bf16_f32 v140, v40, v41
    v_cvt_pk_bf16_f32 v141, v42, v43
    v_cvt_pk_bf16_f32 v142, v44, v45
    v_cvt_pk_bf16_f32 v143, v46, v47
    v_pk_mul_f32 v[220:221], v[48:49], v[48:49]
    v_pk_mul_f32 v[222:223], v[50:51], v[50:51]
    v_pk_mul_f32 v[224:225], v[52:53], v[52:53]
    v_pk_mul_f32 v[226:227], v[54:55], v[54:55]
    v_pk_fma_f32 v[220:221], v[220:221], v[182:183], v[180:181]
    v_pk_fma_f32 v[222:223], v[222:223], v[182:183], v[180:181]
    v_pk_fma_f32 v[224:225], v[224:225], v[182:183], v[180:181]
    v_pk_fma_f32 v[226:227], v[226:227], v[182:183], v[180:181]
    v_pk_mul_f32 v[220:221], v[220:221], v[48:49]
    v_pk_mul_f32 v[222:223], v[222:223], v[50:51]
    v_pk_mul_f32 v[224:225], v[224:225], v[52:53]
    v_pk_mul_f32 v[226:227], v[226:227], v[54:55]
    v_exp_f32 v220, v220
    v_exp_f32 v221, v221
    v_exp_f32 v222, v222
    v_exp_f32 v223, v223
    v_exp_f32 v224, v224
    v_exp_f32 v225, v225
    v_exp_f32 v226, v226
    v_exp_f32 v227, v227
    v_pk_add_f32 v[220:221], v[220:221], 1.0 op_sel_hi:[1,0]
    v_pk_add_f32 v[222:223], v[222:223], 1.0 op_sel_hi:[1,0]
    v_pk_add_f32 v[224:225], v[224:225], 1.0 op_sel_hi:[1,0]
    v_pk_add_f32 v[226:227], v[226:227], 1.0 op_sel_hi:[1,0]
    v_rcp_f32 v220, v220
    v_rcp_f32 v221, v221
    v_rcp_f32 v222, v222
    v_rcp_f32 v223, v223
    v_rcp_f32 v224, v224
    v_rcp_f32 v225, v225
    v_rcp_f32 v226, v226
    v_rcp_f32 v227, v227
    v_pk_mul_f32 v[48:49], v[48:49], v[220:221]
    v_pk_mul_f32 v[50:51], v[50:51], v[222:223]
    v_pk_mul_f32 v[52:53], v[52:53], v[224:225]
    v_pk_mul_f32 v[54:55], v[54:55], v[226:227]
    v_cvt_pk_bf16_f32 v184, v48, v49
    v_cvt_pk_bf16_f32 v185, v50, v51
    v_cvt_pk_bf16_f32 v186, v52, v53
    v_cvt_pk_bf16_f32 v187, v54, v55
    v_pk_mul_f32 v[220:221], v[56:57], v[56:57]
    v_pk_mul_f32 v[222:223], v[58:59], v[58:59]
    v_pk_mul_f32 v[224:225], v[60:61], v[60:61]
    v_pk_mul_f32 v[226:227], v[62:63], v[62:63]
    v_pk_fma_f32 v[220:221], v[220:221], v[182:183], v[180:181]
    v_pk_fma_f32 v[222:223], v[222:223], v[182:183], v[180:181]
    v_pk_fma_f32 v[224:225], v[224:225], v[182:183], v[180:181]
    v_pk_fma_f32 v[226:227], v[226:227], v[182:183], v[180:181]
    v_pk_mul_f32 v[220:221], v[220:221], v[56:57]
    v_pk_mul_f32 v[222:223], v[222:223], v[58:59]
    v_pk_mul_f32 v[224:225], v[224:225], v[60:61]
    v_pk_mul_f32 v[226:227], v[226:227], v[62:63]
    v_exp_f32 v220, v220
    v_exp_f32 v221, v221
    v_exp_f32 v222, v222
    v_exp_f32 v223, v223
    v_exp_f32 v224, v224
    v_exp_f32 v225, v225
    v_exp_f32 v226, v226
    v_exp_f32 v227, v227
    v_pk_add_f32 v[220:221], v[220:221], 1.0 op_sel_hi:[1,0]
    v_pk_add_f32 v[222:223], v[222:223], 1.0 op_sel_hi:[1,0]
    v_pk_add_f32 v[224:225], v[224:225], 1.0 op_sel_hi:[1,0]
    v_pk_add_f32 v[226:227], v[226:227], 1.0 op_sel_hi:[1,0]
    v_rcp_f32 v220, v220
    v_rcp_f32 v221, v221
    v_rcp_f32 v222, v222
    v_rcp_f32 v223, v223
    v_rcp_f32 v224, v224
    v_rcp_f32 v225, v225
    v_rcp_f32 v226, v226
    v_rcp_f32 v227, v227
    v_pk_mul_f32 v[56:57], v[56:57], v[220:221]
    v_pk_mul_f32 v[58:59], v[58:59], v[222:223]
    v_pk_mul_f32 v[60:61], v[60:61], v[224:225]
    v_pk_mul_f32 v[62:63], v[62:63], v[226:227]
    v_cvt_pk_bf16_f32 v192, v56, v57
    v_cvt_pk_bf16_f32 v193, v58, v59
    v_cvt_pk_bf16_f32 v194, v60, v61
    v_cvt_pk_bf16_f32 v195, v62, v63
    v_pk_mul_f32 v[220:221], v[64:65], v[64:65]
    v_pk_mul_f32 v[222:223], v[66:67], v[66:67]
    v_pk_mul_f32 v[224:225], v[68:69], v[68:69]
    v_pk_mul_f32 v[226:227], v[70:71], v[70:71]
    v_pk_fma_f32 v[220:221], v[220:221], v[182:183], v[180:181]
    v_pk_fma_f32 v[222:223], v[222:223], v[182:183], v[180:181]
    v_pk_fma_f32 v[224:225], v[224:225], v[182:183], v[180:181]
    v_pk_fma_f32 v[226:227], v[226:227], v[182:183], v[180:181]
    v_pk_mul_f32 v[220:221], v[220:221], v[64:65]
    v_pk_mul_f32 v[222:223], v[222:223], v[66:67]
    v_pk_mul_f32 v[224:225], v[224:225], v[68:69]
    v_pk_mul_f32 v[226:227], v[226:227], v[70:71]
    v_exp_f32 v220, v220
    v_exp_f32 v221, v221
    v_exp_f32 v222, v222
    v_exp_f32 v223, v223
    v_exp_f32 v224, v224
    v_exp_f32 v225, v225
    v_exp_f32 v226, v226
    v_exp_f32 v227, v227
    v_pk_add_f32 v[220:221], v[220:221], 1.0 op_sel_hi:[1,0]
    v_pk_add_f32 v[222:223], v[222:223], 1.0 op_sel_hi:[1,0]
    v_pk_add_f32 v[224:225], v[224:225], 1.0 op_sel_hi:[1,0]
    v_pk_add_f32 v[226:227], v[226:227], 1.0 op_sel_hi:[1,0]
    v_rcp_f32 v220, v220
    v_rcp_f32 v221, v221
    v_rcp_f32 v222, v222
    v_rcp_f32 v223, v223
    v_rcp_f32 v224, v224
    v_rcp_f32 v225, v225
    v_rcp_f32 v226, v226
    v_rcp_f32 v227, v227
    v_pk_mul_f32 v[64:65], v[64:65], v[220:221]
    v_pk_mul_f32 v[66:67], v[66:67], v[222:223]
    v_pk_mul_f32 v[68:69], v[68:69], v[224:225]
    v_pk_mul_f32 v[70:71], v[70:71], v[226:227]
    v_cvt_pk_bf16_f32 v196, v64, v65
    v_cvt_pk_bf16_f32 v197, v66, v67
    v_cvt_pk_bf16_f32 v198, v68, v69
    v_cvt_pk_bf16_f32 v199, v70, v71
    v_pk_mul_f32 v[220:221], v[72:73], v[72:73]
    v_pk_mul_f32 v[222:223], v[74:75], v[74:75]
    v_pk_mul_f32 v[224:225], v[76:77], v[76:77]
    v_pk_mul_f32 v[226:227], v[78:79], v[78:79]
    v_pk_fma_f32 v[220:221], v[220:221], v[182:183], v[180:181]
    v_pk_fma_f32 v[222:223], v[222:223], v[182:183], v[180:181]
    v_pk_fma_f32 v[224:225], v[224:225], v[182:183], v[180:181]
    v_pk_fma_f32 v[226:227], v[226:227], v[182:183], v[180:181]
    v_pk_mul_f32 v[220:221], v[220:221], v[72:73]
    v_pk_mul_f32 v[222:223], v[222:223], v[74:75]
    v_pk_mul_f32 v[224:225], v[224:225], v[76:77]
    v_pk_mul_f32 v[226:227], v[226:227], v[78:79]
    v_exp_f32 v220, v220
    v_exp_f32 v221, v221
    v_exp_f32 v222, v222
    v_exp_f32 v223, v223
    v_exp_f32 v224, v224
    v_exp_f32 v225, v225
    v_exp_f32 v226, v226
    v_exp_f32 v227, v227
    v_pk_add_f32 v[220:221], v[220:221], 1.0 op_sel_hi:[1,0]
    v_pk_add_f32 v[222:223], v[222:223], 1.0 op_sel_hi:[1,0]
    v_pk_add_f32 v[224:225], v[224:225], 1.0 op_sel_hi:[1,0]
    v_pk_add_f32 v[226:227], v[226:227], 1.0 op_sel_hi:[1,0]
    v_rcp_f32 v220, v220
    v_rcp_f32 v221, v221
    v_rcp_f32 v222, v222
    v_rcp_f32 v223, v223
    v_rcp_f32 v224, v224
    v_rcp_f32 v225, v225
    v_rcp_f32 v226, v226
    v_rcp_f32 v227, v227
    v_pk_mul_f32 v[72:73], v[72:73], v[220:221]
    v_pk_mul_f32 v[74:75], v[74:75], v[222:223]
    v_pk_mul_f32 v[76:77], v[76:77], v[224:225]
    v_pk_mul_f32 v[78:79], v[78:79], v[226:227]
    v_cvt_pk_bf16_f32 v200, v72, v73
    v_cvt_pk_bf16_f32 v201, v74, v75
    v_cvt_pk_bf16_f32 v202, v76, v77
    v_cvt_pk_bf16_f32 v203, v78, v79
    v_pk_mul_f32 v[220:221], v[80:81], v[80:81]
    v_pk_mul_f32 v[222:223], v[82:83], v[82:83]
    v_pk_mul_f32 v[224:225], v[84:85], v[84:85]
    v_pk_mul_f32 v[226:227], v[86:87], v[86:87]
    v_pk_fma_f32 v[220:221], v[220:221], v[182:183], v[180:181]
    v_pk_fma_f32 v[222:223], v[222:223], v[182:183], v[180:181]
    v_pk_fma_f32 v[224:225], v[224:225], v[182:183], v[180:181]
    v_pk_fma_f32 v[226:227], v[226:227], v[182:183], v[180:181]
    v_pk_mul_f32 v[220:221], v[220:221], v[80:81]
    v_pk_mul_f32 v[222:223], v[222:223], v[82:83]
    v_pk_mul_f32 v[224:225], v[224:225], v[84:85]
    v_pk_mul_f32 v[226:227], v[226:227], v[86:87]
    v_exp_f32 v220, v220
    v_exp_f32 v221, v221
    v_exp_f32 v222, v222
    v_exp_f32 v223, v223
    v_exp_f32 v224, v224
    v_exp_f32 v225, v225
    v_exp_f32 v226, v226
    v_exp_f32 v227, v227
    v_pk_add_f32 v[220:221], v[220:221], 1.0 op_sel_hi:[1,0]
    v_pk_add_f32 v[222:223], v[222:223], 1.0 op_sel_hi:[1,0]
    v_pk_add_f32 v[224:225], v[224:225], 1.0 op_sel_hi:[1,0]
    v_pk_add_f32 v[226:227], v[226:227], 1.0 op_sel_hi:[1,0]
    v_rcp_f32 v220, v220
    v_rcp_f32 v221, v221
    v_rcp_f32 v222, v222
    v_rcp_f32 v223, v223
    v_rcp_f32 v224, v224
    v_rcp_f32 v225, v225
    v_rcp_f32 v226, v226
    v_rcp_f32 v227, v227
    v_pk_mul_f32 v[80:81], v[80:81], v[220:221]
    v_pk_mul_f32 v[82:83], v[82:83], v[222:223]
    v_pk_mul_f32 v[84:85], v[84:85], v[224:225]
    v_pk_mul_f32 v[86:87], v[86:87], v[226:227]
    v_cvt_pk_bf16_f32 v204, v80, v81
    v_cvt_pk_bf16_f32 v205, v82, v83
    v_cvt_pk_bf16_f32 v206, v84, v85
    v_cvt_pk_bf16_f32 v207, v86, v87
    s_branch T_SETUP
K1_EPI_Z2:
    v_pk_mul_f32 v[188:189], v[16:17], v[16:17]
    v_pk_mul_f32 v[190:191], v[18:19], v[18:19]
    v_pk_mul_f32 v[192:193], v[20:21], v[20:21]
    v_pk_mul_f32 v[194:195], v[22:23], v[22:23]
    v_pk_fma_f32 v[188:189], v[188:189], v[182:183], v[180:181]
    v_pk_fma_f32 v[190:191], v[190:191], v[182:183], v[180:181]
    v_pk_fma_f32 v[192:193], v[192:193], v[182:183], v[180:181]
    v_pk_fma_f32 v[194:195], v[194:195], v[182:183], v[180:181]
    v_pk_mul_f32 v[188:189], v[188:189], v[16:17]
    v_pk_mul_f32 v[190:191], v[190:191], v[18:19]
    v_pk_mul_f32 v[192:193], v[192:193], v[20:21]
    v_pk_mul_f32 v[194:195], v[194:195], v[22:23]
    v_exp_f32 v188, v188
    v_exp_f32 v189, v189
    v_exp_f32 v190, v190
    v_exp_f32 v191, v191
    v_exp_f32 v192, v192
    v_exp_f32 v193, v193
    v_exp_f32 v194, v194
    v_exp_f32 v195, v195
    v_pk_add_f32 v[188:189], v[188:189], 1.0 op_sel_hi:[1,0]
    v_pk_add_f32 v[190:191], v[190:191], 1.0 op_sel_hi:[1,0]
    v_pk_add_f32 v[192:193], v[192:193], 1.0 op_sel_hi:[1,0]
    v_pk_add_f32 v[194:195], v[194:195], 1.0 op_sel_hi:[1,0]
    v_rcp_f32 v188, v188
    v_rcp_f32 v189, v189
    v_rcp_f32 v190, v190
    v_rcp_f32 v191, v191
    v_rcp_f32 v192, v192
    v_rcp_f32 v193, v193
    v_rcp_f32 v194, v194
    v_rcp_f32 v195, v195
    v_pk_mul_f32 v[16:17], v[16:17], v[188:189]
    v_pk_mul_f32 v[18:19], v[18:19], v[190:191]
    v_pk_mul_f32 v[20:21], v[20:21], v[192:193]
    v_pk_mul_f32 v[22:23], v[22:23], v[194:195]
    v_pk_mul_f32 v[186:187], v[16:17], v[16:17]
    v_mov_b32 v184, v16
    v_mov_b32 v185, v17
    v_pk_add_f32 v[184:185], v[184:185], v[18:19]
    v_pk_fma_f32 v[186:187], v[18:19], v[18:19], v[186:187]
    v_pk_add_f32 v[184:185], v[184:185], v[20:21]
    v_pk_fma_f32 v[186:187], v[20:21], v[20:21], v[186:187]
    v_pk_add_f32 v[184:185], v[184:185], v[22:23]
    v_pk_fma_f32 v[186:187], v[22:23], v[22:23], v[186:187]
    v_pk_mul_f32 v[188:189], v[24:25], v[24:25]
    v_pk_mul_f32 v[190:191], v[26:27], v[26:27]
    v_pk_mul_f32 v[192:193], v[28:29], v[28:29]
    v_pk_mul_f32 v[194:195], v[30:31], v[30:31]
    v_pk_fma_f32 v[188:189], v[188:189], v[182:183], v[180:181]
    v_pk_fma_f32 v[190:191], v[190:191], v[182:183], v[180:181]
    v_pk_fma_f32 v[192:193], v[192:193], v[182:183], v[180:181]
    v_pk_fma_f32 v[194:195], v[194:195], v[182:183], v[180:181]
    v_pk_mul_f32 v[188:189], v[188:189], v[24:25]
    v_pk_mul_f32 v[190:191], v[190:191], v[26:27]
    v_pk_mul_f32 v[192:193], v[192:193], v[28:29]
    v_pk_mul_f32 v[194:195], v[194:195], v[30:31]
    v_exp_f32 v188, v188
    v_exp_f32 v189, v189
    v_exp_f32 v190, v190
    v_exp_f32 v191, v191
    v_exp_f32 v192, v192
    v_exp_f32 v193, v193
    v_exp_f32 v194, v194
    v_exp_f32 v195, v195
    v_pk_add_f32 v[188:189], v[188:189], 1.0 op_sel_hi:[1,0]
    v_pk_add_f32 v[190:191], v[190:191], 1.0 op_sel_hi:[1,0]
    v_pk_add_f32 v[192:193], v[192:193], 1.0 op_sel_hi:[1,0]
    v_pk_add_f32 v[194:195], v[194:195], 1.0 op_sel_hi:[1,0]
    v_rcp_f32 v188, v188
    v_rcp_f32 v189, v189
    v_rcp_f32 v190, v190
    v_rcp_f32 v191, v191
    v_rcp_f32 v192, v192
    v_rcp_f32 v193, v193
    v_rcp_f32 v194, v194
    v_rcp_f32 v195, v195
    v_pk_mul_f32 v[24:25], v[24:25], v[188:189]
    v_pk_mul_f32 v[26:27], v[26:27], v[190:191]
    v_pk_mul_f32 v[28:29], v[28:29], v[192:193]
    v_pk_mul_f32 v[30:31], v[30:31], v[194:195]
    v_pk_add_f32 v[184:185], v[184:185], v[24:25]
    v_pk_fma_f32 v[186:187], v[24:25], v[24:25], v[186:187]
    v_pk_add_f32 v[184:185], v[184:185], v[26:27]
    v_pk_fma_f32 v[186:187], v[26:27], v[26:27], v[186:187]
    v_pk_add_f32 v[184:185], v[184:185], v[28:29]
    v_pk_fma_f32 v[186:187], v[28:29], v[28:29], v[186:187]
    v_pk_add_f32 v[184:185], v[184:185], v[30:31]
    v_pk_fma_f32 v[186:187], v[30:31], v[30:31], v[186:187]
    v_pk_mul_f32 v[188:189], v[32:33], v[32:33]
    v_pk_mul_f32 v[190:191], v[34:35], v[34:35]
    v_pk_mul_f32 v[192:193], v[36:37], v[36:37]
    v_pk_mul_f32 v[194:195], v[38:39], v[38:39]
    v_pk_fma_f32 v[188:189], v[188:189], v[182:183], v[180:181]
    v_pk_fma_f32 v[190:191], v[190:191], v[182:183], v[180:181]
    v_pk_fma_f32 v[192:193], v[192:193], v[182:183], v[180:181]
    v_pk_fma_f32 v[194:195], v[194:195], v[182:183], v[180:181]
    v_pk_mul_f32 v[188:189], v[188:189], v[32:33]
    v_pk_mul_f32 v[190:191], v[190:191], v[34:35]
    v_pk_mul_f32 v[192:193], v[192:193], v[36:37]
    v_pk_mul_f32 v[194:195], v[194:195], v[38:39]
    v_exp_f32 v188, v188
    v_exp_f32 v189, v189
    v_exp_f32 v190, v190
    v_exp_f32 v191, v191
    v_exp_f32 v192, v192
    v_exp_f32 v193, v193
    v_exp_f32 v194, v194
    v_exp_f32 v195, v195
    v_pk_add_f32 v[188:189], v[188:189], 1.0 op_sel_hi:[1,0]
    v_pk_add_f32 v[190:191], v[190:191], 1.0 op_sel_hi:[1,0]
    v_pk_add_f32 v[192:193], v[192:193], 1.0 op_sel_hi:[1,0]
    v_pk_add_f32 v[194:195], v[194:195], 1.0 op_sel_hi:[1,0]
    v_rcp_f32 v188, v188
    v_rcp_f32 v189, v189
    v_rcp_f32 v190, v190
    v_rcp_f32 v191, v191
    v_rcp_f32 v192, v192
    v_rcp_f32 v193, v193
    v_rcp_f32 v194, v194
    v_rcp_f32 v195, v195
    v_pk_mul_f32 v[32:33], v[32:33], v[188:189]
    v_pk_mul_f32 v[34:35], v[34:35], v[190:191]
    v_pk_mul_f32 v[36:37], v[36:37], v[192:193]
    v_pk_mul_f32 v[38:39], v[38:39], v[194:195]
    v_pk_add_f32 v[184:185], v[184:185], v[32:33]
    v_pk_fma_f32 v[186:187], v[32:33], v[32:33], v[186:187]
    v_pk_add_f32 v[184:185], v[184:185], v[34:35]
    v_pk_fma_f32 v[186:187], v[34:35], v[34:35], v[186:187]
    v_pk_add_f32 v[184:185], v[184:185], v[36:37]
    v_pk_fma_f32 v[186:187], v[36:37], v[36:37], v[186:187]
    v_pk_add_f32 v[184:185], v[184:185], v[38:39]
    v_pk_fma_f32 v[186:187], v[38:39], v[38:39], v[186:187]
    v_pk_mul_f32 v[188:189], v[40:41], v[40:41]
    v_pk_mul_f32 v[190:191], v[42:43], v[42:43]
    v_pk_mul_f32 v[192:193], v[44:45], v[44:45]
    v_pk_mul_f32 v[194:195], v[46:47], v[46:47]
    v_pk_fma_f32 v[188:189], v[188:189], v[182:183], v[180:181]
    v_pk_fma_f32 v[190:191], v[190:191], v[182:183], v[180:181]
    v_pk_fma_f32 v[192:193], v[192:193], v[182:183], v[180:181]
    v_pk_fma_f32 v[194:195], v[194:195], v[182:183], v[180:181]
    v_pk_mul_f32 v[188:189], v[188:189], v[40:41]
    v_pk_mul_f32 v[190:191], v[190:191], v[42:43]
    v_pk_mul_f32 v[192:193], v[192:193], v[44:45]
    v_pk_mul_f32 v[194:195], v[194:195], v[46:47]
    v_exp_f32 v188, v188
    v_exp_f32 v189, v189
    v_exp_f32 v190, v190
    v_exp_f32 v191, v191
    v_exp_f32 v192, v192
    v_exp_f32 v193, v193
    v_exp_f32 v194, v194
    v_exp_f32 v195, v195
    v_pk_add_f32 v[188:189], v[188:189], 1.0 op_sel_hi:[1,0]
    v_pk_add_f32 v[190:191], v[190:191], 1.0 op_sel_hi:[1,0]
    v_pk_add_f32 v[192:193], v[192:193], 1.0 op_sel_hi:[1,0]
    v_pk_add_f32 v[194:195], v[194:195], 1.0 op_sel_hi:[1,0]
    v_rcp_f32 v188, v188
    v_rcp_f32 v189, v189
    v_rcp_f32 v190, v190
    v_rcp_f32 v191, v191
    v_rcp_f32 v192, v192
    v_rcp_f32 v193, v193
    v_rcp_f32 v194, v194
    v_rcp_f32 v195, v195
    v_pk_mul_f32 v[40:41], v[40:41], v[188:189]
    v_pk_mul_f32 v[42:43], v[42:43], v[190:191]
    v_pk_mul_f32 v[44:45], v[44:45], v[192:193]
    v_pk_mul_f32 v[46:47], v[46:47], v[194:195]
    v_mov_b32 v4, 0
    global_load_dword v5, v4, s[20:21] sc1
    v_pk_add_f32 v[184:185], v[184:185], v[40:41]
    v_pk_fma_f32 v[186:187], v[40:41], v[40:41], v[186:187]
    v_pk_add_f32 v[184:185], v[184:185], v[42:43]
    v_pk_fma_f32 v[186:187], v[42:43], v[42:43], v[186:187]
    v_pk_add_f32 v[184:185], v[184:185], v[44:45]
    v_pk_fma_f32 v[186:187], v[44:45], v[44:45], v[186:187]
    v_pk_add_f32 v[184:185], v[184:185], v[46:47]
    v_pk_fma_f32 v[186:187], v[46:47], v[46:47], v[186:187]
    v_pk_mul_f32 v[188:189], v[48:49], v[48:49]
    v_pk_mul_f32 v[190:191], v[50:51], v[50:51]
    v_pk_mul_f32 v[192:193], v[52:53], v[52:53]
    v_pk_mul_f32 v[194:195], v[54:55], v[54:55]
    v_pk_fma_f32 v[188:189], v[188:189], v[182:183], v[180:181]
    v_pk_fma_f32 v[190:191], v[190:191], v[182:183], v[180:181]
    v_pk_fma_f32 v[192:193], v[192:193], v[182:183], v[180:181]
    v_pk_fma_f32 v[194:195], v[194:195], v[182:183], v[180:181]
    v_pk_mul_f32 v[188:189], v[188:189], v[48:49]
    v_pk_mul_f32 v[190:191], v[190:191], v[50:51]
    v_pk_mul_f32 v[192:193], v[192:193], v[52:53]
    v_pk_mul_f32 v[194:195], v[194:195], v[54:55]
    v_exp_f32 v188, v188
    v_exp_f32 v189, v189
    v_exp_f32 v190, v190
    v_exp_f32 v191, v191
    v_exp_f32 v192, v192
    v_exp_f32 v193, v193
    v_exp_f32 v194, v194
    v_exp_f32 v195, v195
    v_pk_add_f32 v[188:189], v[188:189], 1.0 op_sel_hi:[1,0]
    v_pk_add_f32 v[190:191], v[190:191], 1.0 op_sel_hi:[1,0]
    v_pk_add_f32 v[192:193], v[192:193], 1.0 op_sel_hi:[1,0]
    v_pk_add_f32 v[194:195], v[194:195], 1.0 op_sel_hi:[1,0]
    v_rcp_f32 v188, v188
    v_rcp_f32 v189, v189
    v_rcp_f32 v190, v190
    v_rcp_f32 v191, v191
    v_rcp_f32 v192, v192
    v_rcp_f32 v193, v193
    v_rcp_f32 v194, v194
    v_rcp_f32 v195, v195
    v_pk_mul_f32 v[48:49], v[48:49], v[188:189]
    v_pk_mul_f32 v[50:51], v[50:51], v[190:191]
    v_pk_mul_f32 v[52:53], v[52:53], v[192:193]
    v_pk_mul_f32 v[54:55], v[54:55], v[194:195]
    v_pk_add_f32 v[184:185], v[184:185], v[48:49]
    v_pk_fma_f32 v[186:187], v[48:49], v[48:49], v[186:187]
    v_pk_add_f32 v[184:185], v[184:185], v[50:51]
    v_pk_fma_f32 v[186:187], v[50:51], v[50:51], v[186:187]
    v_pk_add_f32 v[184:185], v[184:185], v[52:53]
    v_pk_fma_f32 v[186:187], v[52:53], v[52:53], v[186:187]
    v_pk_add_f32 v[184:185], v[184:185], v[54:55]
    v_pk_fma_f32 v[186:187], v[54:55], v[54:55], v[186:187]
    v_pk_mul_f32 v[188:189], v[56:57], v[56:57]
    v_pk_mul_f32 v[190:191], v[58:59], v[58:59]
    v_pk_mul_f32 v[192:193], v[60:61], v[60:61]
    v_pk_mul_f32 v[194:195], v[62:63], v[62:63]
    v_pk_fma_f32 v[188:189], v[188:189], v[182:183], v[180:181]
    v_pk_fma_f32 v[190:191], v[190:191], v[182:183], v[180:181]
    v_pk_fma_f32 v[192:193], v[192:193], v[182:183], v[180:181]
    v_pk_fma_f32 v[194:195], v[194:195], v[182:183], v[180:181]
    v_pk_mul_f32 v[188:189], v[188:189], v[56:57]
    v_pk_mul_f32 v[190:191], v[190:191], v[58:59]
    v_pk_mul_f32 v[192:193], v[192:193], v[60:61]
    v_pk_mul_f32 v[194:195], v[194:195], v[62:63]
    v_exp_f32 v188, v188
    v_exp_f32 v189, v189
    v_exp_f32 v190, v190
    v_exp_f32 v191, v191
    v_exp_f32 v192, v192
    v_exp_f32 v193, v193
    v_exp_f32 v194, v194
    v_exp_f32 v195, v195
    v_pk_add_f32 v[188:189], v[188:189], 1.0 op_sel_hi:[1,0]
    v_pk_add_f32 v[190:191], v[190:191], 1.0 op_sel_hi:[1,0]
    v_pk_add_f32 v[192:193], v[192:193], 1.0 op_sel_hi:[1,0]
    v_pk_add_f32 v[194:195], v[194:195], 1.0 op_sel_hi:[1,0]
    v_rcp_f32 v188, v188
    v_rcp_f32 v189, v189
    v_rcp_f32 v190, v190
    v_rcp_f32 v191, v191
    v_rcp_f32 v192, v192
    v_rcp_f32 v193, v193
    v_rcp_f32 v194, v194
    v_rcp_f32 v195, v195
    v_pk_mul_f32 v[56:57], v[56:57], v[188:189]
    v_pk_mul_f32 v[58:59], v[58:59], v[190:191]
    v_pk_mul_f32 v[60:61], v[60:61], v[192:193]
    v_pk_mul_f32 v[62:63], v[62:63], v[194:195]
    v_pk_add_f32 v[184:185], v[184:185], v[56:57]
    v_pk_fma_f32 v[186:187], v[56:57], v[56:57], v[186:187]
    v_pk_add_f32 v[184:185], v[184:185], v[58:59]
    v_pk_fma_f32 v[186:187], v[58:59], v[58:59], v[186:187]
    v_pk_add_f32 v[184:185], v[184:185], v[60:61]
    v_pk_fma_f32 v[186:187], v[60:61], v[60:61], v[186:187]
    v_pk_add_f32 v[184:185], v[184:185], v[62:63]
    v_pk_fma_f32 v[186:187], v[62:63], v[62:63], v[186:187]
    v_pk_mul_f32 v[188:189], v[64:65], v[64:65]
    v_pk_mul_f32 v[190:191], v[66:67], v[66:67]
    v_pk_mul_f32 v[192:193], v[68:69], v[68:69]
    v_pk_mul_f32 v[194:195], v[70:71], v[70:71]
    v_pk_fma_f32 v[188:189], v[188:189], v[182:183], v[180:181]
    v_pk_fma_f32 v[190:191], v[190:191], v[182:183], v[180:181]
    v_pk_fma_f32 v[192:193], v[192:193], v[182:183], v[180:181]
    v_pk_fma_f32 v[194:195], v[194:195], v[182:183], v[180:181]
    v_pk_mul_f32 v[188:189], v[188:189], v[64:65]
    v_pk_mul_f32 v[190:191], v[190:191], v[66:67]
    v_pk_mul_f32 v[192:193], v[192:193], v[68:69]
    v_pk_mul_f32 v[194:195], v[194:195], v[70:71]
    v_exp_f32 v188, v188
    v_exp_f32 v189, v189
    v_exp_f32 v190, v190
    v_exp_f32 v191, v191
    v_exp_f32 v192, v192
    v_exp_f32 v193, v193
    v_exp_f32 v194, v194
    v_exp_f32 v195, v195
    v_pk_add_f32 v[188:189], v[188:189], 1.0 op_sel_hi:[1,0]
    v_pk_add_f32 v[190:191], v[190:191], 1.0 op_sel_hi:[1,0]
    v_pk_add_f32 v[192:193], v[192:193], 1.0 op_sel_hi:[1,0]
    v_pk_add_f32 v[194:195], v[194:195], 1.0 op_sel_hi:[1,0]
    v_rcp_f32 v188, v188
    v_rcp_f32 v189, v189
    v_rcp_f32 v190, v190
    v_rcp_f32 v191, v191
    v_rcp_f32 v192, v192
    v_rcp_f32 v193, v193
    v_rcp_f32 v194, v194
    v_rcp_f32 v195, v195
    v_pk_mul_f32 v[64:65], v[64:65], v[188:189]
    v_pk_mul_f32 v[66:67], v[66:67], v[190:191]
    v_pk_mul_f32 v[68:69], v[68:69], v[192:193]
    v_pk_mul_f32 v[70:71], v[70:71], v[194:195]
    v_pk_add_f32 v[184:185], v[184:185], v[64:65]
    v_pk_fma_f32 v[186:187], v[64:65], v[64:65], v[186:187]
    v_pk_add_f32 v[184:185], v[184:185], v[66:67]
    v_pk_fma_f32 v[186:187], v[66:67], v[66:67], v[186:187]
    v_pk_add_f32 v[184:185], v[184:185], v[68:69]
    v_pk_fma_f32 v[186:187], v[68:69], v[68:69], v[186:187]
    v_pk_add_f32 v[184:185], v[184:185], v[70:71]
    v_pk_fma_f32 v[186:187], v[70:71], v[70:71], v[186:187]
    v_pk_mul_f32 v[188:189], v[72:73], v[72:73]
    v_pk_mul_f32 v[190:191], v[74:75], v[74:75]
    v_pk_mul_f32 v[192:193], v[76:77], v[76:77]
    v_pk_mul_f32 v[194:195], v[78:79], v[78:79]
    v_pk_fma_f32 v[188:189], v[188:189], v[182:183], v[180:181]
    v_pk_fma_f32 v[190:191], v[190:191], v[182:183], v[180:181]
    v_pk_fma_f32 v[192:193], v[192:193], v[182:183], v[180:181]
    v_pk_fma_f32 v[194:195], v[194:195], v[182:183], v[180:181]
    v_pk_mul_f32 v[188:189], v[188:189], v[72:73]
    v_pk_mul_f32 v[190:191], v[190:191], v[74:75]
    v_pk_mul_f32 v[192:193], v[192:193], v[76:77]
    v_pk_mul_f32 v[194:195], v[194:195], v[78:79]
    v_exp_f32 v188, v188
    v_exp_f32 v189, v189
    v_exp_f32 v190, v190
    v_exp_f32 v191, v191
    v_exp_f32 v192, v192
    v_exp_f32 v193, v193
    v_exp_f32 v194, v194
    v_exp_f32 v195, v195
    v_pk_add_f32 v[188:189], v[188:189], 1.0 op_sel_hi:[1,0]
    v_pk_add_f32 v[190:191], v[190:191], 1.0 op_sel_hi:[1,0]
    v_pk_add_f32 v[192:193], v[192:193], 1.0 op_sel_hi:[1,0]
    v_pk_add_f32 v[194:195], v[194:195], 1.0 op_sel_hi:[1,0]
    v_rcp_f32 v188, v188
    v_rcp_f32 v189, v189
    v_rcp_f32 v190, v190
    v_rcp_f32 v191, v191
    v_rcp_f32 v192, v192
    v_rcp_f32 v193, v193
    v_rcp_f32 v194, v194
    v_rcp_f32 v195, v195
    v_pk_mul_f32 v[72:73], v[72:73], v[188:189]
    v_pk_mul_f32 v[74:75], v[74:75], v[190:191]
    v_pk_mul_f32 v[76:77], v[76:77], v[192:193]
    v_pk_mul_f32 v[78:79], v[78:79], v[194:195]
    v_pk_add_f32 v[184:185], v[184:185], v[72:73]
    v_pk_fma_f32 v[186:187], v[72:73], v[72:73], v[186:187]
    v_pk_add_f32 v[184:185], v[184:185], v[74:75]
    v_pk_fma_f32 v[186:187], v[74:75], v[74:75], v[186:187]
    v_pk_add_f32 v[184:185], v[184:185], v[76:77]
    v_pk_fma_f32 v[186:187], v[76:77], v[76:77], v[186:187]
    v_pk_add_f32 v[184:185], v[184:185], v[78:79]
    v_pk_fma_f32 v[186:187], v[78:79], v[78:79], v[186:187]
    v_pk_mul_f32 v[188:189], v[80:81], v[80:81]
    v_pk_mul_f32 v[190:191], v[82:83], v[82:83]
    v_pk_mul_f32 v[192:193], v[84:85], v[84:85]
    v_pk_mul_f32 v[194:195], v[86:87], v[86:87]
    v_pk_fma_f32 v[188:189], v[188:189], v[182:183], v[180:181]
    v_pk_fma_f32 v[190:191], v[190:191], v[182:183], v[180:181]
    v_pk_fma_f32 v[192:193], v[192:193], v[182:183], v[180:181]
    v_pk_fma_f32 v[194:195], v[194:195], v[182:183], v[180:181]
    v_pk_mul_f32 v[188:189], v[188:189], v[80:81]
    v_pk_mul_f32 v[190:191], v[190:191], v[82:83]
    v_pk_mul_f32 v[192:193], v[192:193], v[84:85]
    v_pk_mul_f32 v[194:195], v[194:195], v[86:87]
    v_exp_f32 v188, v188
    v_exp_f32 v189, v189
    v_exp_f32 v190, v190
    v_exp_f32 v191, v191
    v_exp_f32 v192, v192
    v_exp_f32 v193, v193
    v_exp_f32 v194, v194
    v_exp_f32 v195, v195
    v_pk_add_f32 v[188:189], v[188:189], 1.0 op_sel_hi:[1,0]
    v_pk_add_f32 v[190:191], v[190:191], 1.0 op_sel_hi:[1,0]
    v_pk_add_f32 v[192:193], v[192:193], 1.0 op_sel_hi:[1,0]
    v_pk_add_f32 v[194:195], v[194:195], 1.0 op_sel_hi:[1,0]
    v_rcp_f32 v188, v188
    v_rcp_f32 v189, v189
    v_rcp_f32 v190, v190
    v_rcp_f32 v191, v191
    v_rcp_f32 v192, v192
    v_rcp_f32 v193, v193
    v_rcp_f32 v194, v194
    v_rcp_f32 v195, v195
    v_pk_mul_f32 v[80:81], v[80:81], v[188:189]
    v_pk_mul_f32 v[82:83], v[82:83], v[190:191]
    v_pk_mul_f32 v[84:85], v[84:85], v[192:193]
    v_pk_mul_f32 v[86:87], v[86:87], v[194:195]
    v_pk_add_f32 v[184:185], v[184:185], v[80:81]
    v_pk_fma_f32 v[186:187], v[80:81], v[80:81], v[186:187]
    v_pk_add_f32 v[184:185], v[184:185], v[82:83]
    v_pk_fma_f32 v[186:187], v[82:83], v[82:83], v[186:187]
    v_pk_add_f32 v[184:185], v[184:185], v[84:85]
    v_pk_fma_f32 v[186:187], v[84:85], v[84:85], v[186:187]
    v_pk_add_f32 v[184:185], v[184:185], v[86:87]
    v_pk_fma_f32 v[186:187], v[86:87], v[86:87], v[186:187]
    v_add_f32 v8, v184, v185
    v_add_f32 v9, v186, v187
    v_mov_b32 v10, v8
    v_mov_b32 v11, v9
    s_nop 1
    v_permlane32_swap_b32 v8, v10
    v_permlane32_swap_b32 v9, v11
    s_nop 1
    v_add_f32 v8, v8, v10
    v_add_f32 v9, v9, v11
    v_and_b32 v9, 0x7fffffff, v9
    s_waitcnt vmcnt(0)
    buffer_store_dwordx2 v[8:9], v7, s[32:35], 0 offen sc1
    s_mul_i32 s5, s24, 24
    s_add_u32 s5, s5, s26
    s_lshl_b32 s5, s5, 8
    s_add_u32 s5, s5, 2949120
    v_lshl_add_u32 v12, v2, 3, s5
    v_mul_u32_u24 v13, 3072, v3
    v_add_u32 v12, v12, v13
    v_mul_u32_u24 v14, 304, v2
    v_lshl_add_u32 v14, v3, 4, v14
    v_add_u32 v14, s53, v14
    v_lshrrev_b32 v13, 4, v1
    v_bfe_u32 v240, v1, 2, 2
    v_lshl_add_u32 v240, v13, 3, v240
    v_mul_u32_u24 v240, 304, v240
    v_and_b32 v10, 1, v1
    v_lshl_add_u32 v240, v10, 4, v240
    v_bfe_u32 v10, v1, 1, 1
    v_lshl_add_u32 v240, v10, 3, v240
    v_add_u32 v240, s53, v240
    v_lshlrev_b32 v241, 9, v13
    v_and_b32 v10, 15, v1
    v_lshl_add_u32 v241, v10, 4, v241
    s_lshl_b32 s6, s27, 11
    s_add_u32 s6, s6, 18874368
    v_add_u32 v241, s6, v241
    s_sub_u32 s7, s25, 10
    s_mul_i32 s7, s7, 9
K1_POLL1:
    v_add_u32 v10, -1, v5
    v_and_b32 v10, 0x800000ff, v10
    v_cmp_ne_u32 vcc, 0xff, v10
    s_cbranch_vccz K1_POLL2
    s_cmp_eq_u32 s96, 0
    s_cbranch_scc1 K1_POLL2
    s_sub_u32 s96, s96, 1
    s_sleep 4
    global_load_dword v5, v4, s[20:21] sc1
    s_waitcnt vmcnt(0)
    s_branch K1_POLL1
K1_POLL2:
    buffer_load_dwordx2 v[188:189], v12, s[32:35], 0 offen offset:0 sc1
    buffer_load_dwordx2 v[190:191], v12, s[32:35], 0 offen offset:1024 sc1
    buffer_load_dwordx2 v[192:193], v12, s[32:35], 0 offen offset:2048 sc1
    s_waitcnt vmcnt(0)
    v_or3_b32 v13, v189, v191, v193
    v_cmp_gt_i32 vcc, 0, v13
    s_cbranch_vccz K1_POLL3
    s_cmp_eq_u32 s96, 0
    s_cbranch_scc1 K1_POLL3
    s_sub_u32 s96, s96, 1
    s_sleep 3
    s_branch K1_POLL2
K1_POLL3:
    v_add_f32 v8, v188, v190
    v_add_f32 v9, v189, v191
    v_add_f32 v8, v8, v192
    v_add_f32 v9, v9, v193
    v_mov_b32 v10, v8
    v_mov_b32 v11, v9
    s_nop 1
    v_permlane32_swap_b32 v8, v10
    v_permlane32_swap_b32 v9, v11
    s_nop 1
    v_add_f32 v8, v8, v10
    v_add_f32 v9, v9, v11
    v_mul_f32 v8, 0x3a97b426, v8
    v_mul_f32 v9, 0x3a97b426, v9
    v_fma_f32 v9, -v8, v8, v9
    v_max_f32 v9, 0, v9
    v_add_f32 v9, 0x3727c5ac, v9
    v_rsq_f32 v10, v9
    s_nop 0
    v_mul_f32 v12, v8, v10
    v_sub_f32 v12, 0, v12
    v_mov_b32 v11, v10
    v_mov_b32 v13, v12
    v_pk_fma_f32 v[16:17], v[16:17], v[10:11], v[12:13]
    v_pk_fma_f32 v[18:19], v[18:19], v[10:11], v[12:13]
    v_pk_fma_f32 v[20:21], v[20:21], v[10:11], v[12:13]
    v_pk_fma_f32 v[22:23], v[22:23], v[10:11], v[12:13]
    v_cvt_pk_bf16_f32 v196, v16, v17
    v_cvt_pk_bf16_f32 v197, v18, v19
    v_cvt_pk_bf16_f32 v198, v20, v21
    v_cvt_pk_bf16_f32 v199, v22, v23
    ds_write_b128 v14, v[196:199] offset:0
    ds_read_b64_tr_b16 v[16:17], v240 offset:0
    ds_read_b64_tr_b16 v[18:19], v240 offset:1216
    v_pk_fma_f32 v[24:25], v[24:25], v[10:11], v[12:13]
    v_pk_fma_f32 v[26:27], v[26:27], v[10:11], v[12:13]
    v_pk_fma_f32 v[28:29], v[28:29], v[10:11], v[12:13]
    v_pk_fma_f32 v[30:31], v[30:31], v[10:11], v[12:13]
    v_cvt_pk_bf16_f32 v200, v24, v25
    v_cvt_pk_bf16_f32 v201, v26, v27
    v_cvt_pk_bf16_f32 v202, v28, v29
    v_cvt_pk_bf16_f32 v203, v30, v31
    ds_write_b128 v14, v[200:203] offset:32
    ds_read_b64_tr_b16 v[20:21], v240 offset:32
    ds_read_b64_tr_b16 v[22:23], v240 offset:1248
    v_pk_fma_f32 v[32:33], v[32:33], v[10:11], v[12:13]
    v_pk_fma_f32 v[34:35], v[34:35], v[10:11], v[12:13]
    v_pk_fma_f32 v[36:37], v[36:37], v[10:11], v[12:13]
    v_pk_fma_f32 v[38:39], v[38:39], v[10:11], v[12:13]
    v_cvt_pk_bf16_f32 v204, v32, v33
    v_cvt_pk_bf16_f32 v205, v34, v35
    v_cvt_pk_bf16_f32 v206, v36, v37
    v_cvt_pk_bf16_f32 v207, v38, v39
    ds_write_b128 v14, v[204:207] offset:64
    ds_read_b64_tr_b16 v[24:25], v240 offset:64
    ds_read_b64_tr_b16 v[26:27], v240 offset:1280
    s_waitcnt lgkmcnt(6)
    s_add_u32 s5, s7, 0
    s_lshr_b32 s6, s5, 1
    s_lshl_b32 s6, s6, 17
    s_and_b32 s5, s5, 1
    s_lshl_b32 s5, s5, 8
    s_add_u32 s5, s5, s6
    buffer_store_dwordx4 v[16:19], v241, s[32:35], s5 offen sc1
    v_pk_fma_f32 v[40:41], v[40:41], v[10:11], v[12:13]
    v_pk_fma_f32 v[42:43], v[42:43], v[10:11], v[12:13]
    v_pk_fma_f32 v[44:45], v[44:45], v[10:11], v[12:13]
    v_pk_fma_f32 v[46:47], v[46:47], v[10:11], v[12:13]
    v_cvt_pk_bf16_f32 v208, v40, v41
    v_cvt_pk_bf16_f32 v209, v42, v43
    v_cvt_pk_bf16_f32 v210, v44, v45
    v_cvt_pk_bf16_f32 v211, v46, v47
    ds_write_b128 v14, v[208:211] offset:96
    ds_read_b64_tr_b16 v[28:29], v240 offset:96
    ds_read_b64_tr_b16 v[30:31], v240 offset:1312
    s_waitcnt lgkmcnt(6)
    s_add_u32 s5, s7, 1
    s_lshr_b32 s6, s5, 1
    s_lshl_b32 s6, s6, 17
    s_and_b32 s5, s5, 1
    s_lshl_b32 s5, s5, 8
    s_add_u32 s5, s5, s6
    buffer_store_dwordx4 v[20:23], v241, s[32:35], s5 offen sc1
    v_pk_fma_f32 v[48:49], v[48:49], v[10:11], v[12:13]
    v_pk_fma_f32 v[50:51], v[50:51], v[10:11], v[12:13]
    v_pk_fma_f32 v[52:53], v[52:53], v[10:11], v[12:13]
    v_pk_fma_f32 v[54:55], v[54:55], v[10:11], v[12:13]
    v_cvt_pk_bf16_f32 v212, v48, v49
    v_cvt_pk_bf16_f32 v213, v50, v51
    v_cvt_pk_bf16_f32 v214, v52, v53
    v_cvt_pk_bf16_f32 v215, v54, v55
    ds_write_b128 v14, v[212:215] offset:128
    ds_read_b64_tr_b16 v[32:33], v240 offset:128
    ds_read_b64_tr_b16 v[34:35], v240 offset:1344
    s_waitcnt lgkmcnt(6)
    s_add_u32 s5, s7, 2
    s_lshr_b32 s6, s5, 1
    s_lshl_b32 s6, s6, 17
    s_and_b32 s5, s5, 1
    s_lshl_b32 s5, s5, 8
    s_add_u32 s5, s5, s6
    buffer_store_dwordx4 v[24:27], v241, s[32:35], s5 offen sc1
    v_pk_fma_f32 v[56:57], v[56:57], v[10:11], v[12:13]
    v_pk_fma_f32 v[58:59], v[58:59], v[10:11], v[12:13]
    v_pk_fma_f32 v[60:61], v[60:61], v[10:11], v[12:13]
    v_pk_fma_f32 v[62:63], v[62:63], v[10:11], v[12:13]
    v_cvt_pk_bf16_f32 v216, v56, v57
    v_cvt_pk_bf16_f32 v217, v58, v59
    v_cvt_pk_bf16_f32 v218, v60, v61
    v_cvt_pk_bf16_f32 v219, v62, v63
    ds_write_b128 v14, v[216:219] offset:160
    ds_read_b64_tr_b16 v[36:37], v240 offset:160
    ds_read_b64_tr_b16 v[38:39], v240 offset:1376
    s_waitcnt lgkmcnt(6)
    s_add_u32 s5, s7, 3
    s_lshr_b32 s6, s5, 1
    s_lshl_b32 s6, s6, 17
    s_and_b32 s5, s5, 1
    s_lshl_b32 s5, s5, 8
    s_add_u32 s5, s5, s6
    buffer_store_dwordx4 v[28:31], v241, s[32:35], s5 offen sc1
    v_pk_fma_f32 v[64:65], v[64:65], v[10:11], v[12:13]
    v_pk_fma_f32 v[66:67], v[66:67], v[10:11], v[12:13]
    v_pk_fma_f32 v[68:69], v[68:69], v[10:11], v[12:13]
    v_pk_fma_f32 v[70:71], v[70:71], v[10:11], v[12:13]
    v_cvt_pk_bf16_f32 v220, v64, v65
    v_cvt_pk_bf16_f32 v221, v66, v67
    v_cvt_pk_bf16_f32 v222, v68, v69
    v_cvt_pk_bf16_f32 v223, v70, v71
    ds_write_b128 v14, v[220:223] offset:192
    ds_read_b64_tr_b16 v[40:41], v240 offset:192
    ds_read_b64_tr_b16 v[42:43], v240 offset:1408
    s_waitcnt lgkmcnt(6)
    s_add_u32 s5, s7, 4
    s_lshr_b32 s6, s5, 1
    s_lshl_b32 s6, s6, 17
    s_and_b32 s5, s5, 1
    s_lshl_b32 s5, s5, 8
    s_add_u32 s5, s5, s6
    buffer_store_dwordx4 v[32:35], v241, s[32:35], s5 offen sc1
    v_pk_fma_f32 v[72:73], v[72:73], v[10:11], v[12:13]
    v_pk_fma_f32 v[74:75], v[74:75], v[10:11], v[12:13]
    v_pk_fma_f32 v[76:77], v[76:77], v[10:11], v[12:13]
    v_pk_fma_f32 v[78:79], v[78:79], v[10:11], v[12:13]
    v_cvt_pk_bf16_f32 v224, v72, v73
    v_cvt_pk_bf16_f32 v225, v74, v75
    v_cvt_pk_bf16_f32 v226, v76, v77
    v_cvt_pk_bf16_f32 v227, v78, v79
    ds_write_b128 v14, v[224:227] offset:224
    ds_read_b64_tr_b16 v[44:45], v240 offset:224
    ds_read_b64_tr_b16 v[46:47], v240 offset:1440
    s_waitcnt lgkmcnt(6)
    s_add_u32 s5, s7, 5
    s_lshr_b32 s6, s5, 1
    s_lshl_b32 s6, s6, 17
    s_and_b32 s5, s5, 1
    s_lshl_b32 s5, s5, 8
    s_add_u32 s5, s5, s6
    buffer_store_dwordx4 v[36:39], v241, s[32:35], s5 offen sc1
    v_pk_fma_f32 v[80:81], v[80:81], v[10:11], v[12:13]
    v_pk_fma_f32 v[82:83], v[82:83], v[10:11], v[12:13]
    v_pk_fma_f32 v[84:85], v[84:85], v[10:11], v[12:13]
    v_pk_fma_f32 v[86:87], v[86:87], v[10:11], v[12:13]
    v_cvt_pk_bf16_f32 v228, v80, v81
    v_cvt_pk_bf16_f32 v229, v82, v83
    v_cvt_pk_bf16_f32 v230, v84, v85
    v_cvt_pk_bf16_f32 v231, v86, v87
    ds_write_b128 v14, v[228:231] offset:256
    ds_read_b64_tr_b16 v[48:49], v240 offset:256
    ds_read_b64_tr_b16 v[50:51], v240 offset:1472
    s_waitcnt lgkmcnt(6)
    s_add_u32 s5, s7, 6
    s_lshr_b32 s6, s5, 1
    s_lshl_b32 s6, s6, 17
    s_and_b32 s5, s5, 1
    s_lshl_b32 s5, s5, 8
    s_add_u32 s5, s5, s6
    buffer_store_dwordx4 v[40:43], v241, s[32:35], s5 offen sc1
    s_waitcnt lgkmcnt(3)
    s_add_u32 s5, s7, 7
    s_lshr_b32 s6, s5, 1
    s_lshl_b32 s6, s6, 17
    s_and_b32 s5, s5, 1
    s_lshl_b32 s5, s5, 8
    s_add_u32 s5, s5, s6
    buffer_store_dwordx4 v[44:47], v241, s[32:35], s5 offen sc1
    s_waitcnt lgkmcnt(0)
    s_add_u32 s5, s7, 8
    s_lshr_b32 s6, s5, 1
    s_lshl_b32 s6, s6, 17
    s_and_b32 s5, s5, 1
    s_lshl_b32 s5, s5, 8
    s_add_u32 s5, s5, s6
    buffer_store_dwordx4 v[48:51], v241, s[32:35], s5 offen sc1
    s_branch T_SETUP
K1_EXIT:
    s_endpgm
K1_LOOP_Q:
    s_barrier
    s_cmp_lg_u32 s26, 0
    s_cbranch_scc1 K1_NOC1_2
    s_mov_b64 exec, 1
    global_atomic_add v9, v10, s[20:21] sc1
    s_mov_b64 exec, -1
K1_NOC1_2:
    ds_read_b128 v[136:139], v164 offset:0
    ds_read_b64_tr_b16 v[96:97], v160 offset:0
    ds_read_b64_tr_b16 v[98:99], v160 offset:1280
    ds_read_b64_tr_b16 v[100:101], v160 offset:80
    ds_read_b64_tr_b16 v[102:103], v160 offset:1360
    ds_read_b64_tr_b16 v[104:105], v160 offset:160
    ds_read_b64_tr_b16 v[106:107], v160 offset:1440
    ds_read_b64_tr_b16 v[108:109], v160 offset:240
    ds_read_b64_tr_b16 v[110:111], v160 offset:1520
    ds_read_b64_tr_b16 v[112:113], v162 offset:0
    ds_read_b64_tr_b16 v[114:115], v162 offset:1280
    s_waitcnt lgkmcnt(8)
    v_mfma_f32_32x32x16_bf16 v[16:31], v[96:99], v[136:139], 0
    ds_read_b128 v[140:143], v165 offset:0
    ds_read_b64_tr_b16 v[116:117], v160 offset:5120
    ds_read_b64_tr_b16 v[118:119], v160 offset:6400
    s_waitcnt lgkmcnt(9)
    v_mfma_f32_32x32x16_bf16 v[32:47], v[100:103], v[136:139], 0
    ds_read_b64_tr_b16 v[120:121], v160 offset:5200
    ds_read_b64_tr_b16 v[122:123], v160 offset:6480
    s_waitcnt lgkmcnt(9)
    v_mfma_f32_32x32x16_bf16 v[48:63], v[104:107], v[136:139], 0
    ds_read_b64_tr_b16 v[124:125], v160 offset:5280
    ds_read_b64_tr_b16 v[126:127], v160 offset:6560
    s_waitcnt lgkmcnt(9)
    v_mfma_f32_32x32x16_bf16 v[64:79], v[108:111], v[136:139], 0
    ds_read_b64_tr_b16 v[128:129], v160 offset:5360
    ds_read_b64_tr_b16 v[130:131], v160 offset:6640
    s_waitcnt lgkmcnt(9)
    v_mfma_f32_32x32x16_bf16 v[80:95], v[112:115], v[136:139], 0
    ds_read_b64_tr_b16 v[132:133], v162 offset:5120
    ds_read_b64_tr_b16 v[134:135], v162 offset:6400
    s_waitcnt lgkmcnt(8)
    v_mfma_f32_32x32x16_bf16 v[16:31], v[116:119], v[140:143], v[16:31]
    ds_read_b128 v[136:139], v166 offset:0
    ds_read_b64_tr_b16 v[96:97], v160 offset:10240
    ds_read_b64_tr_b16 v[98:99], v160 offset:11520
    s_waitcnt lgkmcnt(9)
    v_mfma_f32_32x32x16_bf16 v[32:47], v[120:123], v[140:143], v[32:47]
    ds_read_b64_tr_b16 v[100:101], v160 offset:10320
    ds_read_b64_tr_b16 v[102:103], v160 offset:11600
    s_waitcnt lgkmcnt(9)
    v_mfma_f32_32x32x16_bf16 v[48:63], v[124:127], v[140:143], v[48:63]
    ds_read_b64_tr_b16 v[104:105], v160 offset:10400
    ds_read_b64_tr_b16 v[106:107], v160 offset:11680
    s_waitcnt lgkmcnt(9)
    v_mfma_f32_32x32x16_bf16 v[64:79], v[128:131], v[140:143], v[64:79]
    ds_read_b64_tr_b16 v[108:109], v160 offset:10480
    ds_read_b64_tr_b16 v[110:111], v160 offset:11760
    s_waitcnt lgkmcnt(9)
    v_mfma_f32_32x32x16_bf16 v[80:95], v[132:135], v[140:143], v[80:95]
    ds_read_b64_tr_b16 v[112:113], v162 offset:10240
    ds_read_b64_tr_b16 v[114:115], v162 offset:11520
    s_waitcnt lgkmcnt(8)
    v_mfma_f32_32x32x16_bf16 v[16:31], v[96:99], v[136:139], v[16:31]
    ds_read_b128 v[140:143], v167 offset:0
    ds_read_b64_tr_b16 v[116:117], v160 offset:15360
    ds_read_b64_tr_b16 v[118:119], v160 offset:16640
    s_waitcnt lgkmcnt(9)
    v_mfma_f32_32x32x16_bf16 v[32:47], v[100:103], v[136:139], v[32:47]
    ds_read_b64_tr_b16 v[120:121], v160 offset:15440
    ds_read_b64_tr_b16 v[122:123], v160 offset:16720
    s_waitcnt lgkmcnt(9)
    v_mfma_f32_32x32x16_bf16 v[48:63], v[104:107], v[136:139], v[48:63]
    ds_read_b64_tr_b16 v[124:125], v160 offset:15520
    ds_read_b64_tr_b16 v[126:127], v160 offset:16800
    s_waitcnt lgkmcnt(9)
    v_mfma_f32_32x32x16_bf16 v[64:79], v[108:111], v[136:139], v[64:79]
    ds_read_b64_tr_b16 v[128:129], v160 offset:15600
    ds_read_b64_tr_b16 v[130:131], v160 offset:16880
    s_waitcnt lgkmcnt(9)
    v_mfma_f32_32x32x16_bf16 v[80:95], v[112:115], v[136:139], v[80:95]
    ds_read_b64_tr_b16 v[132:133], v162 offset:15360
    ds_read_b64_tr_b16 v[134:135], v162 offset:16640
    s_barrier
    s_waitcnt lgkmcnt(8)
    v_mfma_f32_32x32x16_bf16 v[16:31], v[116:119], v[140:143], v[16:31]
    ds_read_b128 v[136:139], v164 offset:4096
    ds_read_b64_tr_b16 v[96:97], v160 offset:23040
    ds_read_b64_tr_b16 v[98:99], v160 offset:24320
    s_waitcnt lgkmcnt(9)
    v_mfma_f32_32x32x16_bf16 v[32:47], v[120:123], v[140:143], v[32:47]
    ds_read_b64_tr_b16 v[100:101], v160 offset:23120
    ds_read_b64_tr_b16 v[102:103], v160 offset:24400
    s_waitcnt lgkmcnt(9)
    v_mfma_f32_32x32x16_bf16 v[48:63], v[124:127], v[140:143], v[48:63]
    ds_read_b64_tr_b16 v[104:105], v160 offset:23200
    ds_read_b64_tr_b16 v[106:107], v160 offset:24480
    s_waitcnt lgkmcnt(9)
    v_mfma_f32_32x32x16_bf16 v[64:79], v[128:131], v[140:143], v[64:79]
    ds_read_b64_tr_b16 v[108:109], v160 offset:23280
    ds_read_b64_tr_b16 v[110:111], v160 offset:24560
    s_waitcnt lgkmcnt(9)
    v_mfma_f32_32x32x16_bf16 v[80:95], v[132:135], v[140:143], v[80:95]
    ds_read_b64_tr_b16 v[112:113], v162 offset:23040
    ds_read_b64_tr_b16 v[114:115], v162 offset:24320
    s_waitcnt lgkmcnt(8)
    v_mfma_f32_32x32x16_bf16 v[16:31], v[96:99], v[136:139], v[16:31]
    ds_read_b128 v[140:143], v165 offset:4096
    ds_read_b64_tr_b16 v[116:117], v160 offset:28160
    ds_read_b64_tr_b16 v[118:119], v160 offset:29440
    s_waitcnt lgkmcnt(9)
    v_mfma_f32_32x32x16_bf16 v[32:47], v[100:103], v[136:139], v[32:47]
    ds_read_b64_tr_b16 v[120:121], v160 offset:28240
    ds_read_b64_tr_b16 v[122:123], v160 offset:29520
    s_waitcnt lgkmcnt(9)
    v_mfma_f32_32x32x16_bf16 v[48:63], v[104:107], v[136:139], v[48:63]
    ds_read_b64_tr_b16 v[124:125], v160 offset:28320
    ds_read_b64_tr_b16 v[126:127], v160 offset:29600
    s_waitcnt lgkmcnt(9)
    v_mfma_f32_32x32x16_bf16 v[64:79], v[108:111], v[136:139], v[64:79]
    ds_read_b64_tr_b16 v[128:129], v160 offset:28400
    ds_read_b64_tr_b16 v[130:131], v160 offset:29680
    s_waitcnt lgkmcnt(9)
    v_mfma_f32_32x32x16_bf16 v[80:95], v[112:115], v[136:139], v[80:95]
    ds_read_b64_tr_b16 v[132:133], v162 offset:28160
    ds_read_b64_tr_b16 v[134:135], v162 offset:29440
    s_waitcnt lgkmcnt(8)
    v_mfma_f32_32x32x16_bf16 v[16:31], v[116:119], v[140:143], v[16:31]
    ds_read_b128 v[136:139], v166 offset:4096
    ds_read_b64_tr_b16 v[96:97], v160 offset:33280
    ds_read_b64_tr_b16 v[98:99], v160 offset:34560
    s_waitcnt lgkmcnt(9)
    v_mfma_f32_32x32x16_bf16 v[32:47], v[120:123], v[140:143], v[32:47]
    ds_read_b64_tr_b16 v[100:101], v160 offset:33360
    ds_read_b64_tr_b16 v[102:103], v160 offset:34640
    s_waitcnt lgkmcnt(9)
    v_mfma_f32_32x32x16_bf16 v[48:63], v[124:127], v[140:143], v[48:63]
    ds_read_b64_tr_b16 v[104:105], v160 offset:33440
    ds_read_b64_tr_b16 v[106:107], v160 offset:34720
    s_waitcnt lgkmcnt(9)
    v_mfma_f32_32x32x16_bf16 v[64:79], v[128:131], v[140:143], v[64:79]
    ds_read_b64_tr_b16 v[108:109], v160 offset:33520
    ds_read_b64_tr_b16 v[110:111], v160 offset:34800
    s_waitcnt lgkmcnt(9)
    v_mfma_f32_32x32x16_bf16 v[80:95], v[132:135], v[140:143], v[80:95]
    ds_read_b64_tr_b16 v[112:113], v162 offset:33280
    ds_read_b64_tr_b16 v[114:115], v162 offset:34560
    s_waitcnt lgkmcnt(8)
    v_mfma_f32_32x32x16_bf16 v[16:31], v[96:99], v[136:139], v[16:31]
    ds_read_b128 v[140:143], v167 offset:4096
    ds_read_b64_tr_b16 v[116:117], v160 offset:38400
    ds_read_b64_tr_b16 v[118:119], v160 offset:39680
    s_waitcnt lgkmcnt(9)
    v_mfma_f32_32x32x16_bf16 v[32:47], v[100:103], v[136:139], v[32:47]
    ds_read_b64_tr_b16 v[120:121], v160 offset:38480
    ds_read_b64_tr_b16 v[122:123], v160 offset:39760
    s_waitcnt lgkmcnt(9)
    v_mfma_f32_32x32x16_bf16 v[48:63], v[104:107], v[136:139], v[48:63]
    ds_read_b64_tr_b16 v[124:125], v160 offset:38560
    ds_read_b64_tr_b16 v[126:127], v160 offset:39840
    s_waitcnt lgkmcnt(9)
    v_mfma_f32_32x32x16_bf16 v[64:79], v[108:111], v[136:139], v[64:79]
    ds_read_b64_tr_b16 v[128:129], v160 offset:38640
    ds_read_b64_tr_b16 v[130:131], v160 offset:39920
    s_waitcnt lgkmcnt(9)
    v_mfma_f32_32x32x16_bf16 v[80:95], v[112:115], v[136:139], v[80:95]
    ds_read_b64_tr_b16 v[132:133], v162 offset:38400
    ds_read_b64_tr_b16 v[134:135], v162 offset:39680
    s_barrier
    s_waitcnt lgkmcnt(8)
    v_mfma_f32_32x32x16_bf16 v[16:31], v[116:119], v[140:143], v[16:31]
    ds_read_b128 v[136:139], v164 offset:8192
    ds_read_b64_tr_b16 v[96:97], v161 offset:0
    ds_read_b64_tr_b16 v[98:99], v161 offset:1280
    s_waitcnt lgkmcnt(9)
    v_mfma_f32_32x32x16_bf16 v[32:47], v[120:123], v[140:143], v[32:47]
    ds_read_b64_tr_b16 v[100:101], v161 offset:80
    ds_read_b64_tr_b16 v[102:103], v161 offset:1360
    s_waitcnt lgkmcnt(9)
    v_mfma_f32_32x32x16_bf16 v[48:63], v[124:127], v[140:143], v[48:63]
    ds_read_b64_tr_b16 v[104:105], v161 offset:160
    ds_read_b64_tr_b16 v[106:107], v161 offset:1440
    s_waitcnt lgkmcnt(9)
    v_mfma_f32_32x32x16_bf16 v[64:79], v[128:131], v[140:143], v[64:79]
    ds_read_b64_tr_b16 v[108:109], v161 offset:240
    ds_read_b64_tr_b16 v[110:111], v161 offset:1520
    s_waitcnt lgkmcnt(9)
    v_mfma_f32_32x32x16_bf16 v[80:95], v[132:135], v[140:143], v[80:95]
    ds_read_b64_tr_b16 v[112:113], v163 offset:0
    ds_read_b64_tr_b16 v[114:115], v163 offset:1280
    s_waitcnt lgkmcnt(8)
    v_mfma_f32_32x32x16_bf16 v[16:31], v[96:99], v[136:139], v[16:31]
    ds_read_b128 v[140:143], v165 offset:8192
    ds_read_b64_tr_b16 v[116:117], v161 offset:5120
    ds_read_b64_tr_b16 v[118:119], v161 offset:6400
    s_waitcnt lgkmcnt(9)
    v_mfma_f32_32x32x16_bf16 v[32:47], v[100:103], v[136:139], v[32:47]
    ds_read_b64_tr_b16 v[120:121], v161 offset:5200
    ds_read_b64_tr_b16 v[122:123], v161 offset:6480
    s_waitcnt lgkmcnt(9)
    v_mfma_f32_32x32x16_bf16 v[48:63], v[104:107], v[136:139], v[48:63]
    ds_read_b64_tr_b16 v[124:125], v161 offset:5280
    ds_read_b64_tr_b16 v[126:127], v161 offset:6560
    s_waitcnt lgkmcnt(9)
    v_mfma_f32_32x32x16_bf16 v[64:79], v[108:111], v[136:139], v[64:79]
    ds_read_b64_tr_b16 v[128:129], v161 offset:5360
    ds_read_b64_tr_b16 v[130:131], v161 offset:6640
    s_waitcnt lgkmcnt(9)
    v_mfma_f32_32x32x16_bf16 v[80:95], v[112:115], v[136:139], v[80:95]
    ds_read_b64_tr_b16 v[132:133], v163 offset:5120
    ds_read_b64_tr_b16 v[134:135], v163 offset:6400
    s_waitcnt lgkmcnt(8)
    v_mfma_f32_32x32x16_bf16 v[16:31], v[116:119], v[140:143], v[16:31]
    ds_read_b128 v[136:139], v166 offset:8192
    ds_read_b64_tr_b16 v[96:97], v161 offset:10240
    ds_read_b64_tr_b16 v[98:99], v161 offset:11520
    s_waitcnt lgkmcnt(9)
    v_mfma_f32_32x32x16_bf16 v[32:47], v[120:123], v[140:143], v[32:47]
    ds_read_b64_tr_b16 v[100:101], v161 offset:10320
    ds_read_b64_tr_b16 v[102:103], v161 offset:11600
    s_waitcnt lgkmcnt(9)
    v_mfma_f32_32x32x16_bf16 v[48:63], v[124:127], v[140:143], v[48:63]
    ds_read_b64_tr_b16 v[104:105], v161 offset:10400
    ds_read_b64_tr_b16 v[106:107], v161 offset:11680
    s_waitcnt lgkmcnt(9)
    v_mfma_f32_32x32x16_bf16 v[64:79], v[128:131], v[140:143], v[64:79]
    ds_read_b64_tr_b16 v[108:109], v161 offset:10480
    ds_read_b64_tr_b16 v[110:111], v161 offset:11760
    s_waitcnt lgkmcnt(9)
    v_mfma_f32_32x32x16_bf16 v[80:95], v[132:135], v[140:143], v[80:95]
    ds_read_b64_tr_b16 v[112:113], v163 offset:10240
    ds_read_b64_tr_b16 v[114:115], v163 offset:11520
    s_waitcnt lgkmcnt(8)
    v_mfma_f32_32x32x16_bf16 v[16:31], v[96:99], v[136:139], v[16:31]
    ds_read_b128 v[140:143], v167 offset:8192
    ds_read_b64_tr_b16 v[116:117], v161 offset:15360
    ds_read_b64_tr_b16 v[118:119], v161 offset:16640
    s_waitcnt lgkmcnt(9)
    v_mfma_f32_32x32x16_bf16 v[32:47], v[100:103], v[136:139], v[32:47]
    ds_read_b64_tr_b16 v[120:121], v161 offset:15440
    ds_read_b64_tr_b16 v[122:123], v161 offset:16720
    s_waitcnt lgkmcnt(9)
    v_mfma_f32_32x32x16_bf16 v[48:63], v[104:107], v[136:139], v[48:63]
    ds_read_b64_tr_b16 v[124:125], v161 offset:15520
    ds_read_b64_tr_b16 v[126:127], v161 offset:16800
    s_waitcnt lgkmcnt(9)
    v_mfma_f32_32x32x16_bf16 v[64:79], v[108:111], v[136:139], v[64:79]
    ds_read_b64_tr_b16 v[128:129], v161 offset:15600
    ds_read_b64_tr_b16 v[130:131], v161 offset:16880
    s_waitcnt lgkmcnt(9)
    v_mfma_f32_32x32x16_bf16 v[80:95], v[112:115], v[136:139], v[80:95]
    ds_read_b64_tr_b16 v[132:133], v163 offset:15360
    ds_read_b64_tr_b16 v[134:135], v163 offset:16640
    s_barrier
    s_waitcnt lgkmcnt(8)
    v_mfma_f32_32x32x16_bf16 v[16:31], v[116:119], v[140:143], v[16:31]
    ds_read_b128 v[136:139], v164 offset:12288
    ds_read_b64_tr_b16 v[96:97], v161 offset:23040
    ds_read_b64_tr_b16 v[98:99], v161 offset:24320
    s_waitcnt lgkmcnt(9)
    v_mfma_f32_32x32x16_bf16 v[32:47], v[120:123], v[140:143], v[32:47]
    ds_read_b64_tr_b16 v[100:101], v161 offset:23120
    ds_read_b64_tr_b16 v[102:103], v161 offset:24400
    s_waitcnt lgkmcnt(9)
    v_mfma_f32_32x32x16_bf16 v[48:63], v[124:127], v[140:143], v[48:63]
    ds_read_b64_tr_b16 v[104:105], v161 offset:23200
    ds_read_b64_tr_b16 v[106:107], v161 offset:24480
    s_waitcnt lgkmcnt(9)
    v_mfma_f32_32x32x16_bf16 v[64:79], v[128:131], v[140:143], v[64:79]
    ds_read_b64_tr_b16 v[108:109], v161 offset:23280
    ds_read_b64_tr_b16 v[110:111], v161 offset:24560
    s_waitcnt lgkmcnt(9)
    v_mfma_f32_32x32x16_bf16 v[80:95], v[132:135], v[140:143], v[80:95]
    ds_read_b64_tr_b16 v[112:113], v163 offset:23040
    ds_read_b64_tr_b16 v[114:115], v163 offset:24320
    s_waitcnt lgkmcnt(8)
    v_mfma_f32_32x32x16_bf16 v[16:31], v[96:99], v[136:139], v[16:31]
    ds_read_b128 v[140:143], v165 offset:12288
    ds_read_b64_tr_b16 v[116:117], v161 offset:28160
    ds_read_b64_tr_b16 v[118:119], v161 offset:29440
    s_waitcnt lgkmcnt(9)
    v_mfma_f32_32x32x16_bf16 v[32:47], v[100:103], v[136:139], v[32:47]
    ds_read_b64_tr_b16 v[120:121], v161 offset:28240
    ds_read_b64_tr_b16 v[122:123], v161 offset:29520
    s_waitcnt lgkmcnt(9)
    v_mfma_f32_32x32x16_bf16 v[48:63], v[104:107], v[136:139], v[48:63]
    ds_read_b64_tr_b16 v[124:125], v161 offset:28320
    ds_read_b64_tr_b16 v[126:127], v161 offset:29600
    s_waitcnt lgkmcnt(9)
    v_mfma_f32_32x32x16_bf16 v[64:79], v[108:111], v[136:139], v[64:79]
    ds_read_b64_tr_b16 v[128:129], v161 offset:28400
    ds_read_b64_tr_b16 v[130:131], v161 offset:29680
    s_waitcnt lgkmcnt(9)
    v_mfma_f32_32x32x16_bf16 v[80:95], v[112:115], v[136:139], v[80:95]
    ds_read_b64_tr_b16 v[132:133], v163 offset:28160
    ds_read_b64_tr_b16 v[134:135], v163 offset:29440
    s_waitcnt lgkmcnt(8)
    v_mfma_f32_32x32x16_bf16 v[16:31], v[116:119], v[140:143], v[16:31]
    ds_read_b128 v[136:139], v166 offset:12288
    ds_read_b64_tr_b16 v[96:97], v161 offset:33280
    ds_read_b64_tr_b16 v[98:99], v161 offset:34560
    s_waitcnt lgkmcnt(9)
    v_mfma_f32_32x32x16_bf16 v[32:47], v[120:123], v[140:143], v[32:47]
    ds_read_b64_tr_b16 v[100:101], v161 offset:33360
    ds_read_b64_tr_b16 v[102:103], v161 offset:34640
    s_waitcnt lgkmcnt(9)
    v_mfma_f32_32x32x16_bf16 v[48:63], v[124:127], v[140:143], v[48:63]
    ds_read_b64_tr_b16 v[104:105], v161 offset:33440
    ds_read_b64_tr_b16 v[106:107], v161 offset:34720
    s_waitcnt lgkmcnt(9)
    v_mfma_f32_32x32x16_bf16 v[64:79], v[128:131], v[140:143], v[64:79]
    ds_read_b64_tr_b16 v[108:109], v161 offset:33520
    ds_read_b64_tr_b16 v[110:111], v161 offset:34800
    s_waitcnt lgkmcnt(9)
    v_mfma_f32_32x32x16_bf16 v[80:95], v[132:135], v[140:143], v[80:95]
    ds_read_b64_tr_b16 v[112:113], v163 offset:33280
    ds_read_b64_tr_b16 v[114:115], v163 offset:34560
    s_waitcnt lgkmcnt(8)
    v_mfma_f32_32x32x16_bf16 v[16:31], v[96:99], v[136:139], v[16:31]
    ds_read_b128 v[140:143], v167 offset:12288
    ds_read_b64_tr_b16 v[116:117], v161 offset:38400
    ds_read_b64_tr_b16 v[118:119], v161 offset:39680
    s_waitcnt lgkmcnt(9)
    v_mfma_f32_32x32x16_bf16 v[32:47], v[100:103], v[136:139], v[32:47]
    ds_read_b64_tr_b16 v[120:121], v161 offset:38480
    ds_read_b64_tr_b16 v[122:123], v161 offset:39760
    s_waitcnt lgkmcnt(9)
    v_mfma_f32_32x32x16_bf16 v[48:63], v[104:107], v[136:139], v[48:63]
    ds_read_b64_tr_b16 v[124:125], v161 offset:38560
    ds_read_b64_tr_b16 v[126:127], v161 offset:39840
    s_waitcnt lgkmcnt(9)
    v_mfma_f32_32x32x16_bf16 v[64:79], v[108:111], v[136:139], v[64:79]
    ds_read_b64_tr_b16 v[128:129], v161 offset:38640
    ds_read_b64_tr_b16 v[130:131], v161 offset:39920
    s_waitcnt lgkmcnt(9)
    v_mfma_f32_32x32x16_bf16 v[80:95], v[112:115], v[136:139], v[80:95]
    ds_read_b64_tr_b16 v[132:133], v163 offset:38400
    ds_read_b64_tr_b16 v[134:135], v163 offset:39680
    s_barrier
    s_waitcnt lgkmcnt(8)
    v_mfma_f32_32x32x16_bf16 v[16:31], v[116:119], v[140:143], v[16:31]
    ds_read_b128 v[136:139], v164 offset:0
    ds_read_b64_tr_b16 v[96:97], v160 offset:0
    ds_read_b64_tr_b16 v[98:99], v160 offset:1280
    s_waitcnt lgkmcnt(9)
    v_mfma_f32_32x32x16_bf16 v[32:47], v[120:123], v[140:143], v[32:47]
    ds_read_b64_tr_b16 v[100:101], v160 offset:80
    ds_read_b64_tr_b16 v[102:103], v160 offset:1360
    s_waitcnt lgkmcnt(9)
    v_mfma_f32_32x32x16_bf16 v[48:63], v[124:127], v[140:143], v[48:63]
    ds_read_b64_tr_b16 v[104:105], v160 offset:160
    ds_read_b64_tr_b16 v[106:107], v160 offset:1440
    s_waitcnt lgkmcnt(9)
    v_mfma_f32_32x32x16_bf16 v[64:79], v[128:131], v[140:143], v[64:79]
    ds_read_b64_tr_b16 v[108:109], v160 offset:240
    ds_read_b64_tr_b16 v[110:111], v160 offset:1520
    s_waitcnt lgkmcnt(9)
    v_mfma_f32_32x32x16_bf16 v[80:95], v[132:135], v[140:143], v[80:95]
    ds_read_b64_tr_b16 v[112:113], v162 offset:0
    ds_read_b64_tr_b16 v[114:115], v162 offset:1280
    s_waitcnt lgkmcnt(8)
    v_mfma_f32_32x32x16_bf16 v[16:31], v[96:99], v[136:139], v[16:31]
    ds_read_b128 v[140:143], v165 offset:0
    ds_read_b64_tr_b16 v[116:117], v160 offset:5120
    ds_read_b64_tr_b16 v[118:119], v160 offset:6400
    s_waitcnt lgkmcnt(9)
    v_mfma_f32_32x32x16_bf16 v[32:47], v[100:103], v[136:139], v[32:47]
    ds_read_b64_tr_b16 v[120:121], v160 offset:5200
    ds_read_b64_tr_b16 v[122:123], v160 offset:6480
    s_waitcnt lgkmcnt(9)
    v_mfma_f32_32x32x16_bf16 v[48:63], v[104:107], v[136:139], v[48:63]
    ds_read_b64_tr_b16 v[124:125], v160 offset:5280
    ds_read_b64_tr_b16 v[126:127], v160 offset:6560
    s_waitcnt lgkmcnt(9)
    v_mfma_f32_32x32x16_bf16 v[64:79], v[108:111], v[136:139], v[64:79]
    ds_read_b64_tr_b16 v[128:129], v160 offset:5360
    ds_read_b64_tr_b16 v[130:131], v160 offset:6640
    s_waitcnt lgkmcnt(9)
    v_mfma_f32_32x32x16_bf16 v[80:95], v[112:115], v[136:139], v[80:95]
    ds_read_b64_tr_b16 v[132:133], v162 offset:5120
    ds_read_b64_tr_b16 v[134:135], v162 offset:6400
    s_waitcnt lgkmcnt(8)
    v_mfma_f32_32x32x16_bf16 v[16:31], v[116:119], v[140:143], v[16:31]
    ds_read_b128 v[136:139], v166 offset:0
    ds_read_b64_tr_b16 v[96:97], v160 offset:10240
    ds_read_b64_tr_b16 v[98:99], v160 offset:11520
    s_waitcnt lgkmcnt(9)
    v_mfma_f32_32x32x16_bf16 v[32:47], v[120:123], v[140:143], v[32:47]
    ds_read_b64_tr_b16 v[100:101], v160 offset:10320
    ds_read_b64_tr_b16 v[102:103], v160 offset:11600
    s_waitcnt lgkmcnt(9)
    v_mfma_f32_32x32x16_bf16 v[48:63], v[124:127], v[140:143], v[48:63]
    ds_read_b64_tr_b16 v[104:105], v160 offset:10400
    ds_read_b64_tr_b16 v[106:107], v160 offset:11680
    s_waitcnt lgkmcnt(9)
    v_mfma_f32_32x32x16_bf16 v[64:79], v[128:131], v[140:143], v[64:79]
    ds_read_b64_tr_b16 v[108:109], v160 offset:10480
    ds_read_b64_tr_b16 v[110:111], v160 offset:11760
    s_waitcnt lgkmcnt(9)
    v_mfma_f32_32x32x16_bf16 v[80:95], v[132:135], v[140:143], v[80:95]
    ds_read_b64_tr_b16 v[112:113], v162 offset:10240
    ds_read_b64_tr_b16 v[114:115], v162 offset:11520
    s_waitcnt lgkmcnt(8)
    v_mfma_f32_32x32x16_bf16 v[16:31], v[96:99], v[136:139], v[16:31]
    ds_read_b128 v[140:143], v167 offset:0
    ds_read_b64_tr_b16 v[116:117], v160 offset:15360
    ds_read_b64_tr_b16 v[118:119], v160 offset:16640
    s_waitcnt lgkmcnt(9)
    v_mfma_f32_32x32x16_bf16 v[32:47], v[100:103], v[136:139], v[32:47]
    ds_read_b64_tr_b16 v[120:121], v160 offset:15440
    ds_read_b64_tr_b16 v[122:123], v160 offset:16720
    s_waitcnt lgkmcnt(9)
    v_mfma_f32_32x32x16_bf16 v[48:63], v[104:107], v[136:139], v[48:63]
    ds_read_b64_tr_b16 v[124:125], v160 offset:15520
    ds_read_b64_tr_b16 v[126:127], v160 offset:16800
    s_waitcnt lgkmcnt(9)
    v_mfma_f32_32x32x16_bf16 v[64:79], v[108:111], v[136:139], v[64:79]
    ds_read_b64_tr_b16 v[128:129], v160 offset:15600
    ds_read_b64_tr_b16 v[130:131], v160 offset:16880
    s_waitcnt lgkmcnt(9)
    v_mfma_f32_32x32x16_bf16 v[80:95], v[112:115], v[136:139], v[80:95]
    ds_read_b64_tr_b16 v[132:133], v162 offset:15360
    ds_read_b64_tr_b16 v[134:135], v162 offset:16640
    s_barrier
    s_waitcnt lgkmcnt(8)
    v_mfma_f32_32x32x16_bf16 v[16:31], v[116:119], v[140:143], v[16:31]
    ds_read_b128 v[136:139], v164 offset:4096
    ds_read_b64_tr_b16 v[96:97], v160 offset:23040
    ds_read_b64_tr_b16 v[98:99], v160 offset:24320
    s_waitcnt lgkmcnt(9)
    v_mfma_f32_32x32x16_bf16 v[32:47], v[120:123], v[140:143], v[32:47]
    ds_read_b64_tr_b16 v[100:101], v160 offset:23120
    ds_read_b64_tr_b16 v[102:103], v160 offset:24400
    s_waitcnt lgkmcnt(9)
    v_mfma_f32_32x32x16_bf16 v[48:63], v[124:127], v[140:143], v[48:63]
    ds_read_b64_tr_b16 v[104:105], v160 offset:23200
    ds_read_b64_tr_b16 v[106:107], v160 offset:24480
    s_waitcnt lgkmcnt(9)
    v_mfma_f32_32x32x16_bf16 v[64:79], v[128:131], v[140:143], v[64:79]
    ds_read_b64_tr_b16 v[108:109], v160 offset:23280
    ds_read_b64_tr_b16 v[110:111], v160 offset:24560
    s_waitcnt lgkmcnt(9)
    v_mfma_f32_32x32x16_bf16 v[80:95], v[132:135], v[140:143], v[80:95]
    ds_read_b64_tr_b16 v[112:113], v162 offset:23040
    ds_read_b64_tr_b16 v[114:115], v162 offset:24320
    s_waitcnt lgkmcnt(8)
    v_mfma_f32_32x32x16_bf16 v[16:31], v[96:99], v[136:139], v[16:31]
    ds_read_b128 v[140:143], v165 offset:4096
    ds_read_b64_tr_b16 v[116:117], v160 offset:28160
    ds_read_b64_tr_b16 v[118:119], v160 offset:29440
    s_waitcnt lgkmcnt(9)
    v_mfma_f32_32x32x16_bf16 v[32:47], v[100:103], v[136:139], v[32:47]
    ds_read_b64_tr_b16 v[120:121], v160 offset:28240
    ds_read_b64_tr_b16 v[122:123], v160 offset:29520
    s_waitcnt lgkmcnt(9)
    v_mfma_f32_32x32x16_bf16 v[48:63], v[104:107], v[136:139], v[48:63]
    ds_read_b64_tr_b16 v[124:125], v160 offset:28320
    ds_read_b64_tr_b16 v[126:127], v160 offset:29600
    s_waitcnt lgkmcnt(9)
    v_mfma_f32_32x32x16_bf16 v[64:79], v[108:111], v[136:139], v[64:79]
    ds_read_b64_tr_b16 v[128:129], v160 offset:28400
    ds_read_b64_tr_b16 v[130:131], v160 offset:29680
    s_waitcnt lgkmcnt(9)
    v_mfma_f32_32x32x16_bf16 v[80:95], v[112:115], v[136:139], v[80:95]
    ds_read_b64_tr_b16 v[132:133], v162 offset:28160
    ds_read_b64_tr_b16 v[134:135], v162 offset:29440
    s_waitcnt lgkmcnt(8)
    v_mfma_f32_32x32x16_bf16 v[16:31], v[116:119], v[140:143], v[16:31]
    ds_read_b128 v[136:139], v166 offset:4096
    ds_read_b64_tr_b16 v[96:97], v160 offset:33280
    ds_read_b64_tr_b16 v[98:99], v160 offset:34560
    s_waitcnt lgkmcnt(9)
    v_mfma_f32_32x32x16_bf16 v[32:47], v[120:123], v[140:143], v[32:47]
    ds_read_b64_tr_b16 v[100:101], v160 offset:33360
    ds_read_b64_tr_b16 v[102:103], v160 offset:34640
    s_waitcnt lgkmcnt(9)
    v_mfma_f32_32x32x16_bf16 v[48:63], v[124:127], v[140:143], v[48:63]
    ds_read_b64_tr_b16 v[104:105], v160 offset:33440
    ds_read_b64_tr_b16 v[106:107], v160 offset:34720
    s_waitcnt lgkmcnt(9)
    v_mfma_f32_32x32x16_bf16 v[64:79], v[128:131], v[140:143], v[64:79]
    ds_read_b64_tr_b16 v[108:109], v160 offset:33520
    ds_read_b64_tr_b16 v[110:111], v160 offset:34800
    s_waitcnt lgkmcnt(9)
    v_mfma_f32_32x32x16_bf16 v[80:95], v[132:135], v[140:143], v[80:95]
    ds_read_b64_tr_b16 v[112:113], v162 offset:33280
    ds_read_b64_tr_b16 v[114:115], v162 offset:34560
    s_waitcnt lgkmcnt(8)
    v_mfma_f32_32x32x16_bf16 v[16:31], v[96:99], v[136:139], v[16:31]
    ds_read_b128 v[140:143], v167 offset:4096
    ds_read_b64_tr_b16 v[116:117], v160 offset:38400
    ds_read_b64_tr_b16 v[118:119], v160 offset:39680
    s_waitcnt lgkmcnt(9)
    v_mfma_f32_32x32x16_bf16 v[32:47], v[100:103], v[136:139], v[32:47]
    ds_read_b64_tr_b16 v[120:121], v160 offset:38480
    ds_read_b64_tr_b16 v[122:123], v160 offset:39760
    s_waitcnt lgkmcnt(9)
    v_mfma_f32_32x32x16_bf16 v[48:63], v[104:107], v[136:139], v[48:63]
    ds_read_b64_tr_b16 v[124:125], v160 offset:38560
    ds_read_b64_tr_b16 v[126:127], v160 offset:39840
    s_waitcnt lgkmcnt(9)
    v_mfma_f32_32x32x16_bf16 v[64:79], v[108:111], v[136:139], v[64:79]
    ds_read_b64_tr_b16 v[128:129], v160 offset:38640
    ds_read_b64_tr_b16 v[130:131], v160 offset:39920
    s_waitcnt lgkmcnt(9)
    v_mfma_f32_32x32x16_bf16 v[80:95], v[112:115], v[136:139], v[80:95]
    ds_read_b64_tr_b16 v[132:133], v162 offset:38400
    ds_read_b64_tr_b16 v[134:135], v162 offset:39680
    s_barrier
    s_waitcnt lgkmcnt(8)
    v_mfma_f32_32x32x16_bf16 v[16:31], v[116:119], v[140:143], v[16:31]
    ds_read_b128 v[136:139], v164 offset:8192
    ds_read_b64_tr_b16 v[96:97], v161 offset:0
    ds_read_b64_tr_b16 v[98:99], v161 offset:1280
    s_waitcnt lgkmcnt(9)
    v_mfma_f32_32x32x16_bf16 v[32:47], v[120:123], v[140:143], v[32:47]
    ds_read_b64_tr_b16 v[100:101], v161 offset:80
    ds_read_b64_tr_b16 v[102:103], v161 offset:1360
    s_waitcnt lgkmcnt(9)
    v_mfma_f32_32x32x16_bf16 v[48:63], v[124:127], v[140:143], v[48:63]
    ds_read_b64_tr_b16 v[104:105], v161 offset:160
    ds_read_b64_tr_b16 v[106:107], v161 offset:1440
    s_waitcnt lgkmcnt(9)
    v_mfma_f32_32x32x16_bf16 v[64:79], v[128:131], v[140:143], v[64:79]
    ds_read_b64_tr_b16 v[108:109], v161 offset:240
    ds_read_b64_tr_b16 v[110:111], v161 offset:1520
    s_waitcnt lgkmcnt(9)
    v_mfma_f32_32x32x16_bf16 v[80:95], v[132:135], v[140:143], v[80:95]
    ds_read_b64_tr_b16 v[112:113], v163 offset:0
    ds_read_b64_tr_b16 v[114:115], v163 offset:1280
    s_waitcnt lgkmcnt(8)
    v_mfma_f32_32x32x16_bf16 v[16:31], v[96:99], v[136:139], v[16:31]
    ds_read_b128 v[140:143], v165 offset:8192
    ds_read_b64_tr_b16 v[116:117], v161 offset:5120
    ds_read_b64_tr_b16 v[118:119], v161 offset:6400
    s_waitcnt lgkmcnt(9)
    v_mfma_f32_32x32x16_bf16 v[32:47], v[100:103], v[136:139], v[32:47]
    ds_read_b64_tr_b16 v[120:121], v161 offset:5200
    ds_read_b64_tr_b16 v[122:123], v161 offset:6480
    s_waitcnt lgkmcnt(9)
    v_mfma_f32_32x32x16_bf16 v[48:63], v[104:107], v[136:139], v[48:63]
    ds_read_b64_tr_b16 v[124:125], v161 offset:5280
    ds_read_b64_tr_b16 v[126:127], v161 offset:6560
    s_waitcnt lgkmcnt(9)
    v_mfma_f32_32x32x16_bf16 v[64:79], v[108:111], v[136:139], v[64:79]
    ds_read_b64_tr_b16 v[128:129], v161 offset:5360
    ds_read_b64_tr_b16 v[130:131], v161 offset:6640
    s_waitcnt lgkmcnt(9)
    v_mfma_f32_32x32x16_bf16 v[80:95], v[112:115], v[136:139], v[80:95]
    ds_read_b64_tr_b16 v[132:133], v163 offset:5120
    ds_read_b64_tr_b16 v[134:135], v163 offset:6400
    s_waitcnt lgkmcnt(8)
    v_mfma_f32_32x32x16_bf16 v[16:31], v[116:119], v[140:143], v[16:31]
    ds_read_b128 v[136:139], v166 offset:8192
    ds_read_b64_tr_b16 v[96:97], v161 offset:10240
    ds_read_b64_tr_b16 v[98:99], v161 offset:11520
    s_waitcnt lgkmcnt(9)
    v_mfma_f32_32x32x16_bf16 v[32:47], v[120:123], v[140:143], v[32:47]
    ds_read_b64_tr_b16 v[100:101], v161 offset:10320
    ds_read_b64_tr_b16 v[102:103], v161 offset:11600
    s_waitcnt lgkmcnt(9)
    v_mfma_f32_32x32x16_bf16 v[48:63], v[124:127], v[140:143], v[48:63]
    ds_read_b64_tr_b16 v[104:105], v161 offset:10400
    ds_read_b64_tr_b16 v[106:107], v161 offset:11680
    s_waitcnt lgkmcnt(9)
    v_mfma_f32_32x32x16_bf16 v[64:79], v[128:131], v[140:143], v[64:79]
    ds_read_b64_tr_b16 v[108:109], v161 offset:10480
    ds_read_b64_tr_b16 v[110:111], v161 offset:11760
    s_waitcnt lgkmcnt(9)
    v_mfma_f32_32x32x16_bf16 v[80:95], v[132:135], v[140:143], v[80:95]
    ds_read_b64_tr_b16 v[112:113], v163 offset:10240
    ds_read_b64_tr_b16 v[114:115], v163 offset:11520
    s_waitcnt lgkmcnt(8)
    v_mfma_f32_32x32x16_bf16 v[16:31], v[96:99], v[136:139], v[16:31]
    ds_read_b128 v[140:143], v167 offset:8192
    ds_read_b64_tr_b16 v[116:117], v161 offset:15360
    ds_read_b64_tr_b16 v[118:119], v161 offset:16640
    s_waitcnt lgkmcnt(9)
    v_mfma_f32_32x32x16_bf16 v[32:47], v[100:103], v[136:139], v[32:47]
    ds_read_b64_tr_b16 v[120:121], v161 offset:15440
    ds_read_b64_tr_b16 v[122:123], v161 offset:16720
    s_waitcnt lgkmcnt(9)
    v_mfma_f32_32x32x16_bf16 v[48:63], v[104:107], v[136:139], v[48:63]
    ds_read_b64_tr_b16 v[124:125], v161 offset:15520
    ds_read_b64_tr_b16 v[126:127], v161 offset:16800
    s_waitcnt lgkmcnt(9)
    v_mfma_f32_32x32x16_bf16 v[64:79], v[108:111], v[136:139], v[64:79]
    ds_read_b64_tr_b16 v[128:129], v161 offset:15600
    ds_read_b64_tr_b16 v[130:131], v161 offset:16880
    s_waitcnt lgkmcnt(9)
    v_mfma_f32_32x32x16_bf16 v[80:95], v[112:115], v[136:139], v[80:95]
    ds_read_b64_tr_b16 v[132:133], v163 offset:15360
    ds_read_b64_tr_b16 v[134:135], v163 offset:16640
    s_barrier
    s_waitcnt lgkmcnt(8)
    v_mfma_f32_32x32x16_bf16 v[16:31], v[116:119], v[140:143], v[16:31]
    ds_read_b128 v[136:139], v164 offset:12288
    ds_read_b64_tr_b16 v[96:97], v161 offset:23040
    ds_read_b64_tr_b16 v[98:99], v161 offset:24320
    s_waitcnt lgkmcnt(9)
    v_mfma_f32_32x32x16_bf16 v[32:47], v[120:123], v[140:143], v[32:47]
    ds_read_b64_tr_b16 v[100:101], v161 offset:23120
    ds_read_b64_tr_b16 v[102:103], v161 offset:24400
    s_waitcnt lgkmcnt(9)
    v_mfma_f32_32x32x16_bf16 v[48:63], v[124:127], v[140:143], v[48:63]
    ds_read_b64_tr_b16 v[104:105], v161 offset:23200
    ds_read_b64_tr_b16 v[106:107], v161 offset:24480
    s_waitcnt lgkmcnt(9)
    v_mfma_f32_32x32x16_bf16 v[64:79], v[128:131], v[140:143], v[64:79]
    ds_read_b64_tr_b16 v[108:109], v161 offset:23280
    ds_read_b64_tr_b16 v[110:111], v161 offset:24560
    s_waitcnt lgkmcnt(9)
    v_mfma_f32_32x32x16_bf16 v[80:95], v[132:135], v[140:143], v[80:95]
    ds_read_b64_tr_b16 v[112:113], v163 offset:23040
    ds_read_b64_tr_b16 v[114:115], v163 offset:24320
    s_waitcnt lgkmcnt(8)
    v_mfma_f32_32x32x16_bf16 v[16:31], v[96:99], v[136:139], v[16:31]
    ds_read_b128 v[140:143], v165 offset:12288
    ds_read_b64_tr_b16 v[116:117], v161 offset:28160
    ds_read_b64_tr_b16 v[118:119], v161 offset:29440
    s_waitcnt lgkmcnt(9)
    v_mfma_f32_32x32x16_bf16 v[32:47], v[100:103], v[136:139], v[32:47]
    ds_read_b64_tr_b16 v[120:121], v161 offset:28240
    ds_read_b64_tr_b16 v[122:123], v161 offset:29520
    s_waitcnt lgkmcnt(9)
    v_mfma_f32_32x32x16_bf16 v[48:63], v[104:107], v[136:139], v[48:63]
    ds_read_b64_tr_b16 v[124:125], v161 offset:28320
    ds_read_b64_tr_b16 v[126:127], v161 offset:29600
    s_waitcnt lgkmcnt(9)
    v_mfma_f32_32x32x16_bf16 v[64:79], v[108:111], v[136:139], v[64:79]
    ds_read_b64_tr_b16 v[128:129], v161 offset:28400
    ds_read_b64_tr_b16 v[130:131], v161 offset:29680
    s_waitcnt lgkmcnt(9)
    v_mfma_f32_32x32x16_bf16 v[80:95], v[112:115], v[136:139], v[80:95]
    ds_read_b64_tr_b16 v[132:133], v163 offset:28160
    ds_read_b64_tr_b16 v[134:135], v163 offset:29440
    s_waitcnt lgkmcnt(8)
    v_mfma_f32_32x32x16_bf16 v[16:31], v[116:119], v[140:143], v[16:31]
    ds_read_b128 v[136:139], v166 offset:12288
    ds_read_b64_tr_b16 v[96:97], v161 offset:33280
    ds_read_b64_tr_b16 v[98:99], v161 offset:34560
    s_waitcnt lgkmcnt(9)
    v_mfma_f32_32x32x16_bf16 v[32:47], v[120:123], v[140:143], v[32:47]
    ds_read_b64_tr_b16 v[100:101], v161 offset:33360
    ds_read_b64_tr_b16 v[102:103], v161 offset:34640
    s_waitcnt lgkmcnt(9)
    v_mfma_f32_32x32x16_bf16 v[48:63], v[124:127], v[140:143], v[48:63]
    ds_read_b64_tr_b16 v[104:105], v161 offset:33440
    ds_read_b64_tr_b16 v[106:107], v161 offset:34720
    s_waitcnt lgkmcnt(9)
    v_mfma_f32_32x32x16_bf16 v[64:79], v[128:131], v[140:143], v[64:79]
    ds_read_b64_tr_b16 v[108:109], v161 offset:33520
    ds_read_b64_tr_b16 v[110:111], v161 offset:34800
    s_waitcnt lgkmcnt(9)
    v_mfma_f32_32x32x16_bf16 v[80:95], v[132:135], v[140:143], v[80:95]
    ds_read_b64_tr_b16 v[112:113], v163 offset:33280
    ds_read_b64_tr_b16 v[114:115], v163 offset:34560
    s_waitcnt lgkmcnt(8)
    v_mfma_f32_32x32x16_bf16 v[16:31], v[96:99], v[136:139], v[16:31]
    ds_read_b128 v[140:143], v167 offset:12288
    ds_read_b64_tr_b16 v[116:117], v161 offset:38400
    ds_read_b64_tr_b16 v[118:119], v161 offset:39680
    s_waitcnt lgkmcnt(9)
    v_mfma_f32_32x32x16_bf16 v[32:47], v[100:103], v[136:139], v[32:47]
    ds_read_b64_tr_b16 v[120:121], v161 offset:38480
    ds_read_b64_tr_b16 v[122:123], v161 offset:39760
    s_waitcnt lgkmcnt(9)
    v_mfma_f32_32x32x16_bf16 v[48:63], v[104:107], v[136:139], v[48:63]
    ds_read_b64_tr_b16 v[124:125], v161 offset:38560
    ds_read_b64_tr_b16 v[126:127], v161 offset:39840
    s_waitcnt lgkmcnt(9)
    v_mfma_f32_32x32x16_bf16 v[64:79], v[108:111], v[136:139], v[64:79]
    ds_read_b64_tr_b16 v[128:129], v161 offset:38640
    ds_read_b64_tr_b16 v[130:131], v161 offset:39920
    s_waitcnt lgkmcnt(9)
    v_mfma_f32_32x32x16_bf16 v[80:95], v[112:115], v[136:139], v[80:95]
    ds_read_b64_tr_b16 v[132:133], v163 offset:38400
    ds_read_b64_tr_b16 v[134:135], v163 offset:39680
    s_barrier
    s_waitcnt lgkmcnt(8)
    v_mfma_f32_32x32x16_bf16 v[16:31], v[116:119], v[140:143], v[16:31]
    ds_read_b128 v[136:139], v164 offset:0
    ds_read_b64_tr_b16 v[96:97], v160 offset:0
    ds_read_b64_tr_b16 v[98:99], v160 offset:1280
    s_waitcnt lgkmcnt(9)
    v_mfma_f32_32x32x16_bf16 v[32:47], v[120:123], v[140:143], v[32:47]
    ds_read_b64_tr_b16 v[100:101], v160 offset:80
    ds_read_b64_tr_b16 v[102:103], v160 offset:1360
    s_waitcnt lgkmcnt(9)
    v_mfma_f32_32x32x16_bf16 v[48:63], v[124:127], v[140:143], v[48:63]
    ds_read_b64_tr_b16 v[104:105], v160 offset:160
    ds_read_b64_tr_b16 v[106:107], v160 offset:1440
    s_waitcnt lgkmcnt(9)
    v_mfma_f32_32x32x16_bf16 v[64:79], v[128:131], v[140:143], v[64:79]
    ds_read_b64_tr_b16 v[108:109], v160 offset:240
    ds_read_b64_tr_b16 v[110:111], v160 offset:1520
    s_waitcnt lgkmcnt(9)
    v_mfma_f32_32x32x16_bf16 v[80:95], v[132:135], v[140:143], v[80:95]
    ds_read_b64_tr_b16 v[112:113], v162 offset:0
    ds_read_b64_tr_b16 v[114:115], v162 offset:1280
    s_waitcnt lgkmcnt(8)
    v_mfma_f32_32x32x16_bf16 v[16:31], v[96:99], v[136:139], v[16:31]
    ds_read_b128 v[140:143], v165 offset:0
    ds_read_b64_tr_b16 v[116:117], v160 offset:5120
    ds_read_b64_tr_b16 v[118:119], v160 offset:6400
    s_waitcnt lgkmcnt(9)
    v_mfma_f32_32x32x16_bf16 v[32:47], v[100:103], v[136:139], v[32:47]
    ds_read_b64_tr_b16 v[120:121], v160 offset:5200
    ds_read_b64_tr_b16 v[122:123], v160 offset:6480
    s_waitcnt lgkmcnt(9)
    v_mfma_f32_32x32x16_bf16 v[48:63], v[104:107], v[136:139], v[48:63]
    ds_read_b64_tr_b16 v[124:125], v160 offset:5280
    ds_read_b64_tr_b16 v[126:127], v160 offset:6560
    s_waitcnt lgkmcnt(9)
    v_mfma_f32_32x32x16_bf16 v[64:79], v[108:111], v[136:139], v[64:79]
    ds_read_b64_tr_b16 v[128:129], v160 offset:5360
    ds_read_b64_tr_b16 v[130:131], v160 offset:6640
    s_waitcnt lgkmcnt(9)
    v_mfma_f32_32x32x16_bf16 v[80:95], v[112:115], v[136:139], v[80:95]
    ds_read_b64_tr_b16 v[132:133], v162 offset:5120
    ds_read_b64_tr_b16 v[134:135], v162 offset:6400
    s_waitcnt lgkmcnt(8)
    v_mfma_f32_32x32x16_bf16 v[16:31], v[116:119], v[140:143], v[16:31]
    ds_read_b128 v[136:139], v166 offset:0
    ds_read_b64_tr_b16 v[96:97], v160 offset:10240
    ds_read_b64_tr_b16 v[98:99], v160 offset:11520
    s_waitcnt lgkmcnt(9)
    v_mfma_f32_32x32x16_bf16 v[32:47], v[120:123], v[140:143], v[32:47]
    ds_read_b64_tr_b16 v[100:101], v160 offset:10320
    ds_read_b64_tr_b16 v[102:103], v160 offset:11600
    s_waitcnt lgkmcnt(9)
    v_mfma_f32_32x32x16_bf16 v[48:63], v[124:127], v[140:143], v[48:63]
    ds_read_b64_tr_b16 v[104:105], v160 offset:10400
    ds_read_b64_tr_b16 v[106:107], v160 offset:11680
    s_waitcnt lgkmcnt(9)
    v_mfma_f32_32x32x16_bf16 v[64:79], v[128:131], v[140:143], v[64:79]
    ds_read_b64_tr_b16 v[108:109], v160 offset:10480
    ds_read_b64_tr_b16 v[110:111], v160 offset:11760
    s_waitcnt lgkmcnt(9)
    v_mfma_f32_32x32x16_bf16 v[80:95], v[132:135], v[140:143], v[80:95]
    ds_read_b64_tr_b16 v[112:113], v162 offset:10240
    ds_read_b64_tr_b16 v[114:115], v162 offset:11520
    s_waitcnt lgkmcnt(8)
    v_mfma_f32_32x32x16_bf16 v[16:31], v[96:99], v[136:139], v[16:31]
    ds_read_b128 v[140:143], v167 offset:0
    ds_read_b64_tr_b16 v[116:117], v160 offset:15360
    ds_read_b64_tr_b16 v[118:119], v160 offset:16640
    s_waitcnt lgkmcnt(9)
    v_mfma_f32_32x32x16_bf16 v[32:47], v[100:103], v[136:139], v[32:47]
    ds_read_b64_tr_b16 v[120:121], v160 offset:15440
    ds_read_b64_tr_b16 v[122:123], v160 offset:16720
    s_waitcnt lgkmcnt(9)
    v_mfma_f32_32x32x16_bf16 v[48:63], v[104:107], v[136:139], v[48:63]
    ds_read_b64_tr_b16 v[124:125], v160 offset:15520
    ds_read_b64_tr_b16 v[126:127], v160 offset:16800
    s_waitcnt lgkmcnt(9)
    v_mfma_f32_32x32x16_bf16 v[64:79], v[108:111], v[136:139], v[64:79]
    ds_read_b64_tr_b16 v[128:129], v160 offset:15600
    ds_read_b64_tr_b16 v[130:131], v160 offset:16880
    s_waitcnt lgkmcnt(9)
    v_mfma_f32_32x32x16_bf16 v[80:95], v[112:115], v[136:139], v[80:95]
    ds_read_b64_tr_b16 v[132:133], v162 offset:15360
    ds_read_b64_tr_b16 v[134:135], v162 offset:16640
    s_barrier
    s_waitcnt lgkmcnt(8)
    v_mfma_f32_32x32x16_bf16 v[16:31], v[116:119], v[140:143], v[16:31]
    ds_read_b128 v[136:139], v164 offset:4096
    ds_read_b64_tr_b16 v[96:97], v160 offset:23040
    ds_read_b64_tr_b16 v[98:99], v160 offset:24320
    s_waitcnt lgkmcnt(9)
    v_mfma_f32_32x32x16_bf16 v[32:47], v[120:123], v[140:143], v[32:47]
    ds_read_b64_tr_b16 v[100:101], v160 offset:23120
    ds_read_b64_tr_b16 v[102:103], v160 offset:24400
    s_waitcnt lgkmcnt(9)
    v_mfma_f32_32x32x16_bf16 v[48:63], v[124:127], v[140:143], v[48:63]
    ds_read_b64_tr_b16 v[104:105], v160 offset:23200
    ds_read_b64_tr_b16 v[106:107], v160 offset:24480
    s_waitcnt lgkmcnt(9)
    v_mfma_f32_32x32x16_bf16 v[64:79], v[128:131], v[140:143], v[64:79]
    ds_read_b64_tr_b16 v[108:109], v160 offset:23280
    ds_read_b64_tr_b16 v[110:111], v160 offset:24560
    s_waitcnt lgkmcnt(9)
    v_mfma_f32_32x32x16_bf16 v[80:95], v[132:135], v[140:143], v[80:95]
    ds_read_b64_tr_b16 v[112:113], v162 offset:23040
    ds_read_b64_tr_b16 v[114:115], v162 offset:24320
    s_waitcnt lgkmcnt(8)
    v_mfma_f32_32x32x16_bf16 v[16:31], v[96:99], v[136:139], v[16:31]
    ds_read_b128 v[140:143], v165 offset:4096
    ds_read_b64_tr_b16 v[116:117], v160 offset:28160
    ds_read_b64_tr_b16 v[118:119], v160 offset:29440
    s_waitcnt lgkmcnt(9)
    v_mfma_f32_32x32x16_bf16 v[32:47], v[100:103], v[136:139], v[32:47]
    ds_read_b64_tr_b16 v[120:121], v160 offset:28240
    ds_read_b64_tr_b16 v[122:123], v160 offset:29520
    s_waitcnt lgkmcnt(9)
    v_mfma_f32_32x32x16_bf16 v[48:63], v[104:107], v[136:139], v[48:63]
    ds_read_b64_tr_b16 v[124:125], v160 offset:28320
    ds_read_b64_tr_b16 v[126:127], v160 offset:29600
    s_waitcnt lgkmcnt(9)
    v_mfma_f32_32x32x16_bf16 v[64:79], v[108:111], v[136:139], v[64:79]
    ds_read_b64_tr_b16 v[128:129], v160 offset:28400
    ds_read_b64_tr_b16 v[130:131], v160 offset:29680
    s_waitcnt lgkmcnt(9)
    v_mfma_f32_32x32x16_bf16 v[80:95], v[112:115], v[136:139], v[80:95]
    ds_read_b64_tr_b16 v[132:133], v162 offset:28160
    ds_read_b64_tr_b16 v[134:135], v162 offset:29440
    s_waitcnt lgkmcnt(8)
    v_mfma_f32_32x32x16_bf16 v[16:31], v[116:119], v[140:143], v[16:31]
    ds_read_b128 v[136:139], v166 offset:4096
    ds_read_b64_tr_b16 v[96:97], v160 offset:33280
    ds_read_b64_tr_b16 v[98:99], v160 offset:34560
    s_waitcnt lgkmcnt(9)
    v_mfma_f32_32x32x16_bf16 v[32:47], v[120:123], v[140:143], v[32:47]
    ds_read_b64_tr_b16 v[100:101], v160 offset:33360
    ds_read_b64_tr_b16 v[102:103], v160 offset:34640
    s_waitcnt lgkmcnt(9)
    v_mfma_f32_32x32x16_bf16 v[48:63], v[124:127], v[140:143], v[48:63]
    ds_read_b64_tr_b16 v[104:105], v160 offset:33440
    ds_read_b64_tr_b16 v[106:107], v160 offset:34720
    s_waitcnt lgkmcnt(9)
    v_mfma_f32_32x32x16_bf16 v[64:79], v[128:131], v[140:143], v[64:79]
    ds_read_b64_tr_b16 v[108:109], v160 offset:33520
    ds_read_b64_tr_b16 v[110:111], v160 offset:34800
    s_waitcnt lgkmcnt(9)
    v_mfma_f32_32x32x16_bf16 v[80:95], v[132:135], v[140:143], v[80:95]
    ds_read_b64_tr_b16 v[112:113], v162 offset:33280
    ds_read_b64_tr_b16 v[114:115], v162 offset:34560
    s_waitcnt lgkmcnt(8)
    v_mfma_f32_32x32x16_bf16 v[16:31], v[96:99], v[136:139], v[16:31]
    ds_read_b128 v[140:143], v167 offset:4096
    ds_read_b64_tr_b16 v[116:117], v160 offset:38400
    ds_read_b64_tr_b16 v[118:119], v160 offset:39680
    s_waitcnt lgkmcnt(9)
    v_mfma_f32_32x32x16_bf16 v[32:47], v[100:103], v[136:139], v[32:47]
    ds_read_b64_tr_b16 v[120:121], v160 offset:38480
    ds_read_b64_tr_b16 v[122:123], v160 offset:39760
    s_waitcnt lgkmcnt(9)
    v_mfma_f32_32x32x16_bf16 v[48:63], v[104:107], v[136:139], v[48:63]
    ds_read_b64_tr_b16 v[124:125], v160 offset:38560
    ds_read_b64_tr_b16 v[126:127], v160 offset:39840
    s_waitcnt lgkmcnt(9)
    v_mfma_f32_32x32x16_bf16 v[64:79], v[108:111], v[136:139], v[64:79]
    ds_read_b64_tr_b16 v[128:129], v160 offset:38640
    ds_read_b64_tr_b16 v[130:131], v160 offset:39920
    s_waitcnt lgkmcnt(9)
    v_mfma_f32_32x32x16_bf16 v[80:95], v[112:115], v[136:139], v[80:95]
    ds_read_b64_tr_b16 v[132:133], v162 offset:38400
    ds_read_b64_tr_b16 v[134:135], v162 offset:39680
    s_waitcnt lgkmcnt(8)
    v_mfma_f32_32x32x16_bf16 v[16:31], v[116:119], v[140:143], v[16:31]
    s_waitcnt lgkmcnt(6)
    v_mfma_f32_32x32x16_bf16 v[32:47], v[120:123], v[140:143], v[32:47]
    s_waitcnt lgkmcnt(4)
    v_mfma_f32_32x32x16_bf16 v[48:63], v[124:127], v[140:143], v[48:63]
    s_waitcnt lgkmcnt(2)
    v_mfma_f32_32x32x16_bf16 v[64:79], v[128:131], v[140:143], v[64:79]
    s_waitcnt lgkmcnt(0)
    v_mfma_f32_32x32x16_bf16 v[80:95], v[132:135], v[140:143], v[80:95]
    s_barrier
    s_nop 2
    s_mov_b32 s40, 0x3ea52b5c
    s_mov_b32 s41, 0x3ea52b5c
    s_lshl_b32 s5, s27, 5
    s_lshl_b32 s6, s25, 3
    s_add_u32 s5, s5, s6
    s_mul_i32 s5, s5, 1280
    v_mul_u32_u24 v10, 2560, v3
    v_lshl_add_u32 v10, v2, 3, v10
    v_pk_mul_f32 v[16:17], v[16:17], s[40:41]
    v_pk_mul_f32 v[18:19], v[18:19], s[40:41]
    v_pk_mul_f32 v[20:21], v[20:21], s[40:41]
    v_pk_mul_f32 v[22:23], v[22:23], s[40:41]
    v_cvt_pk_bf16_f32 v180, v16, v17
    v_cvt_pk_bf16_f32 v181, v18, v19
    v_cvt_pk_bf16_f32 v182, v20, v21
    v_cvt_pk_bf16_f32 v183, v22, v23
    s_add_u32 s6, s5, 0
    buffer_store_dwordx4 v[180:183], v173, s[32:35], s6 offen sc1
    v_pk_mul_f32 v[24:25], v[24:25], s[40:41]
    v_pk_mul_f32 v[26:27], v[26:27], s[40:41]
    v_pk_mul_f32 v[28:29], v[28:29], s[40:41]
    v_pk_mul_f32 v[30:31], v[30:31], s[40:41]
    v_cvt_pk_bf16_f32 v184, v24, v25
    v_cvt_pk_bf16_f32 v185, v26, v27
    v_cvt_pk_bf16_f32 v186, v28, v29
    v_cvt_pk_bf16_f32 v187, v30, v31
    s_add_u32 s6, s5, 1280
    buffer_store_dwordx4 v[184:187], v173, s[32:35], s6 offen sc1
    v_pk_mul_f32 v[32:33], v[32:33], s[40:41]
    v_pk_mul_f32 v[34:35], v[34:35], s[40:41]
    v_pk_mul_f32 v[36:37], v[36:37], s[40:41]
    v_pk_mul_f32 v[38:39], v[38:39], s[40:41]
    v_cvt_pk_bf16_f32 v188, v32, v33
    v_cvt_pk_bf16_f32 v189, v34, v35
    v_cvt_pk_bf16_f32 v190, v36, v37
    v_cvt_pk_bf16_f32 v191, v38, v39
    s_add_u32 s6, s5, 2560
    buffer_store_dwordx4 v[188:191], v173, s[32:35], s6 offen sc1
    v_pk_mul_f32 v[40:41], v[40:41], s[40:41]
    v_pk_mul_f32 v[42:43], v[42:43], s[40:41]
    v_pk_mul_f32 v[44:45], v[44:45], s[40:41]
    v_pk_mul_f32 v[46:47], v[46:47], s[40:41]
    v_cvt_pk_bf16_f32 v192, v40, v41
    v_cvt_pk_bf16_f32 v193, v42, v43
    v_cvt_pk_bf16_f32 v194, v44, v45
    v_cvt_pk_bf16_f32 v195, v46, v47
    s_add_u32 s6, s5, 3840
    buffer_store_dwordx4 v[192:195], v173, s[32:35], s6 offen sc1
    v_pk_mul_f32 v[48:49], v[48:49], s[40:41]
    v_pk_mul_f32 v[50:51], v[50:51], s[40:41]
    v_pk_mul_f32 v[52:53], v[52:53], s[40:41]
    v_pk_mul_f32 v[54:55], v[54:55], s[40:41]
    v_cvt_pk_bf16_f32 v196, v48, v49
    v_cvt_pk_bf16_f32 v197, v50, v51
    v_cvt_pk_bf16_f32 v198, v52, v53
    v_cvt_pk_bf16_f32 v199, v54, v55
    s_add_u32 s6, s5, 5120
    buffer_store_dwordx4 v[196:199], v173, s[32:35], s6 offen sc1
    v_pk_mul_f32 v[56:57], v[56:57], s[40:41]
    v_pk_mul_f32 v[58:59], v[58:59], s[40:41]
    v_pk_mul_f32 v[60:61], v[60:61], s[40:41]
    v_pk_mul_f32 v[62:63], v[62:63], s[40:41]
    v_cvt_pk_bf16_f32 v200, v56, v57
    v_cvt_pk_bf16_f32 v201, v58, v59
    v_cvt_pk_bf16_f32 v202, v60, v61
    v_cvt_pk_bf16_f32 v203, v62, v63
    s_add_u32 s6, s5, 6400
    buffer_store_dwordx4 v[200:203], v173, s[32:35], s6 offen sc1
    v_pk_mul_f32 v[64:65], v[64:65], s[40:41]
    v_pk_mul_f32 v[66:67], v[66:67], s[40:41]
    v_pk_mul_f32 v[68:69], v[68:69], s[40:41]
    v_pk_mul_f32 v[70:71], v[70:71], s[40:41]
    v_cvt_pk_bf16_f32 v204, v64, v65
    v_cvt_pk_bf16_f32 v205, v66, v67
    v_cvt_pk_bf16_f32 v206, v68, v69
    v_cvt_pk_bf16_f32 v207, v70, v71
    s_add_u32 s6, s5, 7680
    buffer_store_dwordx4 v[204:207], v173, s[32:35], s6 offen sc1
    v_pk_mul_f32 v[72:73], v[72:73], s[40:41]
    v_pk_mul_f32 v[74:75], v[74:75], s[40:41]
    v_pk_mul_f32 v[76:77], v[76:77], s[40:41]
    v_pk_mul_f32 v[78:79], v[78:79], s[40:41]
    v_cvt_pk_bf16_f32 v208, v72, v73
    v_cvt_pk_bf16_f32 v209, v74, v75
    v_cvt_pk_bf16_f32 v210, v76, v77
    v_cvt_pk_bf16_f32 v211, v78, v79
    s_add_u32 s6, s5, 8960
    buffer_store_dwordx4 v[208:211], v173, s[32:35], s6 offen sc1
    v_pk_mul_f32 v[80:81], v[80:81], s[40:41]
    v_pk_mul_f32 v[82:83], v[82:83], s[40:41]
    v_pk_mul_f32 v[84:85], v[84:85], s[40:41]
    v_pk_mul_f32 v[86:87], v[86:87], s[40:41]
    v_cvt_pk_bf16_f32 v180, v80, v81
    v_cvt_pk_bf16_f32 v181, v82, v83
    v_cvt_pk_bf16_f32 v182, v84, v85
    v_cvt_pk_bf16_f32 v183, v86, v87
    s_add_u32 s6, s5, 0
    buffer_store_dwordx2 v[180:181], v10, s[32:35], s6 offen offset:1024 sc1
    buffer_store_dwordx2 v[182:183], v10, s[32:35], s6 offen offset:2304 sc1
    v_pk_mul_f32 v[88:89], v[88:89], s[40:41]
    v_pk_mul_f32 v[90:91], v[90:91], s[40:41]
    v_pk_mul_f32 v[92:93], v[92:93], s[40:41]
    v_pk_mul_f32 v[94:95], v[94:95], s[40:41]
    v_cvt_pk_bf16_f32 v184, v88, v89
    v_cvt_pk_bf16_f32 v185, v90, v91
    v_cvt_pk_bf16_f32 v186, v92, v93
    v_cvt_pk_bf16_f32 v187, v94, v95
    s_add_u32 s6, s5, 5120
    buffer_store_dwordx2 v[184:185], v10, s[32:35], s6 offen offset:1024 sc1
    buffer_store_dwordx2 v[186:187], v10, s[32:35], s6 offen offset:2304 sc1
    s_mov_b32 s31, 1
T_SETUP:
    s_load_dwordx4 s[8:11], s[0:1], 56
    s_mov_b64 s[92:93], s[20:21]
    s_mov_b64 s[12:13], s[22:23]
    s_and_b32 s3, s2, 7
    s_lshr_b32 s4, s2, 3
    s_lshl_b32 s28, s3, 2
    s_lshr_b32 s5, s4, 3
    s_add_u32 s28, s28, s5
    s_and_b32 s29, s4, 7
    s_mov_b32 s36, s28
    s_mov_b32 s67, s29
    v_lshrrev_b32 v13, 6, v0
    v_and_b32 v1, 63, v0
    v_readfirstlane_b32 s30, v13
    v_and_b32 v2, 31, v0
    v_bfe_u32 v3, v0, 5, 1
    v_lshlrev_b32 v11, 4, v1
    s_mov_b32 s32, 0xfffff
    s_mov_b32 s33, 0xfffff
    s_mov_b32 s34, -1
    s_mov_b32 s35, 0
    s_mov_b32 s44, 0
    s_mov_b32 s45, -1
    s_lshr_b32 s46, s30, 2
    s_and_b32 s47, s30, 1
    s_bfe_u32 s48, s30, 0x10001
    s_lshr_b32 s49, s30, 1
    s_lshl_b32 s50, s28, 1
    s_add_u32 s50, s50, s47
    s_lshl_b32 s51, s29, 2
    s_lshl_b32 s5, s48, 1
    s_add_u32 s51, s51, s5
    s_add_u32 s51, s51, s46
    v_lshlrev_b32 v5, 3, v2
    v_mul_u32_u24 v6, 20, v3
    v_add_u32 v6, v6, v2
    v_lshlrev_b32 v6, 4, v6
    v_and_b32 v12, 27, v2
    v_cmp_eq_u32 vcc, 24, v12
    v_mov_b32 v13, 0x3f803f80
    s_nop 0
    v_cndmask_b32 v216, 0, v13, vcc
    v_cndmask_b32 v217, 0, v13, vcc
    v_cndmask_b32 v218, 0, v13, vcc
    v_cndmask_b32 v219, 0, v13, vcc
    v_cndmask_b32 v220, 0, v13, vcc
    v_cndmask_b32 v221, 0, v13, vcc
    v_cndmask_b32 v222, 0, v13, vcc
    v_cndmask_b32 v223, 0, v13, vcc
    v_cndmask_b32 v224, 0, v13, vcc
    v_cndmask_b32 v225, 0, v13, vcc
    v_cndmask_b32 v226, 0, v13, vcc
    v_cndmask_b32 v227, 0, v13, vcc
    v_cndmask_b32 v228, 0, v13, vcc
    v_cndmask_b32 v229, 0, v13, vcc
    v_cndmask_b32 v230, 0, v13, vcc
    v_cndmask_b32 v231, 0, v13, vcc
    v_mov_b32 v212, 0x3f803f80
    v_mov_b32 v213, 0x3f80
    s_and_b32 s5, s51, 3
    s_lshl_b32 s6, s47, 2
    s_add_u32 s5, s5, s6
    s_mul_i32 s53, s5, 1280
    s_xor_b32 s5, s5, 1
    s_mul_i32 s52, s5, 1280
    s_mov_b32 s54, 2621440
    s_mul_i32 s55, s46, 81920
    s_add_u32 s55, s55, 2621440
    s_and_b32 s5, s30, 3
    s_lshl_b32 s6, s5, 11
    s_mul_i32 s64, s46, 7680
    s_add_u32 s64, s64, s6
    s_add_u32 s66, s55, s6
    s_cmp_eq_u32 s5, 3
    s_mov_b32 s68, -1
    s_cselect_b32 s69, 0, -1
    v_mov_b32 v151, v5
    v_add_u32 v244, s52, v11
    v_add_u32 v245, s52, v5
    v_add_u32 v246, s53, v11
    v_add_u32 v247, s53, v5
    s_mov_b32 s16, s12
    s_mov_b32 s17, s13
    s_mov_b32 s18, 23068672
    s_mov_b32 s19, 0x00020000
    s_mul_i32 s5, s46, 7680
    v_add_u32 v4, s5, v11
    v_add_u32 v5, s5, v5
    v_add_u32 v6, s5, v6
    s_lshl_b32 s5, s28, 7
    s_add_u32 s5, s5, 3096576
    v_lshl_add_u32 v8, v2, 2, s5
    s_cmp_eq_u32 s31, 0
    s_cbranch_scc1 T_NQ
    v_mov_b32 v250, s98
    v_mov_b32 v251, 1
    s_waitcnt vmcnt(0)
    s_mov_b64 exec, 1
    buffer_store_dword v251, v250, s[16:19], 0 offen sc1
    s_mov_b64 exec, -1
T_NQ:
    s_cmp_lg_u32 s30, 4
    s_cbranch_scc1 T_READY
    v_mov_b32 v80, 0
    v_min_u32 v82, 5, v2
    v_lshl_add_u32 v82, v3, 5, v82
    v_lshlrev_b32 v82, 4, v82
    v_add_u32 v82, 3100672, v82
    s_lshr_b32 s6, s29, 1
    s_lshl_b32 s6, s6, 2
    s_add_u32 s5, s5, s6
    v_lshl_add_u32 v83, v3, 6, s5
T_C1:
    v_add_u32 v84, -1, v81
    v_and_b32 v84, 0x800000ff, v84
    v_cmp_ne_u32 vcc, 0xff, v84
    s_cbranch_vccz T_Q
    s_cmp_eq_u32 s96, 0
    s_cbranch_scc1 T_Q
    s_sub_u32 s96, s96, 1
    s_sleep 8
    global_load_dword v81, v80, s[92:93] sc1
    s_waitcnt vmcnt(0)
    s_branch T_C1
T_Q:
    buffer_load_dword v87, v83, s[16:19], 0 offen sc1
    s_waitcnt vmcnt(0)
    v_cmp_ne_u32 vcc, 1, v87
    s_cbranch_vccz T_QOK
    s_cmp_eq_u32 s96, 0
    s_cbranch_scc1 T_QOK
    s_sub_u32 s96, s96, 1
    s_sleep 8
    s_branch T_Q
T_QOK:
    buffer_load_dwordx4 v[88:91], v82, s[16:19], 0 offen sc1
    s_lshl_b32 s5, s28, 6
    s_lshl_b32 s6, s29, 2
    s_add_u32 s5, s5, s6
    s_mul_i32 s5, s5, 1280
    s_mov_b32 m0, 0
    s_add_u32 s7, s5, 0
    buffer_load_dwordx4 v11, s[16:19], s7 offen offset:0 sc1 lds
    buffer_load_dwordx4 v11, s[16:19], s7 offen offset:1024 sc1 lds
    buffer_load_dwordx4 v11, s[16:19], s7 offen offset:2048 sc1 lds
    buffer_load_dwordx4 v11, s[16:19], s7 offen offset:3072 sc1 lds
    s_mov_b32 m0, 4096
    s_add_u32 s7, s5, 4096
    buffer_load_dwordx4 v11, s[16:19], s7 offen offset:0 sc1 lds
    s_mov_b32 m0, 5120
    s_add_u32 s7, s5, 40960
    buffer_load_dwordx4 v11, s[16:19], s7 offen offset:0 sc1 lds
    buffer_load_dwordx4 v11, s[16:19], s7 offen offset:1024 sc1 lds
    buffer_load_dwordx4 v11, s[16:19], s7 offen offset:2048 sc1 lds
    buffer_load_dwordx4 v11, s[16:19], s7 offen offset:3072 sc1 lds
    s_mov_b32 m0, 9216
    s_add_u32 s7, s5, 45056
    buffer_load_dwordx4 v11, s[16:19], s7 offen offset:0 sc1 lds
    s_waitcnt vmcnt(10)
T_KV:
    v_and_b32 v88, v88, v89
    v_and_b32 v90, v90, v91
    v_and_b32 v88, v88, v90
    v_cmp_ne_u32 vcc, 1, v88
    s_cbranch_vccz T_KVOK
    s_cmp_eq_u32 s96, 0
    s_cbranch_scc1 T_KVOK
    s_sub_u32 s96, s96, 1
    s_sleep 24
    buffer_load_dwordx4 v[88:91], v82, s[16:19], 0 offen sc1
    s_waitcnt vmcnt(0)
    s_branch T_KV
T_KVOK:
    s_mov_b32 m0, 15360
    s_mov_b32 s7, 2621440
    buffer_load_dwordx4 v11, s[16:19], s7 offen offset:0 sc1 lds
    buffer_load_dwordx4 v11, s[16:19], s7 offen offset:1024 sc1 lds
    buffer_load_dwordx4 v11, s[16:19], s7 offen offset:2048 sc1 lds
    buffer_load_dwordx4 v11, s[16:19], s7 offen offset:3072 sc1 lds
    s_mov_b32 m0, 19456
    s_mov_b32 s7, 2625536
    buffer_load_dwordx4 v11, s[16:19], s7 offen offset:0 sc1 lds
    buffer_load_dwordx4 v11, s[16:19], s7 offen offset:1024 sc1 lds
    buffer_load_dwordx4 v11, s[16:19], s7 offen offset:2048 sc1 lds
    s_mov_b64 exec, s[34:35]
    buffer_load_dwordx4 v11, s[16:19], s7 offen offset:3072 sc1 lds
    s_mov_b64 exec, -1
    s_mov_b32 m0, 23040
    s_mov_b32 s7, 2703360
    buffer_load_dwordx4 v11, s[16:19], s7 offen offset:0 sc1 lds
    buffer_load_dwordx4 v11, s[16:19], s7 offen offset:1024 sc1 lds
    buffer_load_dwordx4 v11, s[16:19], s7 offen offset:2048 sc1 lds
    buffer_load_dwordx4 v11, s[16:19], s7 offen offset:3072 sc1 lds
    s_mov_b32 m0, 27136
    s_mov_b32 s7, 2707456
    buffer_load_dwordx4 v11, s[16:19], s7 offen offset:0 sc1 lds
    buffer_load_dwordx4 v11, s[16:19], s7 offen offset:1024 sc1 lds
    buffer_load_dwordx4 v11, s[16:19], s7 offen offset:2048 sc1 lds
    s_mov_b64 exec, s[34:35]
    buffer_load_dwordx4 v11, s[16:19], s7 offen offset:3072 sc1 lds
    s_mov_b64 exec, -1
    s_waitcnt vmcnt(0)
T_READY:
    s_barrier
    s_add_u32 m0, s64, 30720
    s_add_u32 s39, s66, 7680
    buffer_load_dwordx4 v11, s[16:19], s39 offen sc1 lds
    s_add_u32 m0, s64, 30720
    s_add_u32 s39, s66, 7680
    s_mov_b64 exec, s[68:69]
    buffer_load_dwordx4 v11, s[16:19], s39 offen offset:1024 lds
    s_mov_b64 exec, -1
    ds_read_b128 v[232:235], v244
    ds_read_b64 v[236:237], v245 offset:1024
    ds_read_b128 v[238:241], v246
    ds_read_b64 v[242:243], v247 offset:1024
    ds_read_b128 v[144:147], v11 offset:15360
    ds_read_b64 v[148:149], v151 offset:16384
    ds_read_b128 v[208:211], v4 offset:15360
    s_mov_b64 exec, s[34:35]
    ds_read_b64 v[212:213], v5 offset:16384
    s_mov_b64 exec, s[32:33]
    ds_read_b128 v[216:219], v6 offset:16640
    ds_read_b128 v[220:223], v6 offset:17280
    s_mov_b64 exec, -1
    v_mov_b32 v244, 0
    s_waitcnt lgkmcnt(4)
    v_cndmask_b32 v236, v236, v244, s[44:45]
    v_cndmask_b32 v237, v237, v244, s[44:45]
    v_cndmask_b32 v242, v242, v244, s[44:45]
    v_cndmask_b32 v243, v243, v244, s[44:45]
    s_nop 1
    v_mfma_f32_32x32x16_bf16 v[16:31], v[144:147], v[232:235], 0
    v_mfma_f32_32x32x8_bf16 v[16:31], v[148:149], v[236:237], v[16:31]
    v_mfma_f32_32x32x16_bf16 v[32:47], v[144:147], v[238:241], 0
    v_mfma_f32_32x32x8_bf16 v[32:47], v[148:149], v[242:243], v[32:47]
    s_nop 9
    v_max3_f32 v244, v16, v17, v18
    v_max3_f32 v244, v244, v19, v20
    v_max3_f32 v244, v244, v21, v22
    v_max3_f32 v244, v244, v23, v24
    v_max3_f32 v244, v244, v25, v26
    v_max3_f32 v244, v244, v27, v28
    v_max3_f32 v244, v244, v29, v30
    v_max_f32 v244, v244, v31
    v_max3_f32 v245, v32, v33, v34
    v_max3_f32 v245, v245, v35, v36
    v_max3_f32 v245, v245, v37, v38
    v_max3_f32 v245, v245, v39, v40
    v_max3_f32 v245, v245, v41, v42
    v_max3_f32 v245, v245, v43, v44
    v_max3_f32 v245, v245, v45, v46
    v_max_f32 v245, v245, v47
    v_mov_b32 v246, v244
    s_nop 1
    v_permlane32_swap_b32 v246, v244
    s_nop 1
    v_max_f32 v244, v244, v246
    v_sub_f32 v244, 0, v244
    v_and_b32 v246, 0xffff0000, v244
    v_sub_f32 v247, v244, v246
    v_and_b32 v248, 0xffff0000, v247
    v_sub_f32 v249, v247, v248
    v_lshrrev_b32 v246, 16, v246
    v_or_b32 v246, v246, v248
    v_lshrrev_b32 v249, 16, v249
    v_cndmask_b32 v236, v236, v246, s[44:45]
    v_cndmask_b32 v237, v237, v249, s[44:45]
    v_mov_b32 v250, v245
    s_nop 1
    v_permlane32_swap_b32 v250, v245
    s_nop 1
    v_max_f32 v245, v245, v250
    v_sub_f32 v245, 0, v245
    v_and_b32 v250, 0xffff0000, v245
    v_sub_f32 v251, v245, v250
    v_and_b32 v252, 0xffff0000, v251
    v_sub_f32 v253, v251, v252
    v_lshrrev_b32 v250, 16, v250
    v_or_b32 v250, v250, v252
    v_lshrrev_b32 v253, 16, v253
    v_cndmask_b32 v242, v242, v250, s[44:45]
    v_cndmask_b32 v243, v243, v253, s[44:45]
    s_waitcnt lgkmcnt(0)
    v_mfma_f32_32x32x16_bf16 v[16:31], v[208:211], v[232:235], 0
    v_mfma_f32_32x32x8_bf16 v[16:31], v[212:213], v[236:237], v[16:31]
    s_cmp_eq_u32 s29, 7
    s_cbranch_scc1 K2_NOG
    s_nop 9
    v_exp_f32 v16, v16
    v_exp_f32 v17, v17
    v_exp_f32 v18, v18
    s_setprio 3
    s_waitcnt lgkmcnt(0)
    s_mov_b32 s20, s8
    s_mov_b32 s21, s9
    s_mov_b32 s22, 8388608
    s_mov_b32 s23, 0x00020000
    s_mov_b32 s24, s10
    s_mov_b32 s25, s11
    s_mov_b32 s26, 4096
    s_mov_b32 s27, 0x00020000
    s_lshl_b32 s65, s30, 12
    s_add_u32 s65, s65, 61440
    s_xor_b32 s5, s47, s46
    s_lshl_b32 s7, s28, 1
    s_add_u32 s5, s5, s7
    s_lshl_b32 s5, s5, 17
    s_lshl_b32 s7, s46, 11
    s_add_u32 s5, s5, s7
    s_lshl_b32 s7, s48, 7
    s_add_u32 s5, s5, s7
    v_lshrrev_b32 v12, 3, v1
    v_lshlrev_b32 v12, 12, v12
    v_lshrrev_b32 v15, 4, v1
    v_and_b32 v9, 7, v1
    v_xor_b32 v9, v9, v15
    v_lshl_add_u32 v9, v9, 4, v12
    v_add_u32 v9, s5, v9
    v_xor_b32 v10, 64, v9
    s_lshl_b32 s5, s29, 2
    s_and_b32 s61, s30, 3
    s_add_u32 s60, s5, s61
    s_lshl_b32 s7, s46, 16
    s_add_u32 s7, s7, 18874368
    s_min_u32 s5, s60, 26
    s_lshl_b32 s5, s5, 17
    s_add_u32 s5, s5, s7
    v_add_u32 v7, s5, v11
    s_lshl_b32 s62, s28, 1
    s_add_u32 s62, s62, s46
    s_mul_i32 s14, s62, 54
    s_min_u32 s5, s60, 26
    s_lshl_b32 s5, s5, 1
    s_add_u32 s14, s14, s5
    s_lshl_b32 s14, s14, 10
    s_add_u32 s14, s14, 3145728
    s_lshl_b32 s15, s62, 6
    s_lshl_b32 s100, s62, 7
    s_add_u32 s100, s100, 2883584
    s_lshl_b32 s101, s50, 7
    s_add_u32 s101, s101, 2883584
    v_lshlrev_b32 v191, 1, v2
    v_lshlrev_b32 v215, 2, v2
    v_cvt_pk_bf16_f32 v16, v16, v17
    v_exp_f32 v19, v19
    v_exp_f32 v20, v20
    v_cvt_pk_bf16_f32 v17, v18, v19
    v_exp_f32 v21, v21
    v_mfma_f32_32x32x16_bf16 v[32:47], v[208:211], v[238:241], 0
    ds_read_b128 v[208:211], v4 offset:17920
    v_exp_f32 v22, v22
    v_cvt_pk_bf16_f32 v18, v20, v21
    v_exp_f32 v23, v23
    v_exp_f32 v24, v24
    v_cvt_pk_bf16_f32 v19, v22, v23
    v_mfma_f32_32x32x8_bf16 v[32:47], v[212:213], v[242:243], v[32:47]
    s_mov_b64 exec, s[34:35]
    ds_read_b64 v[212:213], v5 offset:18944
    s_mov_b64 exec, s[32:33]
    ds_read_b128 v[224:227], v6 offset:19200
    ds_read_b128 v[228:231], v6 offset:19840
    s_mov_b64 exec, -1
    v_exp_f32 v25, v25
    v_exp_f32 v26, v26
    v_cvt_pk_bf16_f32 v20, v24, v25
    v_exp_f32 v27, v27
    v_exp_f32 v28, v28
    v_cvt_pk_bf16_f32 v21, v26, v27
    v_exp_f32 v29, v29
    v_exp_f32 v30, v30
    v_cvt_pk_bf16_f32 v22, v28, v29
    v_exp_f32 v31, v31
    v_mfma_f32_32x32x16_bf16 v[48:63], v[216:219], v[16:19], 0
    s_lshl_b32 s5, s46, 14
    s_add_u32 s5, s5, 61440
    v_bfe_u32 v12, v2, 1, 3
    v_xor_b32 v12, v12, v3
    v_lshlrev_b32 v12, 4, v12
    v_lshl_add_u32 v12, v2, 7, v12
    v_xor_b32 v176, 0, v12
    v_add_u32 v176, s5, v176
    v_add_u32 v180, 0x10000, v176
    v_xor_b32 v177, 32, v12
    v_add_u32 v177, s5, v177
    v_add_u32 v181, 0x10000, v177
    v_xor_b32 v178, 64, v12
    v_add_u32 v178, s5, v178
    v_add_u32 v182, 0x10000, v178
    v_xor_b32 v179, 96, v12
    v_add_u32 v179, s5, v179
    v_add_u32 v183, 0x10000, v179
    s_lshl_b32 s5, s29, 5
    s_add_u32 s6, s5, s28
    s_lshl_b32 s6, s6, 3
    s_add_u32 s6, s6, s30
    s_lshl_b32 s6, s6, 2
    s_add_u32 s6, s6, 3080192
    v_mov_b32 v15, s6
    v_mov_b32 v14, 1
    v_cvt_pk_bf16_f32 v23, v30, v31
    v_exp_f32 v32, v32
    v_exp_f32 v33, v33
    v_exp_f32 v34, v34
    v_mfma_f32_32x32x16_bf16 v[48:63], v[220:223], v[20:23], v[48:63]
    s_setprio 2
    s_waitcnt lgkmcnt(2)
    s_waitcnt vmcnt(0)
    s_cmp_ge_u32 s30, 4
    s_cbranch_scc1 K2_ND0G
    s_cmp_eq_u32 s97, 0
    s_cbranch_scc0 K2_ND0G
    v_mov_b32 v244, s98
    s_mov_b64 exec, 1
    buffer_store_dword v14, v244, s[16:19], 0 offen sc1
    s_mov_b64 exec, -1
K2_ND0G:
    v_cvt_pk_bf16_f32 v32, v32, v33
    v_exp_f32 v35, v35
    v_exp_f32 v36, v36
    v_cvt_pk_bf16_f32 v33, v34, v35
    v_exp_f32 v37, v37
    v_mfma_f32_32x32x16_bf16 v[16:31], v[208:211], v[232:235], 0
    v_exp_f32 v38, v38
    v_cvt_pk_bf16_f32 v34, v36, v37
    v_exp_f32 v39, v39
    v_exp_f32 v40, v40
    v_cvt_pk_bf16_f32 v35, v38, v39
    v_mfma_f32_32x32x8_bf16 v[16:31], v[212:213], v[236:237], v[16:31]
    s_waitcnt lgkmcnt(0)
    v_exp_f32 v41, v41
    v_exp_f32 v42, v42
    v_cvt_pk_bf16_f32 v36, v40, v41
    v_exp_f32 v43, v43
    v_exp_f32 v44, v44
    v_cvt_pk_bf16_f32 v37, v42, v43
    v_exp_f32 v45, v45
    v_exp_f32 v46, v46
    v_cvt_pk_bf16_f32 v38, v44, v45
    v_exp_f32 v47, v47
    v_mfma_f32_32x32x16_bf16 v[64:79], v[216:219], v[32:35], 0
    v_cvt_pk_bf16_f32 v39, v46, v47
    v_exp_f32 v16, v16
    v_exp_f32 v17, v17
    v_exp_f32 v18, v18
    v_mfma_f32_32x32x16_bf16 v[64:79], v[220:223], v[36:39], v[64:79]
    s_setprio 1
    s_cmp_lg_u32 s30, 4
    s_cbranch_scc1 K2_KVIG
    v_add_u32 v12, 3100672, v11
    buffer_load_dwordx4 v[248:251], v12, s[16:19], 0 offen offset:0 sc1
K2_KVIG:
    v_cvt_pk_bf16_f32 v16, v16, v17
    v_exp_f32 v19, v19
    v_exp_f32 v20, v20
    v_cvt_pk_bf16_f32 v17, v18, v19
    v_exp_f32 v21, v21
    v_mfma_f32_32x32x16_bf16 v[32:47], v[208:211], v[238:241], 0
    ds_read_b128 v[208:211], v4 offset:20480
    v_exp_f32 v22, v22
    v_cvt_pk_bf16_f32 v18, v20, v21
    v_exp_f32 v23, v23
    v_exp_f32 v24, v24
    v_cvt_pk_bf16_f32 v19, v22, v23
    v_mfma_f32_32x32x8_bf16 v[32:47], v[212:213], v[242:243], v[32:47]
    s_mov_b64 exec, s[34:35]
    ds_read_b64 v[212:213], v5 offset:21504
    s_mov_b64 exec, s[32:33]
    ds_read_b128 v[216:219], v6 offset:21760
    ds_read_b128 v[220:223], v6 offset:22400
    s_mov_b64 exec, -1
    v_exp_f32 v25, v25
    v_exp_f32 v26, v26
    v_cvt_pk_bf16_f32 v20, v24, v25
    v_exp_f32 v27, v27
    v_exp_f32 v28, v28
    v_cvt_pk_bf16_f32 v21, v26, v27
    v_exp_f32 v29, v29
    v_exp_f32 v30, v30
    v_cvt_pk_bf16_f32 v22, v28, v29
    v_exp_f32 v31, v31
    v_mfma_f32_32x32x16_bf16 v[48:63], v[224:227], v[16:19], v[48:63]
    s_add_u32 m0, s65, 65536
    s_mov_b32 s39, 0
    buffer_load_dwordx4 v9, s[20:23], s39 offen lds
    s_add_u32 m0, s65, 66560
    s_mov_b32 s39, 32768
    buffer_load_dwordx4 v10, s[20:23], s39 offen lds
    v_cvt_pk_bf16_f32 v23, v30, v31
    v_exp_f32 v32, v32
    v_exp_f32 v33, v33
    v_exp_f32 v34, v34
    v_mfma_f32_32x32x16_bf16 v[48:63], v[228:231], v[20:23], v[48:63]
    s_setprio 0
    s_waitcnt lgkmcnt(2)
    s_add_u32 m0, s65, 67584
    s_mov_b32 s39, 65536
    buffer_load_dwordx4 v9, s[20:23], s39 offen lds
    v_cvt_pk_bf16_f32 v32, v32, v33
    v_exp_f32 v35, v35
    v_exp_f32 v36, v36
    v_cvt_pk_bf16_f32 v33, v34, v35
    v_exp_f32 v37, v37
    v_mfma_f32_32x32x16_bf16 v[16:31], v[208:211], v[232:235], 0
    s_add_u32 m0, s65, 68608
    s_mov_b32 s39, 98304
    buffer_load_dwordx4 v10, s[20:23], s39 offen lds
    v_exp_f32 v38, v38
    v_cvt_pk_bf16_f32 v34, v36, v37
    v_exp_f32 v39, v39
    v_exp_f32 v40, v40
    v_cvt_pk_bf16_f32 v35, v38, v39
    v_mfma_f32_32x32x8_bf16 v[16:31], v[212:213], v[236:237], v[16:31]
    s_waitcnt lgkmcnt(0)
    v_exp_f32 v41, v41
    v_exp_f32 v42, v42
    v_cvt_pk_bf16_f32 v36, v40, v41
    v_exp_f32 v43, v43
    v_exp_f32 v44, v44
    v_cvt_pk_bf16_f32 v37, v42, v43
    v_exp_f32 v45, v45
    v_exp_f32 v46, v46
    v_cvt_pk_bf16_f32 v38, v44, v45
    v_exp_f32 v47, v47
    v_mfma_f32_32x32x16_bf16 v[64:79], v[224:227], v[32:35], v[64:79]
    v_cvt_pk_bf16_f32 v39, v46, v47
    s_cmp_lg_u32 s30, 4
    s_cbranch_scc1 K2_KVOKG
    s_waitcnt vmcnt(4)
    v_and_b32 v248, v248, v249
    v_and_b32 v248, v248, v250
    v_and_b32 v248, v248, v251
    v_cmp_ne_u32 vcc, 1, v248
    s_cbranch_vccz K2_KVOKG
K2_KVSPG:
    s_cmp_eq_u32 s96, 0
    s_cbranch_scc1 K2_KVOKG
    s_sub_u32 s96, s96, 1
    s_sleep 12
    s_mov_b64 exec, vcc
    v_add_u32 v12, 3100672, v11
    buffer_load_dwordx4 v[248:251], v12, s[16:19], 0 offen offset:0 sc1
    s_waitcnt vmcnt(0)
    v_and_b32 v248, v248, v249
    v_and_b32 v248, v248, v250
    v_and_b32 v248, v248, v251
    v_cmp_ne_u32 vcc, 1, v248
    s_mov_b64 exec, -1
    s_cbranch_vccnz K2_KVSPG
K2_KVOKG:
    s_barrier
    v_exp_f32 v16, v16
    v_exp_f32 v17, v17
    v_exp_f32 v18, v18
    v_mfma_f32_32x32x16_bf16 v[64:79], v[228:231], v[36:39], v[64:79]
    s_setprio 3
    s_add_u32 m0, s64, 46080
    s_add_u32 s39, s66, 15360
    buffer_load_dwordx4 v11, s[16:19], s39 offen sc1 lds
    v_cvt_pk_bf16_f32 v16, v16, v17
    v_exp_f32 v19, v19
    v_exp_f32 v20, v20
    v_cvt_pk_bf16_f32 v17, v18, v19
    v_exp_f32 v21, v21
    v_mfma_f32_32x32x16_bf16 v[32:47], v[208:211], v[238:241], 0
    ds_read_b128 v[208:211], v4 offset:30720
    v_exp_f32 v22, v22
    v_cvt_pk_bf16_f32 v18, v20, v21
    v_exp_f32 v23, v23
    v_exp_f32 v24, v24
    v_cvt_pk_bf16_f32 v19, v22, v23
    v_mfma_f32_32x32x8_bf16 v[32:47], v[212:213], v[242:243], v[32:47]
    s_mov_b64 exec, s[34:35]
    ds_read_b64 v[212:213], v5 offset:31744
    s_mov_b64 exec, s[32:33]
    ds_read_b128 v[224:227], v6 offset:32000
    ds_read_b128 v[228:231], v6 offset:32640
    s_mov_b64 exec, -1
    v_exp_f32 v25, v25
    v_exp_f32 v26, v26
    v_cvt_pk_bf16_f32 v20, v24, v25
    v_exp_f32 v27, v27
    v_exp_f32 v28, v28
    v_cvt_pk_bf16_f32 v21, v26, v27
    v_exp_f32 v29, v29
    v_exp_f32 v30, v30
    v_cvt_pk_bf16_f32 v22, v28, v29
    v_exp_f32 v31, v31
    v_mfma_f32_32x32x16_bf16 v[48:63], v[216:219], v[16:19], v[48:63]
    s_add_u32 m0, s64, 46080
    s_add_u32 s39, s66, 15360
    s_mov_b64 exec, s[68:69]
    buffer_load_dwordx4 v11, s[16:19], s39 offen offset:1024 lds
    s_mov_b64 exec, -1
    s_add_u32 m0, s64, 0
    s_add_u32 s39, s66, 23040
    buffer_load_dwordx4 v11, s[16:19], s39 offen sc1 lds
    s_add_u32 m0, s64, 0
    s_add_u32 s39, s66, 23040
    s_mov_b64 exec, s[68:69]
    buffer_load_dwordx4 v11, s[16:19], s39 offen offset:1024 lds
    s_mov_b64 exec, -1
    v_cvt_pk_bf16_f32 v23, v30, v31
    v_exp_f32 v32, v32
    v_exp_f32 v33, v33
    v_exp_f32 v34, v34
    v_mfma_f32_32x32x16_bf16 v[48:63], v[220:223], v[20:23], v[48:63]
    s_waitcnt lgkmcnt(2)
    s_add_u32 m0, s65, 0
    s_mov_b32 s39, 256
    buffer_load_dwordx4 v9, s[20:23], s39 offen lds
    v_cvt_pk_bf16_f32 v32, v32, v33
    v_exp_f32 v35, v35
    v_exp_f32 v36, v36
    v_cvt_pk_bf16_f32 v33, v34, v35
    v_exp_f32 v37, v37
    v_mfma_f32_32x32x16_bf16 v[16:31], v[208:211], v[232:235], 0
    s_add_u32 m0, s65, 1024
    s_mov_b32 s39, 33024
    buffer_load_dwordx4 v10, s[20:23], s39 offen lds
    v_exp_f32 v38, v38
    v_cvt_pk_bf16_f32 v34, v36, v37
    v_exp_f32 v39, v39
    v_exp_f32 v40, v40
    v_cvt_pk_bf16_f32 v35, v38, v39
    v_mfma_f32_32x32x8_bf16 v[16:31], v[212:213], v[236:237], v[16:31]
    s_waitcnt lgkmcnt(0)
    v_exp_f32 v41, v41
    v_exp_f32 v42, v42
    v_cvt_pk_bf16_f32 v36, v40, v41
    v_exp_f32 v43, v43
    v_exp_f32 v44, v44
    v_cvt_pk_bf16_f32 v37, v42, v43
    v_exp_f32 v45, v45
    v_exp_f32 v46, v46
    v_cvt_pk_bf16_f32 v38, v44, v45
    v_exp_f32 v47, v47
    v_mfma_f32_32x32x16_bf16 v[64:79], v[216:219], v[32:35], v[64:79]
    v_cvt_pk_bf16_f32 v39, v46, v47
    v_exp_f32 v16, v16
    v_exp_f32 v17, v17
    v_exp_f32 v18, v18
    v_mfma_f32_32x32x16_bf16 v[64:79], v[220:223], v[36:39], v[64:79]
    s_setprio 2
    s_add_u32 m0, s65, 2048
    s_mov_b32 s39, 65792
    buffer_load_dwordx4 v9, s[20:23], s39 offen lds
    v_cvt_pk_bf16_f32 v16, v16, v17
    v_exp_f32 v19, v19
    v_exp_f32 v20, v20
    v_cvt_pk_bf16_f32 v17, v18, v19
    v_exp_f32 v21, v21
    v_mfma_f32_32x32x16_bf16 v[32:47], v[208:211], v[238:241], 0
    ds_read_b128 v[208:211], v4 offset:33280
    v_exp_f32 v22, v22
    v_cvt_pk_bf16_f32 v18, v20, v21
    v_exp_f32 v23, v23
    v_exp_f32 v24, v24
    v_cvt_pk_bf16_f32 v19, v22, v23
    v_mfma_f32_32x32x8_bf16 v[32:47], v[212:213], v[242:243], v[32:47]
    s_mov_b64 exec, s[34:35]
    ds_read_b64 v[212:213], v5 offset:34304
    s_mov_b64 exec, s[32:33]
    ds_read_b128 v[216:219], v6 offset:34560
    ds_read_b128 v[220:223], v6 offset:35200
    s_mov_b64 exec, -1
    v_exp_f32 v25, v25
    v_exp_f32 v26, v26
    v_cvt_pk_bf16_f32 v20, v24, v25
    v_exp_f32 v27, v27
    v_exp_f32 v28, v28
    v_cvt_pk_bf16_f32 v21, v26, v27
    v_exp_f32 v29, v29
    v_exp_f32 v30, v30
    v_cvt_pk_bf16_f32 v22, v28, v29
    v_exp_f32 v31, v31
    v_mfma_f32_32x32x16_bf16 v[48:63], v[224:227], v[16:19], v[48:63]
    s_add_u32 m0, s65, 3072
    s_mov_b32 s39, 98560
    buffer_load_dwordx4 v10, s[20:23], s39 offen lds
    v_cvt_pk_bf16_f32 v23, v30, v31
    v_exp_f32 v32, v32
    v_exp_f32 v33, v33
    v_exp_f32 v34, v34
    v_mfma_f32_32x32x16_bf16 v[48:63], v[228:231], v[20:23], v[48:63]
    s_setprio 1
    s_waitcnt lgkmcnt(2)
    v_cvt_pk_bf16_f32 v32, v32, v33
    v_exp_f32 v35, v35
    v_exp_f32 v36, v36
    v_cvt_pk_bf16_f32 v33, v34, v35
    v_exp_f32 v37, v37
    v_mfma_f32_32x32x16_bf16 v[16:31], v[208:211], v[232:235], 0
    v_exp_f32 v38, v38
    v_cvt_pk_bf16_f32 v34, v36, v37
    v_exp_f32 v39, v39
    v_exp_f32 v40, v40
    v_cvt_pk_bf16_f32 v35, v38, v39
    v_mfma_f32_32x32x8_bf16 v[16:31], v[212:213], v[236:237], v[16:31]
    s_waitcnt lgkmcnt(0)
    v_exp_f32 v41, v41
    v_exp_f32 v42, v42
    v_cvt_pk_bf16_f32 v36, v40, v41
    v_exp_f32 v43, v43
    v_exp_f32 v44, v44
    v_cvt_pk_bf16_f32 v37, v42, v43
    v_exp_f32 v45, v45
    v_exp_f32 v46, v46
    v_cvt_pk_bf16_f32 v38, v44, v45
    v_exp_f32 v47, v47
    v_mfma_f32_32x32x16_bf16 v[64:79], v[224:227], v[32:35], v[64:79]
    s_cmp_eq_u32 s97, 0
    s_cbranch_scc1 K2_Z1_7G
    s_add_u32 s5, s97, 7168
    buffer_store_dwordx4 v[200:203], v11, s[16:19], s5 offen sc1
K2_Z1_7G:
    v_cvt_pk_bf16_f32 v39, v46, v47
    v_exp_f32 v16, v16
    v_exp_f32 v17, v17
    v_exp_f32 v18, v18
    v_mfma_f32_32x32x16_bf16 v[64:79], v[228:231], v[36:39], v[64:79]
    s_cmp_lg_u32 s30, 4
    s_cbranch_scc1 K2_F1IG
    v_lshlrev_b32 v12, 6, v1
    v_add_u32 v12, 3096616, v12
    buffer_load_dwordx4 v[248:251], v12, s[16:19], 0 offen offset:0 sc1
    buffer_load_dwordx2 v[252:253], v12, s[16:19], 0 offen offset:16 sc1
K2_F1IG:
    v_cvt_pk_bf16_f32 v16, v16, v17
    v_exp_f32 v19, v19
    v_exp_f32 v20, v20
    v_cvt_pk_bf16_f32 v17, v18, v19
    v_exp_f32 v21, v21
    v_mfma_f32_32x32x16_bf16 v[32:47], v[208:211], v[238:241], 0
    ds_read_b128 v[208:211], v4 offset:35840
    v_exp_f32 v22, v22
    v_cvt_pk_bf16_f32 v18, v20, v21
    v_exp_f32 v23, v23
    v_exp_f32 v24, v24
    v_cvt_pk_bf16_f32 v19, v22, v23
    v_mfma_f32_32x32x8_bf16 v[32:47], v[212:213], v[242:243], v[32:47]
    s_mov_b64 exec, s[34:35]
    ds_read_b64 v[212:213], v5 offset:36864
    s_mov_b64 exec, s[32:33]
    ds_read_b128 v[224:227], v6 offset:37120
    ds_read_b128 v[228:231], v6 offset:37760
    s_mov_b64 exec, -1
    v_exp_f32 v25, v25
    v_exp_f32 v26, v26
    v_cvt_pk_bf16_f32 v20, v24, v25
    v_exp_f32 v27, v27
    v_exp_f32 v28, v28
    v_cvt_pk_bf16_f32 v21, v26, v27
    v_exp_f32 v29, v29
    v_exp_f32 v30, v30
    v_cvt_pk_bf16_f32 v22, v28, v29
    v_exp_f32 v31, v31
    v_mfma_f32_32x32x16_bf16 v[48:63], v[216:219], v[16:19], v[48:63]
    s_add_u32 m0, s64, 15360
    s_add_u32 s39, s66, 30720
    buffer_load_dwordx4 v11, s[16:19], s39 offen sc1 lds
    s_add_u32 m0, s64, 15360
    s_add_u32 s39, s66, 30720
    s_mov_b64 exec, s[68:69]
    buffer_load_dwordx4 v11, s[16:19], s39 offen offset:1024 lds
    s_mov_b64 exec, -1
    s_add_u32 m0, s65, 32768
    s_mov_b32 s39, 512
    buffer_load_dwordx4 v9, s[20:23], s39 offen lds
    s_add_u32 m0, s65, 33792
    s_mov_b32 s39, 33280
    buffer_load_dwordx4 v10, s[20:23], s39 offen lds
    v_cvt_pk_bf16_f32 v23, v30, v31
    v_exp_f32 v32, v32
    v_exp_f32 v33, v33
    v_exp_f32 v34, v34
    v_mfma_f32_32x32x16_bf16 v[48:63], v[220:223], v[20:23], v[48:63]
    s_setprio 0
    s_waitcnt lgkmcnt(2)
    s_add_u32 m0, s65, 34816
    s_mov_b32 s39, 66048
    buffer_load_dwordx4 v9, s[20:23], s39 offen lds
    v_cvt_pk_bf16_f32 v32, v32, v33
    v_exp_f32 v35, v35
    v_exp_f32 v36, v36
    v_cvt_pk_bf16_f32 v33, v34, v35
    v_exp_f32 v37, v37
    v_mfma_f32_32x32x16_bf16 v[16:31], v[208:211], v[232:235], 0
    s_add_u32 m0, s65, 35840
    s_mov_b32 s39, 98816
    buffer_load_dwordx4 v10, s[20:23], s39 offen lds
    v_exp_f32 v38, v38
    v_cvt_pk_bf16_f32 v34, v36, v37
    v_exp_f32 v39, v39
    v_exp_f32 v40, v40
    v_cvt_pk_bf16_f32 v35, v38, v39
    v_mfma_f32_32x32x8_bf16 v[16:31], v[212:213], v[236:237], v[16:31]
    s_waitcnt lgkmcnt(0)
    v_exp_f32 v41, v41
    v_exp_f32 v42, v42
    v_cvt_pk_bf16_f32 v36, v40, v41
    v_exp_f32 v43, v43
    v_exp_f32 v44, v44
    v_cvt_pk_bf16_f32 v37, v42, v43
    v_exp_f32 v45, v45
    v_exp_f32 v46, v46
    v_cvt_pk_bf16_f32 v38, v44, v45
    v_exp_f32 v47, v47
    v_mfma_f32_32x32x16_bf16 v[64:79], v[216:219], v[32:35], v[64:79]
    v_cvt_pk_bf16_f32 v39, v46, v47
    s_cmp_lg_u32 s30, 4
    s_cbranch_scc1 K2_F1OKG
    s_waitcnt vmcnt(6)
    v_and_b32 v248, v248, v249
    v_and_b32 v248, v248, v250
    v_and_b32 v248, v248, v251
    v_and_b32 v248, v248, v252
    v_and_b32 v248, v248, v253
    v_cmp_ne_u32 vcc, 1, v248
    s_cbranch_vccz K2_F1OKG
K2_F1SPG:
    s_cmp_eq_u32 s96, 0
    s_cbranch_scc1 K2_F1OKG
    s_sub_u32 s96, s96, 1
    s_sleep 12
    s_mov_b64 exec, vcc
    v_lshlrev_b32 v12, 6, v1
    v_add_u32 v12, 3096616, v12
    buffer_load_dwordx4 v[248:251], v12, s[16:19], 0 offen offset:0 sc1
    buffer_load_dwordx2 v[252:253], v12, s[16:19], 0 offen offset:16 sc1
    s_waitcnt vmcnt(0)
    v_and_b32 v248, v248, v249
    v_and_b32 v248, v248, v250
    v_and_b32 v248, v248, v251
    v_and_b32 v248, v248, v252
    v_and_b32 v248, v248, v253
    v_cmp_ne_u32 vcc, 1, v248
    s_mov_b64 exec, -1
    s_cbranch_vccnz K2_F1SPG
K2_F1OKG:
    s_waitcnt vmcnt(12)
    s_barrier
    v_exp_f32 v16, v16
    v_exp_f32 v17, v17
    v_exp_f32 v18, v18
    v_mfma_f32_32x32x16_bf16 v[64:79], v[220:223], v[36:39], v[64:79]
    s_setprio 3
    s_mov_b32 s37, 0
    buffer_load_dwordx4 v[144:147], v7, s[16:19], s37 offen offset:0 sc1
    v_cvt_pk_bf16_f32 v16, v16, v17
    v_exp_f32 v19, v19
    v_exp_f32 v20, v20
    v_cvt_pk_bf16_f32 v17, v18, v19
    v_exp_f32 v21, v21
    v_mfma_f32_32x32x16_bf16 v[32:47], v[208:211], v[238:241], 0
    ds_read_b128 v[208:211], v4 offset:46080
    v_exp_f32 v22, v22
    v_cvt_pk_bf16_f32 v18, v20, v21
    v_exp_f32 v23, v23
    v_exp_f32 v24, v24
    v_cvt_pk_bf16_f32 v19, v22, v23
    v_mfma_f32_32x32x8_bf16 v[32:47], v[212:213], v[242:243], v[32:47]
    s_mov_b64 exec, s[34:35]
    ds_read_b64 v[212:213], v5 offset:47104
    s_mov_b64 exec, s[32:33]
    ds_read_b128 v[216:219], v6 offset:47360
    ds_read_b128 v[220:223], v6 offset:48000
    s_mov_b64 exec, -1
    v_exp_f32 v25, v25
    v_exp_f32 v26, v26
    v_cvt_pk_bf16_f32 v20, v24, v25
    v_exp_f32 v27, v27
    v_exp_f32 v28, v28
    v_cvt_pk_bf16_f32 v21, v26, v27
    v_exp_f32 v29, v29
    v_exp_f32 v30, v30
    v_cvt_pk_bf16_f32 v22, v28, v29
    v_exp_f32 v31, v31
    v_mfma_f32_32x32x16_bf16 v[48:63], v[224:227], v[16:19], v[48:63]
    s_mov_b32 s37, 0
    buffer_load_dwordx4 v[148:151], v7, s[16:19], s37 offen offset:1024 sc1
    s_mov_b32 s37, 0
    buffer_load_dwordx4 v[152:155], v7, s[16:19], s37 offen offset:2048 sc1
    s_cmp_eq_u32 s97, 0
    s_cbranch_scc1 K2_Z1_8G
    s_add_u32 s5, s97, 8192
    buffer_store_dwordx4 v[204:207], v11, s[16:19], s5 offen sc1
K2_Z1_8G:
    v_cvt_pk_bf16_f32 v23, v30, v31
    v_exp_f32 v32, v32
    v_exp_f32 v33, v33
    v_exp_f32 v34, v34
    v_mfma_f32_32x32x16_bf16 v[48:63], v[228:231], v[20:23], v[48:63]
    s_setprio 2
    s_waitcnt lgkmcnt(2)
    s_mov_b32 s37, 0
    buffer_load_dwordx4 v[156:159], v7, s[16:19], s37 offen offset:3072 sc1
    v_cvt_pk_bf16_f32 v32, v32, v33
    v_exp_f32 v35, v35
    v_exp_f32 v36, v36
    v_cvt_pk_bf16_f32 v33, v34, v35
    v_exp_f32 v37, v37
    v_mfma_f32_32x32x16_bf16 v[16:31], v[208:211], v[232:235], 0
    s_mov_b32 s37, 4096
    buffer_load_dwordx4 v[160:163], v7, s[16:19], s37 offen offset:0 sc1
    v_exp_f32 v38, v38
    v_cvt_pk_bf16_f32 v34, v36, v37
    v_exp_f32 v39, v39
    v_exp_f32 v40, v40
    v_cvt_pk_bf16_f32 v35, v38, v39
    v_mfma_f32_32x32x8_bf16 v[16:31], v[212:213], v[236:237], v[16:31]
    s_waitcnt lgkmcnt(0)
    s_mov_b32 s37, 4096
    buffer_load_dwordx4 v[164:167], v7, s[16:19], s37 offen offset:1024 sc1
    v_exp_f32 v41, v41
    v_exp_f32 v42, v42
    v_cvt_pk_bf16_f32 v36, v40, v41
    v_exp_f32 v43, v43
    v_exp_f32 v44, v44
    v_cvt_pk_bf16_f32 v37, v42, v43
    v_exp_f32 v45, v45
    v_exp_f32 v46, v46
    v_cvt_pk_bf16_f32 v38, v44, v45
    v_exp_f32 v47, v47
    v_mfma_f32_32x32x16_bf16 v[64:79], v[224:227], v[32:35], v[64:79]
    v_cvt_pk_bf16_f32 v39, v46, v47
    v_exp_f32 v16, v16
    v_exp_f32 v17, v17
    v_exp_f32 v18, v18
    v_mfma_f32_32x32x16_bf16 v[64:79], v[228:231], v[36:39], v[64:79]
    s_setprio 1
    s_mov_b32 s37, 4096
    buffer_load_dwordx4 v[168:171], v7, s[16:19], s37 offen offset:2048 sc1
    v_cvt_pk_bf16_f32 v16, v16, v17
    v_exp_f32 v19, v19
    v_exp_f32 v20, v20
    v_cvt_pk_bf16_f32 v17, v18, v19
    v_exp_f32 v21, v21
    v_mfma_f32_32x32x16_bf16 v[32:47], v[208:211], v[238:241], 0
    ds_read_b128 v[208:211], v4 offset:48640
    v_exp_f32 v22, v22
    v_cvt_pk_bf16_f32 v18, v20, v21
    v_exp_f32 v23, v23
    v_exp_f32 v24, v24
    v_cvt_pk_bf16_f32 v19, v22, v23
    v_mfma_f32_32x32x8_bf16 v[32:47], v[212:213], v[242:243], v[32:47]
    s_mov_b64 exec, s[34:35]
    ds_read_b64 v[212:213], v5 offset:49664
    s_mov_b64 exec, s[32:33]
    ds_read_b128 v[224:227], v6 offset:49920
    ds_read_b128 v[228:231], v6 offset:50560
    s_mov_b64 exec, -1
    v_exp_f32 v25, v25
    v_exp_f32 v26, v26
    v_cvt_pk_bf16_f32 v20, v24, v25
    v_exp_f32 v27, v27
    v_exp_f32 v28, v28
    v_cvt_pk_bf16_f32 v21, v26, v27
    v_exp_f32 v29, v29
    v_exp_f32 v30, v30
    v_cvt_pk_bf16_f32 v22, v28, v29
    v_exp_f32 v31, v31
    v_mfma_f32_32x32x16_bf16 v[48:63], v[216:219], v[16:19], v[48:63]
    s_mov_b32 s37, 4096
    buffer_load_dwordx4 v[172:175], v7, s[16:19], s37 offen offset:3072 sc1
    v_cvt_pk_bf16_f32 v23, v30, v31
    v_exp_f32 v32, v32
    v_exp_f32 v33, v33
    v_exp_f32 v34, v34
    v_mfma_f32_32x32x16_bf16 v[48:63], v[220:223], v[20:23], v[48:63]
    s_setprio 0
    s_waitcnt lgkmcnt(2)
    s_add_u32 m0, s64, 30720
    s_add_u32 s39, s66, 38400
    buffer_load_dwordx4 v11, s[16:19], s39 offen sc1 lds
    v_cvt_pk_bf16_f32 v32, v32, v33
    v_exp_f32 v35, v35
    v_exp_f32 v36, v36
    v_cvt_pk_bf16_f32 v33, v34, v35
    v_exp_f32 v37, v37
    v_mfma_f32_32x32x16_bf16 v[16:31], v[208:211], v[232:235], 0
    s_add_u32 m0, s64, 30720
    s_add_u32 s39, s66, 38400
    s_mov_b64 exec, s[68:69]
    buffer_load_dwordx4 v11, s[16:19], s39 offen offset:1024 lds
    s_mov_b64 exec, -1
    v_exp_f32 v38, v38
    v_cvt_pk_bf16_f32 v34, v36, v37
    v_exp_f32 v39, v39
    v_exp_f32 v40, v40
    v_cvt_pk_bf16_f32 v35, v38, v39
    v_mfma_f32_32x32x8_bf16 v[16:31], v[212:213], v[236:237], v[16:31]
    s_waitcnt lgkmcnt(0)
    v_exp_f32 v41, v41
    v_exp_f32 v42, v42
    v_cvt_pk_bf16_f32 v36, v40, v41
    v_exp_f32 v43, v43
    v_exp_f32 v44, v44
    v_cvt_pk_bf16_f32 v37, v42, v43
    v_exp_f32 v45, v45
    v_exp_f32 v46, v46
    v_cvt_pk_bf16_f32 v38, v44, v45
    v_exp_f32 v47, v47
    v_mfma_f32_32x32x16_bf16 v[64:79], v[216:219], v[32:35], v[64:79]
    s_cmp_eq_u32 s97, 0
    s_cbranch_scc1 K2_Z1_0G
    s_add_u32 s5, s97, 0
    buffer_store_dwordx4 v[128:131], v11, s[16:19], s5 offen sc1
K2_Z1_0G:
    v_cvt_pk_bf16_f32 v39, v46, v47
    s_waitcnt vmcnt(20)
    s_barrier
    v_exp_f32 v16, v16
    v_exp_f32 v17, v17
    v_exp_f32 v18, v18
    v_mfma_f32_32x32x16_bf16 v[64:79], v[220:223], v[36:39], v[64:79]
    s_setprio 3
    ds_read_b128 v[112:115], v180 offset:0
    ds_read_b128 v[116:119], v180 offset:4096
    v_cvt_pk_bf16_f32 v16, v16, v17
    v_exp_f32 v19, v19
    v_exp_f32 v20, v20
    v_mfma_f32_32x32x16_bf16 v[32:47], v[208:211], v[238:241], 0
    ds_read_b128 v[208:211], v4 offset:51200
    v_cvt_pk_bf16_f32 v17, v18, v19
    v_exp_f32 v21, v21
    v_exp_f32 v22, v22
    v_cvt_pk_bf16_f32 v18, v20, v21
    v_mfma_f32_32x32x8_bf16 v[32:47], v[212:213], v[242:243], v[32:47]
    s_mov_b64 exec, s[34:35]
    ds_read_b64 v[212:213], v5 offset:52224
    s_mov_b64 exec, s[32:33]
    ds_read_b128 v[216:219], v6 offset:52480
    ds_read_b128 v[220:223], v6 offset:53120
    s_mov_b64 exec, -1
    v_exp_f32 v23, v23
    v_exp_f32 v24, v24
    v_cvt_pk_bf16_f32 v19, v22, v23
    s_waitcnt vmcnt(9) lgkmcnt(5)
    v_mfma_f32_32x32x16_bf16 v[80:95], v[144:147], v[112:115], 0
    ds_read_b128 v[120:123], v181 offset:0
    ds_read_b128 v[124:127], v181 offset:4096
    v_exp_f32 v25, v25
    v_exp_f32 v26, v26
    v_cvt_pk_bf16_f32 v20, v24, v25
    v_exp_f32 v27, v27
    s_waitcnt lgkmcnt(6)
    v_mfma_f32_32x32x16_bf16 v[96:111], v[144:147], v[116:119], 0
    ds_read_b128 v[112:115], v182 offset:0
    s_mov_b32 s37, 8192
    buffer_load_dwordx4 v[144:147], v7, s[16:19], s37 offen offset:0 sc1
    v_exp_f32 v28, v28
    v_cvt_pk_bf16_f32 v21, v26, v27
    v_exp_f32 v29, v29
    v_exp_f32 v30, v30
    s_waitcnt vmcnt(9) lgkmcnt(2)
    v_mfma_f32_32x32x16_bf16 v[80:95], v[148:151], v[120:123], v[80:95]
    ds_read_b128 v[116:119], v182 offset:4096
    v_cvt_pk_bf16_f32 v22, v28, v29
    v_exp_f32 v31, v31
    v_mfma_f32_32x32x16_bf16 v[48:63], v[224:227], v[16:19], v[48:63]
    v_cvt_pk_bf16_f32 v23, v30, v31
    v_exp_f32 v32, v32
    v_exp_f32 v33, v33
    v_exp_f32 v34, v34
    v_mfma_f32_32x32x16_bf16 v[48:63], v[228:231], v[20:23], v[48:63]
    v_cvt_pk_bf16_f32 v32, v32, v33
    v_exp_f32 v35, v35
    v_exp_f32 v36, v36
    v_mfma_f32_32x32x16_bf16 v[16:31], v[208:211], v[232:235], 0
    v_cvt_pk_bf16_f32 v33, v34, v35
    v_exp_f32 v37, v37
    v_exp_f32 v38, v38
    v_cvt_pk_bf16_f32 v34, v36, v37
    v_mfma_f32_32x32x8_bf16 v[16:31], v[212:213], v[236:237], v[16:31]
    v_exp_f32 v39, v39
    v_exp_f32 v40, v40
    v_cvt_pk_bf16_f32 v35, v38, v39
    s_waitcnt lgkmcnt(2)
    v_mfma_f32_32x32x16_bf16 v[96:111], v[148:151], v[124:127], v[96:111]
    ds_read_b128 v[120:123], v183 offset:0
    s_mov_b32 s37, 8192
    buffer_load_dwordx4 v[148:151], v7, s[16:19], s37 offen offset:1024 sc1
    v_exp_f32 v41, v41
    v_exp_f32 v42, v42
    v_cvt_pk_bf16_f32 v36, v40, v41
    v_exp_f32 v43, v43
    s_waitcnt vmcnt(9) lgkmcnt(2)
    v_mfma_f32_32x32x16_bf16 v[80:95], v[152:155], v[112:115], v[80:95]
    ds_read_b128 v[124:127], v183 offset:4096
    v_exp_f32 v44, v44
    v_cvt_pk_bf16_f32 v37, v42, v43
    v_exp_f32 v45, v45
    v_exp_f32 v46, v46
    s_waitcnt lgkmcnt(2)
    v_mfma_f32_32x32x16_bf16 v[96:111], v[152:155], v[116:119], v[96:111]
    ds_read_b128 v[112:115], v180 offset:8192
    s_mov_b32 s37, 8192
    buffer_load_dwordx4 v[152:155], v7, s[16:19], s37 offen offset:2048 sc1
    v_cvt_pk_bf16_f32 v38, v44, v45
    v_exp_f32 v47, v47
    v_mfma_f32_32x32x16_bf16 v[64:79], v[224:227], v[32:35], v[64:79]
    v_cvt_pk_bf16_f32 v39, v46, v47
    v_exp_f32 v16, v16
    v_exp_f32 v17, v17
    v_exp_f32 v18, v18
    v_mfma_f32_32x32x16_bf16 v[64:79], v[228:231], v[36:39], v[64:79]
    s_setprio 2
    v_cvt_pk_bf16_f32 v16, v16, v17
    v_exp_f32 v19, v19
    v_exp_f32 v20, v20
    v_mfma_f32_32x32x16_bf16 v[32:47], v[208:211], v[238:241], 0
    ds_read_b128 v[208:211], v4 offset:0
    v_cvt_pk_bf16_f32 v17, v18, v19
    v_exp_f32 v21, v21
    v_exp_f32 v22, v22
    v_mfma_f32_32x32x8_bf16 v[32:47], v[212:213], v[242:243], v[32:47]
    s_mov_b64 exec, s[34:35]
    ds_read_b64 v[212:213], v5 offset:1024
    s_mov_b64 exec, s[32:33]
    ds_read_b128 v[224:227], v6 offset:1280
    ds_read_b128 v[228:231], v6 offset:1920
    s_mov_b64 exec, -1
    v_cvt_pk_bf16_f32 v18, v20, v21
    v_exp_f32 v23, v23
    v_exp_f32 v24, v24
    s_waitcnt vmcnt(9) lgkmcnt(6)
    v_mfma_f32_32x32x16_bf16 v[80:95], v[156:159], v[120:123], v[80:95]
    ds_read_b128 v[116:119], v180 offset:12288
    v_cvt_pk_bf16_f32 v19, v22, v23
    v_exp_f32 v25, v25
    v_exp_f32 v26, v26
    s_waitcnt lgkmcnt(6)
    v_mfma_f32_32x32x16_bf16 v[96:111], v[156:159], v[124:127], v[96:111]
    ds_read_b128 v[120:123], v181 offset:8192
    s_mov_b32 s37, 8192
    buffer_load_dwordx4 v[156:159], v7, s[16:19], s37 offen offset:3072 sc1
    v_cvt_pk_bf16_f32 v20, v24, v25
    v_exp_f32 v27, v27
    v_exp_f32 v28, v28
    s_waitcnt vmcnt(9) lgkmcnt(6)
    v_mfma_f32_32x32x16_bf16 v[80:95], v[160:163], v[112:115], v[80:95]
    ds_read_b128 v[124:127], v181 offset:12288
    s_cmp_eq_u32 s97, 0
    s_cbranch_scc1 K2_Z1_1G
    s_add_u32 s5, s97, 1024
    buffer_store_dwordx4 v[132:135], v11, s[16:19], s5 offen sc1
K2_Z1_1G:
    v_cvt_pk_bf16_f32 v21, v26, v27
    v_exp_f32 v29, v29
    v_exp_f32 v30, v30
    s_waitcnt lgkmcnt(2)
    v_mfma_f32_32x32x16_bf16 v[96:111], v[160:163], v[116:119], v[96:111]
    ds_read_b128 v[112:115], v182 offset:8192
    s_mov_b32 s37, 12288
    buffer_load_dwordx4 v[160:163], v7, s[16:19], s37 offen offset:0 sc1
    v_cvt_pk_bf16_f32 v22, v28, v29
    v_exp_f32 v31, v31
    v_mfma_f32_32x32x16_bf16 v[48:63], v[216:219], v[16:19], v[48:63]
    v_cvt_pk_bf16_f32 v23, v30, v31
    v_exp_f32 v32, v32
    v_exp_f32 v33, v33
    v_exp_f32 v34, v34
    v_mfma_f32_32x32x16_bf16 v[48:63], v[220:223], v[20:23], v[48:63]
    s_setprio 1
    v_cvt_pk_bf16_f32 v32, v32, v33
    v_exp_f32 v35, v35
    v_exp_f32 v36, v36
    v_mfma_f32_32x32x16_bf16 v[16:31], v[208:211], v[232:235], 0
    v_cvt_pk_bf16_f32 v33, v34, v35
    v_exp_f32 v37, v37
    v_exp_f32 v38, v38
    v_cvt_pk_bf16_f32 v34, v36, v37
    v_mfma_f32_32x32x8_bf16 v[16:31], v[212:213], v[236:237], v[16:31]
    v_exp_f32 v39, v39
    v_exp_f32 v40, v40
    v_cvt_pk_bf16_f32 v35, v38, v39
    s_waitcnt vmcnt(9) lgkmcnt(2)
    v_mfma_f32_32x32x16_bf16 v[80:95], v[164:167], v[120:123], v[80:95]
    ds_read_b128 v[116:119], v182 offset:12288
    v_exp_f32 v41, v41
    v_exp_f32 v42, v42
    v_cvt_pk_bf16_f32 v36, v40, v41
    v_exp_f32 v43, v43
    s_waitcnt lgkmcnt(2)
    v_mfma_f32_32x32x16_bf16 v[96:111], v[164:167], v[124:127], v[96:111]
    ds_read_b128 v[120:123], v183 offset:8192
    s_mov_b32 s37, 12288
    buffer_load_dwordx4 v[164:167], v7, s[16:19], s37 offen offset:1024 sc1
    v_exp_f32 v44, v44
    v_cvt_pk_bf16_f32 v37, v42, v43
    v_exp_f32 v45, v45
    v_exp_f32 v46, v46
    s_waitcnt vmcnt(9) lgkmcnt(2)
    v_mfma_f32_32x32x16_bf16 v[80:95], v[168:171], v[112:115], v[80:95]
    ds_read_b128 v[124:127], v183 offset:12288
    v_cvt_pk_bf16_f32 v38, v44, v45
    v_exp_f32 v47, v47
    v_mfma_f32_32x32x16_bf16 v[64:79], v[216:219], v[32:35], v[64:79]
    v_cvt_pk_bf16_f32 v39, v46, v47
    v_exp_f32 v16, v16
    v_exp_f32 v17, v17
    v_exp_f32 v18, v18
    v_mfma_f32_32x32x16_bf16 v[64:79], v[220:223], v[36:39], v[64:79]
    s_setprio 0
    v_cvt_pk_bf16_f32 v16, v16, v17
    v_exp_f32 v19, v19
    v_exp_f32 v20, v20
    v_mfma_f32_32x32x16_bf16 v[32:47], v[208:211], v[238:241], 0
    ds_read_b128 v[208:211], v4 offset:2560
    v_cvt_pk_bf16_f32 v17, v18, v19
    v_exp_f32 v21, v21
    v_exp_f32 v22, v22
    v_cvt_pk_bf16_f32 v18, v20, v21
    v_mfma_f32_32x32x8_bf16 v[32:47], v[212:213], v[242:243], v[32:47]
    s_mov_b64 exec, s[34:35]
    ds_read_b64 v[212:213], v5 offset:3584
    s_mov_b64 exec, s[32:33]
    ds_read_b128 v[216:219], v6 offset:3840
    ds_read_b128 v[220:223], v6 offset:4480
    s_mov_b64 exec, -1
    v_exp_f32 v23, v23
    v_exp_f32 v24, v24
    v_cvt_pk_bf16_f32 v19, v22, v23
    s_waitcnt lgkmcnt(6)
    v_mfma_f32_32x32x16_bf16 v[96:111], v[168:171], v[116:119], v[96:111]
    s_mov_b32 s37, 12288
    buffer_load_dwordx4 v[168:171], v7, s[16:19], s37 offen offset:2048 sc1
    v_exp_f32 v25, v25
    v_exp_f32 v26, v26
    v_cvt_pk_bf16_f32 v20, v24, v25
    v_exp_f32 v27, v27
    s_waitcnt vmcnt(9) lgkmcnt(5)
    v_mfma_f32_32x32x16_bf16 v[80:95], v[172:175], v[120:123], v[80:95]
    v_exp_f32 v28, v28
    v_cvt_pk_bf16_f32 v21, v26, v27
    v_exp_f32 v29, v29
    v_exp_f32 v30, v30
    s_waitcnt lgkmcnt(4)
    v_mfma_f32_32x32x16_bf16 v[96:111], v[172:175], v[124:127], v[96:111]
    s_mov_b32 s37, 12288
    buffer_load_dwordx4 v[172:175], v7, s[16:19], s37 offen offset:3072 sc1
    v_cvt_pk_bf16_f32 v22, v28, v29
    v_exp_f32 v31, v31
    v_mfma_f32_32x32x16_bf16 v[48:63], v[224:227], v[16:19], v[48:63]
    v_cvt_pk_bf16_f32 v23, v30, v31
    s_waitcnt lgkmcnt(0)
    s_barrier
    v_exp_f32 v32, v32
    v_exp_f32 v33, v33
    v_exp_f32 v34, v34
    v_mfma_f32_32x32x16_bf16 v[48:63], v[228:231], v[20:23], v[48:63]
    s_setprio 3
    ds_read_b128 v[112:115], v176 offset:0
    ds_read_b128 v[116:119], v176 offset:4096
    v_cvt_pk_bf16_f32 v32, v32, v33
    v_exp_f32 v35, v35
    v_exp_f32 v36, v36
    v_mfma_f32_32x32x16_bf16 v[16:31], v[208:211], v[232:235], 0
    v_cvt_pk_bf16_f32 v33, v34, v35
    v_exp_f32 v37, v37
    v_exp_f32 v38, v38
    v_cvt_pk_bf16_f32 v34, v36, v37
    v_mfma_f32_32x32x8_bf16 v[16:31], v[212:213], v[236:237], v[16:31]
    v_exp_f32 v39, v39
    v_exp_f32 v40, v40
    v_cvt_pk_bf16_f32 v35, v38, v39
    s_waitcnt vmcnt(7) lgkmcnt(1)
    v_mfma_f32_32x32x16_bf16 v[80:95], v[144:147], v[112:115], v[80:95]
    ds_read_b128 v[120:123], v177 offset:0
    ds_read_b128 v[124:127], v177 offset:4096
    v_exp_f32 v41, v41
    v_exp_f32 v42, v42
    v_cvt_pk_bf16_f32 v36, v40, v41
    v_exp_f32 v43, v43
    s_waitcnt lgkmcnt(2)
    v_mfma_f32_32x32x16_bf16 v[96:111], v[144:147], v[116:119], v[96:111]
    ds_read_b128 v[112:115], v178 offset:0
    s_mov_b32 s37, 16384
    buffer_load_dwordx4 v[144:147], v7, s[16:19], s37 offen offset:0 sc1
    v_exp_f32 v44, v44
    v_cvt_pk_bf16_f32 v37, v42, v43
    v_exp_f32 v45, v45
    v_exp_f32 v46, v46
    s_waitcnt vmcnt(7) lgkmcnt(2)
    v_mfma_f32_32x32x16_bf16 v[80:95], v[148:151], v[120:123], v[80:95]
    ds_read_b128 v[116:119], v178 offset:4096
    s_cmp_eq_u32 s97, 0
    s_cbranch_scc1 K2_Z1_2G
    s_add_u32 s5, s97, 2048
    buffer_store_dwordx4 v[136:139], v11, s[16:19], s5 offen sc1
K2_Z1_2G:
    v_cvt_pk_bf16_f32 v38, v44, v45
    v_exp_f32 v47, v47
    v_mfma_f32_32x32x16_bf16 v[64:79], v[224:227], v[32:35], v[64:79]
    v_cvt_pk_bf16_f32 v39, v46, v47
    v_exp_f32 v16, v16
    v_exp_f32 v17, v17
    v_exp_f32 v18, v18
    v_mfma_f32_32x32x16_bf16 v[64:79], v[228:231], v[36:39], v[64:79]
    s_add_u32 m0, s65, 65536
    s_mov_b32 s39, 768
    buffer_load_dwordx4 v9, s[20:23], s39 offen lds
    v_cvt_pk_bf16_f32 v16, v16, v17
    v_exp_f32 v19, v19
    v_exp_f32 v20, v20
    v_mfma_f32_32x32x16_bf16 v[32:47], v[208:211], v[238:241], 0
    ds_read_b128 v[208:211], v4 offset:5120
    v_cvt_pk_bf16_f32 v17, v18, v19
    v_exp_f32 v21, v21
    v_exp_f32 v22, v22
    v_cvt_pk_bf16_f32 v18, v20, v21
    v_mfma_f32_32x32x8_bf16 v[32:47], v[212:213], v[242:243], v[32:47]
    s_mov_b64 exec, s[34:35]
    ds_read_b64 v[212:213], v5 offset:6144
    s_mov_b64 exec, s[32:33]
    ds_read_b128 v[224:227], v6 offset:6400
    ds_read_b128 v[228:231], v6 offset:7040
    s_mov_b64 exec, -1
    v_exp_f32 v23, v23
    v_exp_f32 v24, v24
    v_cvt_pk_bf16_f32 v19, v22, v23
    s_waitcnt lgkmcnt(6)
    v_mfma_f32_32x32x16_bf16 v[96:111], v[148:151], v[124:127], v[96:111]
    ds_read_b128 v[120:123], v179 offset:0
    s_mov_b32 s37, 16384
    buffer_load_dwordx4 v[148:151], v7, s[16:19], s37 offen offset:1024 sc1
    v_exp_f32 v25, v25
    v_exp_f32 v26, v26
    v_cvt_pk_bf16_f32 v20, v24, v25
    v_exp_f32 v27, v27
    s_waitcnt vmcnt(8) lgkmcnt(6)
    v_mfma_f32_32x32x16_bf16 v[80:95], v[152:155], v[112:115], v[80:95]
    ds_read_b128 v[124:127], v179 offset:4096
    s_add_u32 m0, s65, 66560
    s_mov_b32 s39, 33536
    buffer_load_dwordx4 v10, s[20:23], s39 offen lds
    v_exp_f32 v28, v28
    v_cvt_pk_bf16_f32 v21, v26, v27
    v_exp_f32 v29, v29
    v_exp_f32 v30, v30
    s_waitcnt lgkmcnt(6)
    v_mfma_f32_32x32x16_bf16 v[96:111], v[152:155], v[116:119], v[96:111]
    ds_read_b128 v[112:115], v176 offset:8192
    s_mov_b32 s37, 16384
    buffer_load_dwordx4 v[152:155], v7, s[16:19], s37 offen offset:2048 sc1
    v_cvt_pk_bf16_f32 v22, v28, v29
    v_exp_f32 v31, v31
    v_mfma_f32_32x32x16_bf16 v[48:63], v[216:219], v[16:19], v[48:63]
    v_cvt_pk_bf16_f32 v23, v30, v31
    v_exp_f32 v32, v32
    v_exp_f32 v33, v33
    v_exp_f32 v34, v34
    v_mfma_f32_32x32x16_bf16 v[48:63], v[220:223], v[20:23], v[48:63]
    s_setprio 2
    s_waitcnt lgkmcnt(5)
    s_add_u32 m0, s65, 67584
    s_mov_b32 s39, 66304
    buffer_load_dwordx4 v9, s[20:23], s39 offen lds
    v_cvt_pk_bf16_f32 v32, v32, v33
    v_exp_f32 v35, v35
    v_exp_f32 v36, v36
    v_mfma_f32_32x32x16_bf16 v[16:31], v[208:211], v[232:235], 0
    s_add_u32 m0, s65, 68608
    s_mov_b32 s39, 99072
    buffer_load_dwordx4 v10, s[20:23], s39 offen lds
    v_cvt_pk_bf16_f32 v33, v34, v35
    v_exp_f32 v37, v37
    v_exp_f32 v38, v38
    v_mfma_f32_32x32x8_bf16 v[16:31], v[212:213], v[236:237], v[16:31]
    s_waitcnt lgkmcnt(3)
    v_cvt_pk_bf16_f32 v34, v36, v37
    v_exp_f32 v39, v39
    v_exp_f32 v40, v40
    s_waitcnt vmcnt(11) lgkmcnt(2)
    v_mfma_f32_32x32x16_bf16 v[80:95], v[156:159], v[120:123], v[80:95]
    ds_read_b128 v[116:119], v176 offset:12288
    v_cvt_pk_bf16_f32 v35, v38, v39
    v_exp_f32 v41, v41
    v_exp_f32 v42, v42
    s_waitcnt lgkmcnt(2)
    v_mfma_f32_32x32x16_bf16 v[96:111], v[156:159], v[124:127], v[96:111]
    ds_read_b128 v[120:123], v177 offset:8192
    s_mov_b32 s37, 16384
    buffer_load_dwordx4 v[156:159], v7, s[16:19], s37 offen offset:3072 sc1
    v_cvt_pk_bf16_f32 v36, v40, v41
    v_exp_f32 v43, v43
    v_exp_f32 v44, v44
    s_waitcnt vmcnt(11) lgkmcnt(2)
    v_mfma_f32_32x32x16_bf16 v[80:95], v[160:163], v[112:115], v[80:95]
    ds_read_b128 v[124:127], v177 offset:12288
    v_cvt_pk_bf16_f32 v37, v42, v43
    v_exp_f32 v45, v45
    v_exp_f32 v46, v46
    s_waitcnt lgkmcnt(2)
    v_mfma_f32_32x32x16_bf16 v[96:111], v[160:163], v[116:119], v[96:111]
    ds_read_b128 v[112:115], v178 offset:8192
    s_mov_b32 s37, 20480
    buffer_load_dwordx4 v[160:163], v7, s[16:19], s37 offen offset:0 sc1
    v_cvt_pk_bf16_f32 v38, v44, v45
    v_exp_f32 v47, v47
    v_mfma_f32_32x32x16_bf16 v[64:79], v[216:219], v[32:35], v[64:79]
    v_cvt_pk_bf16_f32 v39, v46, v47
    v_exp_f32 v16, v16
    v_exp_f32 v17, v17
    v_exp_f32 v18, v18
    v_mfma_f32_32x32x16_bf16 v[64:79], v[220:223], v[36:39], v[64:79]
    s_setprio 1
    v_cvt_pk_bf16_f32 v16, v16, v17
    v_exp_f32 v19, v19
    v_exp_f32 v20, v20
    v_mfma_f32_32x32x16_bf16 v[32:47], v[208:211], v[238:241], 0
    ds_read_b128 v[208:211], v4 offset:15360
    v_cvt_pk_bf16_f32 v17, v18, v19
    v_exp_f32 v21, v21
    v_exp_f32 v22, v22
    v_cvt_pk_bf16_f32 v18, v20, v21
    v_mfma_f32_32x32x8_bf16 v[32:47], v[212:213], v[242:243], v[32:47]
    s_mov_b64 exec, s[34:35]
    ds_read_b64 v[212:213], v5 offset:16384
    s_mov_b64 exec, s[32:33]
    ds_read_b128 v[216:219], v6 offset:16640
    ds_read_b128 v[220:223], v6 offset:17280
    s_mov_b64 exec, -1
    v_exp_f32 v23, v23
    v_exp_f32 v24, v24
    v_cvt_pk_bf16_f32 v19, v22, v23
    s_waitcnt vmcnt(11) lgkmcnt(6)
    v_mfma_f32_32x32x16_bf16 v[80:95], v[164:167], v[120:123], v[80:95]
    ds_read_b128 v[116:119], v178 offset:12288
    v_exp_f32 v25, v25
    v_exp_f32 v26, v26
    v_cvt_pk_bf16_f32 v20, v24, v25
    v_exp_f32 v27, v27
    s_waitcnt lgkmcnt(6)
    v_mfma_f32_32x32x16_bf16 v[96:111], v[164:167], v[124:127], v[96:111]
    ds_read_b128 v[120:123], v179 offset:8192
    s_mov_b32 s37, 20480
    buffer_load_dwordx4 v[164:167], v7, s[16:19], s37 offen offset:1024 sc1
    v_exp_f32 v28, v28
    v_cvt_pk_bf16_f32 v21, v26, v27
    v_exp_f32 v29, v29
    v_exp_f32 v30, v30
    s_waitcnt vmcnt(11) lgkmcnt(6)
    v_mfma_f32_32x32x16_bf16 v[80:95], v[168:171], v[112:115], v[80:95]
    ds_read_b128 v[124:127], v179 offset:12288
    s_cmp_eq_u32 s97, 0
    s_cbranch_scc1 K2_Z1_3G
    s_add_u32 s5, s97, 3072
    buffer_store_dwordx4 v[140:143], v11, s[16:19], s5 offen sc1
K2_Z1_3G:
    v_cvt_pk_bf16_f32 v22, v28, v29
    v_exp_f32 v31, v31
    v_mfma_f32_32x32x16_bf16 v[48:63], v[224:227], v[16:19], v[48:63]
    v_cvt_pk_bf16_f32 v23, v30, v31
    v_exp_f32 v32, v32
    v_exp_f32 v33, v33
    v_exp_f32 v34, v34
    v_mfma_f32_32x32x16_bf16 v[48:63], v[228:231], v[20:23], v[48:63]
    s_setprio 0
    s_waitcnt lgkmcnt(5)
    s_add_u32 m0, s64, 46080
    s_add_u32 s39, s66, 46080
    buffer_load_dwordx4 v11, s[16:19], s39 offen sc1 lds
    v_cvt_pk_bf16_f32 v32, v32, v33
    v_exp_f32 v35, v35
    v_exp_f32 v36, v36
    v_mfma_f32_32x32x16_bf16 v[16:31], v[208:211], v[232:235], 0
    s_add_u32 m0, s64, 46080
    s_add_u32 s39, s66, 46080
    s_mov_b64 exec, s[68:69]
    buffer_load_dwordx4 v11, s[16:19], s39 offen offset:1024 lds
    s_mov_b64 exec, -1
    v_cvt_pk_bf16_f32 v33, v34, v35
    v_exp_f32 v37, v37
    v_exp_f32 v38, v38
    v_cvt_pk_bf16_f32 v34, v36, v37
    v_mfma_f32_32x32x8_bf16 v[16:31], v[212:213], v[236:237], v[16:31]
    s_waitcnt lgkmcnt(3)
    v_exp_f32 v39, v39
    v_exp_f32 v40, v40
    v_cvt_pk_bf16_f32 v35, v38, v39
    s_waitcnt lgkmcnt(2)
    v_mfma_f32_32x32x16_bf16 v[96:111], v[168:171], v[116:119], v[96:111]
    s_mov_b32 s37, 20480
    buffer_load_dwordx4 v[168:171], v7, s[16:19], s37 offen offset:2048 sc1
    v_exp_f32 v41, v41
    v_exp_f32 v42, v42
    v_cvt_pk_bf16_f32 v36, v40, v41
    v_exp_f32 v43, v43
    s_waitcnt vmcnt(13) lgkmcnt(1)
    v_mfma_f32_32x32x16_bf16 v[80:95], v[172:175], v[120:123], v[80:95]
    v_exp_f32 v44, v44
    v_cvt_pk_bf16_f32 v37, v42, v43
    v_exp_f32 v45, v45
    v_exp_f32 v46, v46
    s_waitcnt lgkmcnt(0)
    v_mfma_f32_32x32x16_bf16 v[96:111], v[172:175], v[124:127], v[96:111]
    s_mov_b32 s37, 20480
    buffer_load_dwordx4 v[172:175], v7, s[16:19], s37 offen offset:3072 sc1
    v_cvt_pk_bf16_f32 v38, v44, v45
    v_exp_f32 v47, v47
    v_mfma_f32_32x32x16_bf16 v[64:79], v[224:227], v[32:35], v[64:79]
    v_cvt_pk_bf16_f32 v39, v46, v47
    s_barrier
    v_exp_f32 v16, v16
    v_exp_f32 v17, v17
    v_exp_f32 v18, v18
    v_mfma_f32_32x32x16_bf16 v[64:79], v[228:231], v[36:39], v[64:79]
    s_setprio 3
    ds_read_b128 v[112:115], v176 offset:32768
    ds_read_b128 v[116:119], v176 offset:36864
    v_cvt_pk_bf16_f32 v16, v16, v17
    v_exp_f32 v19, v19
    v_exp_f32 v20, v20
    v_mfma_f32_32x32x16_bf16 v[32:47], v[208:211], v[238:241], 0
    ds_read_b128 v[208:211], v4 offset:17920
    v_cvt_pk_bf16_f32 v17, v18, v19
    v_exp_f32 v21, v21
    v_exp_f32 v22, v22
    v_cvt_pk_bf16_f32 v18, v20, v21
    v_mfma_f32_32x32x8_bf16 v[32:47], v[212:213], v[242:243], v[32:47]
    s_mov_b64 exec, s[34:35]
    ds_read_b64 v[212:213], v5 offset:18944
    s_mov_b64 exec, s[32:33]
    ds_read_b128 v[224:227], v6 offset:19200
    ds_read_b128 v[228:231], v6 offset:19840
    s_mov_b64 exec, -1
    v_exp_f32 v23, v23
    v_exp_f32 v24, v24
    v_cvt_pk_bf16_f32 v19, v22, v23
    s_waitcnt vmcnt(13) lgkmcnt(5)
    v_mfma_f32_32x32x16_bf16 v[80:95], v[144:147], v[112:115], v[80:95]
    ds_read_b128 v[120:123], v177 offset:32768
    ds_read_b128 v[124:127], v177 offset:36864
    v_exp_f32 v25, v25
    v_exp_f32 v26, v26
    v_cvt_pk_bf16_f32 v20, v24, v25
    v_exp_f32 v27, v27
    s_waitcnt lgkmcnt(6)
    v_mfma_f32_32x32x16_bf16 v[96:111], v[144:147], v[116:119], v[96:111]
    ds_read_b128 v[112:115], v178 offset:32768
    s_mov_b32 s37, 24576
    buffer_load_dwordx4 v[144:147], v7, s[16:19], s37 offen offset:0 sc1
    v_exp_f32 v28, v28
    v_cvt_pk_bf16_f32 v21, v26, v27
    v_exp_f32 v29, v29
    v_exp_f32 v30, v30
    s_waitcnt vmcnt(12) lgkmcnt(2)
    v_mfma_f32_32x32x16_bf16 v[80:95], v[148:151], v[120:123], v[80:95]
    ds_read_b128 v[116:119], v178 offset:36864
    v_cvt_pk_bf16_f32 v22, v28, v29
    v_exp_f32 v31, v31
    v_mfma_f32_32x32x16_bf16 v[48:63], v[216:219], v[16:19], v[48:63]
    v_cvt_pk_bf16_f32 v23, v30, v31
    v_exp_f32 v32, v32
    v_exp_f32 v33, v33
    v_exp_f32 v34, v34
    v_mfma_f32_32x32x16_bf16 v[48:63], v[220:223], v[20:23], v[48:63]
    s_add_u32 m0, s65, 0
    s_mov_b32 s39, 1024
    buffer_load_dwordx4 v9, s[20:23], s39 offen lds
    v_cvt_pk_bf16_f32 v32, v32, v33
    v_exp_f32 v35, v35
    v_exp_f32 v36, v36
    v_mfma_f32_32x32x16_bf16 v[16:31], v[208:211], v[232:235], 0
    s_add_u32 m0, s65, 1024
    s_mov_b32 s39, 33792
    buffer_load_dwordx4 v10, s[20:23], s39 offen lds
    v_cvt_pk_bf16_f32 v33, v34, v35
    v_exp_f32 v37, v37
    v_exp_f32 v38, v38
    v_cvt_pk_bf16_f32 v34, v36, v37
    v_mfma_f32_32x32x8_bf16 v[16:31], v[212:213], v[236:237], v[16:31]
    v_exp_f32 v39, v39
    v_exp_f32 v40, v40
    v_cvt_pk_bf16_f32 v35, v38, v39
    s_waitcnt lgkmcnt(2)
    v_mfma_f32_32x32x16_bf16 v[96:111], v[148:151], v[124:127], v[96:111]
    ds_read_b128 v[120:123], v179 offset:32768
    s_mov_b32 s37, 24576
    buffer_load_dwordx4 v[148:151], v7, s[16:19], s37 offen offset:1024 sc1
    v_exp_f32 v41, v41
    v_exp_f32 v42, v42
    v_cvt_pk_bf16_f32 v36, v40, v41
    v_exp_f32 v43, v43
    s_waitcnt vmcnt(13) lgkmcnt(2)
    v_mfma_f32_32x32x16_bf16 v[80:95], v[152:155], v[112:115], v[80:95]
    ds_read_b128 v[124:127], v179 offset:36864
    v_exp_f32 v44, v44
    v_cvt_pk_bf16_f32 v37, v42, v43
    v_exp_f32 v45, v45
    v_exp_f32 v46, v46
    s_waitcnt lgkmcnt(2)
    v_mfma_f32_32x32x16_bf16 v[96:111], v[152:155], v[116:119], v[96:111]
    ds_read_b128 v[112:115], v176 offset:40960
    s_mov_b32 s37, 24576
    buffer_load_dwordx4 v[152:155], v7, s[16:19], s37 offen offset:2048 sc1
    v_cvt_pk_bf16_f32 v38, v44, v45
    v_exp_f32 v47, v47
    v_mfma_f32_32x32x16_bf16 v[64:79], v[216:219], v[32:35], v[64:79]
    s_cmp_eq_u32 s97, 0
    s_cbranch_scc1 K2_Z1_4G
    s_add_u32 s5, s97, 4096
    buffer_store_dwordx4 v[184:187], v11, s[16:19], s5 offen sc1
K2_Z1_4G:
    v_cvt_pk_bf16_f32 v39, v46, v47
    v_exp_f32 v16, v16
    v_exp_f32 v17, v17
    v_exp_f32 v18, v18
    v_mfma_f32_32x32x16_bf16 v[64:79], v[220:223], v[36:39], v[64:79]
    s_setprio 2
    s_add_u32 m0, s65, 2048
    s_mov_b32 s39, 66560
    buffer_load_dwordx4 v9, s[20:23], s39 offen lds
    v_cvt_pk_bf16_f32 v16, v16, v17
    v_exp_f32 v19, v19
    v_exp_f32 v20, v20
    v_mfma_f32_32x32x16_bf16 v[32:47], v[208:211], v[238:241], 0
    ds_read_b128 v[208:211], v4 offset:20480
    v_cvt_pk_bf16_f32 v17, v18, v19
    v_exp_f32 v21, v21
    v_exp_f32 v22, v22
    v_mfma_f32_32x32x8_bf16 v[32:47], v[212:213], v[242:243], v[32:47]
    s_mov_b64 exec, s[34:35]
    ds_read_b64 v[212:213], v5 offset:21504
    s_mov_b64 exec, s[32:33]
    ds_read_b128 v[216:219], v6 offset:21760
    ds_read_b128 v[220:223], v6 offset:22400
    s_mov_b64 exec, -1
    v_cvt_pk_bf16_f32 v18, v20, v21
    v_exp_f32 v23, v23
    v_exp_f32 v24, v24
    s_waitcnt vmcnt(12) lgkmcnt(6)
    v_mfma_f32_32x32x16_bf16 v[80:95], v[156:159], v[120:123], v[80:95]
    ds_read_b128 v[116:119], v176 offset:45056
    s_add_u32 m0, s65, 3072
    s_mov_b32 s39, 99328
    buffer_load_dwordx4 v10, s[20:23], s39 offen lds
    v_cvt_pk_bf16_f32 v19, v22, v23
    v_exp_f32 v25, v25
    v_exp_f32 v26, v26
    s_waitcnt lgkmcnt(6)
    v_mfma_f32_32x32x16_bf16 v[96:111], v[156:159], v[124:127], v[96:111]
    ds_read_b128 v[120:123], v177 offset:40960
    s_mov_b32 s37, 24576
    buffer_load_dwordx4 v[156:159], v7, s[16:19], s37 offen offset:3072 sc1
    v_cvt_pk_bf16_f32 v20, v24, v25
    v_exp_f32 v27, v27
    v_exp_f32 v28, v28
    s_waitcnt vmcnt(13) lgkmcnt(6)
    v_mfma_f32_32x32x16_bf16 v[80:95], v[160:163], v[112:115], v[80:95]
    ds_read_b128 v[124:127], v177 offset:45056
    v_cvt_pk_bf16_f32 v21, v26, v27
    v_exp_f32 v29, v29
    v_exp_f32 v30, v30
    s_waitcnt lgkmcnt(2)
    v_mfma_f32_32x32x16_bf16 v[96:111], v[160:163], v[116:119], v[96:111]
    ds_read_b128 v[112:115], v178 offset:40960
    s_mov_b32 s37, 28672
    buffer_load_dwordx4 v[160:163], v7, s[16:19], s37 offen offset:0 sc1
    v_cvt_pk_bf16_f32 v22, v28, v29
    v_exp_f32 v31, v31
    v_mfma_f32_32x32x16_bf16 v[48:63], v[224:227], v[16:19], v[48:63]
    v_cvt_pk_bf16_f32 v23, v30, v31
    v_exp_f32 v32, v32
    v_exp_f32 v33, v33
    v_exp_f32 v34, v34
    v_mfma_f32_32x32x16_bf16 v[48:63], v[228:231], v[20:23], v[48:63]
    s_setprio 1
    v_cvt_pk_bf16_f32 v32, v32, v33
    v_exp_f32 v35, v35
    v_exp_f32 v36, v36
    v_mfma_f32_32x32x16_bf16 v[16:31], v[208:211], v[232:235], 0
    v_cvt_pk_bf16_f32 v33, v34, v35
    v_exp_f32 v37, v37
    v_exp_f32 v38, v38
    v_cvt_pk_bf16_f32 v34, v36, v37
    v_mfma_f32_32x32x8_bf16 v[16:31], v[212:213], v[236:237], v[16:31]
    v_exp_f32 v39, v39
    v_exp_f32 v40, v40
    v_cvt_pk_bf16_f32 v35, v38, v39
    s_waitcnt vmcnt(13) lgkmcnt(2)
    v_mfma_f32_32x32x16_bf16 v[80:95], v[164:167], v[120:123], v[80:95]
    ds_read_b128 v[116:119], v178 offset:45056
    v_exp_f32 v41, v41
    v_exp_f32 v42, v42
    v_cvt_pk_bf16_f32 v36, v40, v41
    v_exp_f32 v43, v43
    s_waitcnt lgkmcnt(2)
    v_mfma_f32_32x32x16_bf16 v[96:111], v[164:167], v[124:127], v[96:111]
    ds_read_b128 v[120:123], v179 offset:40960
    s_mov_b32 s37, 28672
    buffer_load_dwordx4 v[164:167], v7, s[16:19], s37 offen offset:1024 sc1
    v_exp_f32 v44, v44
    v_cvt_pk_bf16_f32 v37, v42, v43
    v_exp_f32 v45, v45
    v_exp_f32 v46, v46
    s_waitcnt vmcnt(11) lgkmcnt(2)
    v_mfma_f32_32x32x16_bf16 v[80:95], v[168:171], v[112:115], v[80:95]
    ds_read_b128 v[124:127], v179 offset:45056
    v_cvt_pk_bf16_f32 v38, v44, v45
    v_exp_f32 v47, v47
    v_mfma_f32_32x32x16_bf16 v[64:79], v[224:227], v[32:35], v[64:79]
    v_cvt_pk_bf16_f32 v39, v46, v47
    v_exp_f32 v16, v16
    v_exp_f32 v17, v17
    v_exp_f32 v18, v18
    v_mfma_f32_32x32x16_bf16 v[64:79], v[228:231], v[36:39], v[64:79]
    s_setprio 0
    s_add_u32 m0, s64, 0
    s_add_u32 s39, s66, 53760
    buffer_load_dwordx4 v11, s[16:19], s39 offen sc1 lds
    v_cvt_pk_bf16_f32 v16, v16, v17
    v_exp_f32 v19, v19
    v_exp_f32 v20, v20
    v_mfma_f32_32x32x16_bf16 v[32:47], v[208:211], v[238:241], 0
    ds_read_b128 v[208:211], v4 offset:30720
    v_cvt_pk_bf16_f32 v17, v18, v19
    v_exp_f32 v21, v21
    v_exp_f32 v22, v22
    v_cvt_pk_bf16_f32 v18, v20, v21
    v_mfma_f32_32x32x8_bf16 v[32:47], v[212:213], v[242:243], v[32:47]
    s_mov_b64 exec, s[34:35]
    ds_read_b64 v[212:213], v5 offset:31744
    s_mov_b64 exec, s[32:33]
    ds_read_b128 v[224:227], v6 offset:32000
    ds_read_b128 v[228:231], v6 offset:32640
    s_mov_b64 exec, -1
    v_exp_f32 v23, v23
    v_exp_f32 v24, v24
    v_cvt_pk_bf16_f32 v19, v22, v23
    s_waitcnt lgkmcnt(6)
    v_mfma_f32_32x32x16_bf16 v[96:111], v[168:171], v[116:119], v[96:111]
    s_mov_b32 s37, 28672
    buffer_load_dwordx4 v[168:171], v7, s[16:19], s37 offen offset:2048 sc1
    v_exp_f32 v25, v25
    v_exp_f32 v26, v26
    v_cvt_pk_bf16_f32 v20, v24, v25
    v_exp_f32 v27, v27
    s_waitcnt vmcnt(12) lgkmcnt(5)
    v_mfma_f32_32x32x16_bf16 v[80:95], v[172:175], v[120:123], v[80:95]
    s_add_u32 m0, s64, 0
    s_add_u32 s39, s66, 53760
    s_mov_b64 exec, s[68:69]
    buffer_load_dwordx4 v11, s[16:19], s39 offen offset:1024 lds
    s_mov_b64 exec, -1
    v_exp_f32 v28, v28
    v_cvt_pk_bf16_f32 v21, v26, v27
    v_exp_f32 v29, v29
    v_exp_f32 v30, v30
    s_waitcnt lgkmcnt(4)
    v_mfma_f32_32x32x16_bf16 v[96:111], v[172:175], v[124:127], v[96:111]
    s_mov_b32 s37, 28672
    buffer_load_dwordx4 v[172:175], v7, s[16:19], s37 offen offset:3072 sc1
    v_cvt_pk_bf16_f32 v22, v28, v29
    v_exp_f32 v31, v31
    v_mfma_f32_32x32x16_bf16 v[48:63], v[216:219], v[16:19], v[48:63]
    s_cmp_eq_u32 s97, 0
    s_cbranch_scc1 K2_Z1_5G
    s_add_u32 s5, s97, 5120
    buffer_store_dwordx4 v[192:195], v11, s[16:19], s5 offen sc1
K2_Z1_5G:
    v_cvt_pk_bf16_f32 v23, v30, v31
    s_waitcnt lgkmcnt(0)
    s_barrier
    v_exp_f32 v32, v32
    v_exp_f32 v33, v33
    v_exp_f32 v34, v34
    v_mfma_f32_32x32x16_bf16 v[48:63], v[220:223], v[20:23], v[48:63]
    s_setprio 3
    ds_read_b128 v[112:115], v180 offset:0
    ds_read_b128 v[116:119], v180 offset:4096
    v_cvt_pk_bf16_f32 v32, v32, v33
    v_exp_f32 v35, v35
    v_exp_f32 v36, v36
    v_mfma_f32_32x32x16_bf16 v[16:31], v[208:211], v[232:235], 0
    v_cvt_pk_bf16_f32 v33, v34, v35
    v_exp_f32 v37, v37
    v_exp_f32 v38, v38
    v_cvt_pk_bf16_f32 v34, v36, v37
    v_mfma_f32_32x32x8_bf16 v[16:31], v[212:213], v[236:237], v[16:31]
    v_exp_f32 v39, v39
    v_exp_f32 v40, v40
    v_cvt_pk_bf16_f32 v35, v38, v39
    s_waitcnt vmcnt(13) lgkmcnt(1)
    v_mfma_f32_32x32x16_bf16 v[80:95], v[144:147], v[112:115], v[80:95]
    ds_read_b128 v[120:123], v181 offset:0
    ds_read_b128 v[124:127], v181 offset:4096
    v_exp_f32 v41, v41
    v_exp_f32 v42, v42
    v_cvt_pk_bf16_f32 v36, v40, v41
    v_exp_f32 v43, v43
    s_waitcnt lgkmcnt(2)
    v_mfma_f32_32x32x16_bf16 v[96:111], v[144:147], v[116:119], v[96:111]
    ds_read_b128 v[112:115], v182 offset:0
    s_mov_b32 s37, 32768
    buffer_load_dwordx4 v[144:147], v7, s[16:19], s37 offen offset:0 sc1
    v_exp_f32 v44, v44
    v_cvt_pk_bf16_f32 v37, v42, v43
    v_exp_f32 v45, v45
    v_exp_f32 v46, v46
    s_waitcnt vmcnt(11) lgkmcnt(2)
    v_mfma_f32_32x32x16_bf16 v[80:95], v[148:151], v[120:123], v[80:95]
    ds_read_b128 v[116:119], v182 offset:4096
    v_cvt_pk_bf16_f32 v38, v44, v45
    v_exp_f32 v47, v47
    v_mfma_f32_32x32x16_bf16 v[64:79], v[216:219], v[32:35], v[64:79]
    v_cvt_pk_bf16_f32 v39, v46, v47
    v_exp_f32 v16, v16
    v_exp_f32 v17, v17
    v_exp_f32 v18, v18
    v_mfma_f32_32x32x16_bf16 v[64:79], v[220:223], v[36:39], v[64:79]
    s_add_u32 m0, s65, 32768
    s_mov_b32 s39, 1280
    buffer_load_dwordx4 v9, s[20:23], s39 offen lds
    v_cvt_pk_bf16_f32 v16, v16, v17
    v_exp_f32 v19, v19
    v_exp_f32 v20, v20
    v_mfma_f32_32x32x16_bf16 v[32:47], v[208:211], v[238:241], 0
    ds_read_b128 v[208:211], v4 offset:33280
    v_cvt_pk_bf16_f32 v17, v18, v19
    v_exp_f32 v21, v21
    v_exp_f32 v22, v22
    v_cvt_pk_bf16_f32 v18, v20, v21
    v_mfma_f32_32x32x8_bf16 v[32:47], v[212:213], v[242:243], v[32:47]
    s_mov_b64 exec, s[34:35]
    ds_read_b64 v[212:213], v5 offset:34304
    s_mov_b64 exec, s[32:33]
    ds_read_b128 v[216:219], v6 offset:34560
    ds_read_b128 v[220:223], v6 offset:35200
    s_mov_b64 exec, -1
    v_exp_f32 v23, v23
    v_exp_f32 v24, v24
    v_cvt_pk_bf16_f32 v19, v22, v23
    s_waitcnt lgkmcnt(6)
    v_mfma_f32_32x32x16_bf16 v[96:111], v[148:151], v[124:127], v[96:111]
    ds_read_b128 v[120:123], v183 offset:0
    s_mov_b32 s37, 32768
    buffer_load_dwordx4 v[148:151], v7, s[16:19], s37 offen offset:1024 sc1
    v_exp_f32 v25, v25
    v_exp_f32 v26, v26
    v_cvt_pk_bf16_f32 v20, v24, v25
    v_exp_f32 v27, v27
    s_waitcnt vmcnt(12) lgkmcnt(6)
    v_mfma_f32_32x32x16_bf16 v[80:95], v[152:155], v[112:115], v[80:95]
    ds_read_b128 v[124:127], v183 offset:4096
    s_add_u32 m0, s65, 33792
    s_mov_b32 s39, 34048
    buffer_load_dwordx4 v10, s[20:23], s39 offen lds
    v_exp_f32 v28, v28
    v_cvt_pk_bf16_f32 v21, v26, v27
    v_exp_f32 v29, v29
    v_exp_f32 v30, v30
    s_waitcnt lgkmcnt(6)
    v_mfma_f32_32x32x16_bf16 v[96:111], v[152:155], v[116:119], v[96:111]
    ds_read_b128 v[112:115], v180 offset:8192
    s_mov_b32 s37, 32768
    buffer_load_dwordx4 v[152:155], v7, s[16:19], s37 offen offset:2048 sc1
    v_cvt_pk_bf16_f32 v22, v28, v29
    v_exp_f32 v31, v31
    v_mfma_f32_32x32x16_bf16 v[48:63], v[224:227], v[16:19], v[48:63]
    v_cvt_pk_bf16_f32 v23, v30, v31
    v_exp_f32 v32, v32
    v_exp_f32 v33, v33
    v_exp_f32 v34, v34
    v_mfma_f32_32x32x16_bf16 v[48:63], v[228:231], v[20:23], v[48:63]
    s_setprio 2
    s_waitcnt lgkmcnt(5)
    s_add_u32 m0, s65, 34816
    s_mov_b32 s39, 66816
    buffer_load_dwordx4 v9, s[20:23], s39 offen lds
    v_cvt_pk_bf16_f32 v32, v32, v33
    v_exp_f32 v35, v35
    v_exp_f32 v36, v36
    v_mfma_f32_32x32x16_bf16 v[16:31], v[208:211], v[232:235], 0
    s_add_u32 m0, s65, 35840
    s_mov_b32 s39, 99584
    buffer_load_dwordx4 v10, s[20:23], s39 offen lds
    v_cvt_pk_bf16_f32 v33, v34, v35
    v_exp_f32 v37, v37
    v_exp_f32 v38, v38
    v_mfma_f32_32x32x8_bf16 v[16:31], v[212:213], v[236:237], v[16:31]
    s_waitcnt lgkmcnt(3)
    v_cvt_pk_bf16_f32 v34, v36, v37
    v_exp_f32 v39, v39
    v_exp_f32 v40, v40
    s_waitcnt vmcnt(13) lgkmcnt(2)
    v_mfma_f32_32x32x16_bf16 v[80:95], v[156:159], v[120:123], v[80:95]
    ds_read_b128 v[116:119], v180 offset:12288
    v_cvt_pk_bf16_f32 v35, v38, v39
    v_exp_f32 v41, v41
    v_exp_f32 v42, v42
    s_waitcnt lgkmcnt(2)
    v_mfma_f32_32x32x16_bf16 v[96:111], v[156:159], v[124:127], v[96:111]
    ds_read_b128 v[120:123], v181 offset:8192
    s_mov_b32 s37, 32768
    buffer_load_dwordx4 v[156:159], v7, s[16:19], s37 offen offset:3072 sc1
    v_cvt_pk_bf16_f32 v36, v40, v41
    v_exp_f32 v43, v43
    v_exp_f32 v44, v44
    s_waitcnt vmcnt(13) lgkmcnt(2)
    v_mfma_f32_32x32x16_bf16 v[80:95], v[160:163], v[112:115], v[80:95]
    ds_read_b128 v[124:127], v181 offset:12288
    s_cmp_eq_u32 s97, 0
    s_cbranch_scc1 K2_Z1_6G
    s_add_u32 s5, s97, 6144
    buffer_store_dwordx4 v[196:199], v11, s[16:19], s5 offen sc1
K2_Z1_6G:
    v_cvt_pk_bf16_f32 v37, v42, v43
    v_exp_f32 v45, v45
    v_exp_f32 v46, v46
    s_waitcnt lgkmcnt(2)
    v_mfma_f32_32x32x16_bf16 v[96:111], v[160:163], v[116:119], v[96:111]
    ds_read_b128 v[112:115], v182 offset:8192
    s_mov_b32 s37, 36864
    buffer_load_dwordx4 v[160:163], v7, s[16:19], s37 offen offset:0 sc1
    v_cvt_pk_bf16_f32 v38, v44, v45
    v_exp_f32 v47, v47
    v_mfma_f32_32x32x16_bf16 v[64:79], v[224:227], v[32:35], v[64:79]
    v_cvt_pk_bf16_f32 v39, v46, v47
    v_exp_f32 v16, v16
    v_exp_f32 v17, v17
    v_exp_f32 v18, v18
    v_mfma_f32_32x32x16_bf16 v[64:79], v[228:231], v[36:39], v[64:79]
    s_setprio 1
    v_cvt_pk_bf16_f32 v16, v16, v17
    v_exp_f32 v19, v19
    v_exp_f32 v20, v20
    v_mfma_f32_32x32x16_bf16 v[32:47], v[208:211], v[238:241], 0
    ds_read_b128 v[208:211], v4 offset:35840
    v_cvt_pk_bf16_f32 v17, v18, v19
    v_exp_f32 v21, v21
    v_exp_f32 v22, v22
    v_cvt_pk_bf16_f32 v18, v20, v21
    v_mfma_f32_32x32x8_bf16 v[32:47], v[212:213], v[242:243], v[32:47]
    s_mov_b64 exec, s[34:35]
    ds_read_b64 v[212:213], v5 offset:36864
    s_mov_b64 exec, s[32:33]
    ds_read_b128 v[224:227], v6 offset:37120
    ds_read_b128 v[228:231], v6 offset:37760
    s_mov_b64 exec, -1
    v_exp_f32 v23, v23
    v_exp_f32 v24, v24
    v_cvt_pk_bf16_f32 v19, v22, v23
    s_waitcnt vmcnt(13) lgkmcnt(6)
    v_mfma_f32_32x32x16_bf16 v[80:95], v[164:167], v[120:123], v[80:95]
    ds_read_b128 v[116:119], v182 offset:12288
    v_exp_f32 v25, v25
    v_exp_f32 v26, v26
    v_cvt_pk_bf16_f32 v20, v24, v25
    v_exp_f32 v27, v27
    s_waitcnt lgkmcnt(6)
    v_mfma_f32_32x32x16_bf16 v[96:111], v[164:167], v[124:127], v[96:111]
    ds_read_b128 v[120:123], v183 offset:8192
    s_mov_b32 s37, 36864
    buffer_load_dwordx4 v[164:167], v7, s[16:19], s37 offen offset:1024 sc1
    v_exp_f32 v28, v28
    v_cvt_pk_bf16_f32 v21, v26, v27
    v_exp_f32 v29, v29
    v_exp_f32 v30, v30
    s_waitcnt vmcnt(12) lgkmcnt(6)
    v_mfma_f32_32x32x16_bf16 v[80:95], v[168:171], v[112:115], v[80:95]
    ds_read_b128 v[124:127], v183 offset:12288
    v_cvt_pk_bf16_f32 v22, v28, v29
    v_exp_f32 v31, v31
    v_mfma_f32_32x32x16_bf16 v[48:63], v[216:219], v[16:19], v[48:63]
    v_cvt_pk_bf16_f32 v23, v30, v31
    v_exp_f32 v32, v32
    v_exp_f32 v33, v33
    v_exp_f32 v34, v34
    v_mfma_f32_32x32x16_bf16 v[48:63], v[220:223], v[20:23], v[48:63]
    s_setprio 0
    s_waitcnt lgkmcnt(5)
    s_add_u32 m0, s64, 15360
    s_add_u32 s39, s66, 61440
    buffer_load_dwordx4 v11, s[16:19], s39 offen sc1 lds
    v_cvt_pk_bf16_f32 v32, v32, v33
    v_exp_f32 v35, v35
    v_exp_f32 v36, v36
    v_mfma_f32_32x32x16_bf16 v[16:31], v[208:211], v[232:235], 0
    s_add_u32 m0, s64, 15360
    s_add_u32 s39, s66, 61440
    s_mov_b64 exec, s[68:69]
    buffer_load_dwordx4 v11, s[16:19], s39 offen offset:1024 lds
    s_mov_b64 exec, -1
    v_cvt_pk_bf16_f32 v33, v34, v35
    v_exp_f32 v37, v37
    v_exp_f32 v38, v38
    v_cvt_pk_bf16_f32 v34, v36, v37
    v_mfma_f32_32x32x8_bf16 v[16:31], v[212:213], v[236:237], v[16:31]
    s_waitcnt lgkmcnt(3)
    v_exp_f32 v39, v39
    v_exp_f32 v40, v40
    v_cvt_pk_bf16_f32 v35, v38, v39
    s_waitcnt lgkmcnt(2)
    v_mfma_f32_32x32x16_bf16 v[96:111], v[168:171], v[116:119], v[96:111]
    s_mov_b32 s37, 36864
    buffer_load_dwordx4 v[168:171], v7, s[16:19], s37 offen offset:2048 sc1
    v_exp_f32 v41, v41
    v_exp_f32 v42, v42
    v_cvt_pk_bf16_f32 v36, v40, v41
    v_exp_f32 v43, v43
    s_waitcnt vmcnt(13) lgkmcnt(1)
    v_mfma_f32_32x32x16_bf16 v[80:95], v[172:175], v[120:123], v[80:95]
    v_exp_f32 v44, v44
    v_cvt_pk_bf16_f32 v37, v42, v43
    v_exp_f32 v45, v45
    v_exp_f32 v46, v46
    s_waitcnt lgkmcnt(0)
    v_mfma_f32_32x32x16_bf16 v[96:111], v[172:175], v[124:127], v[96:111]
    s_mov_b32 s37, 36864
    buffer_load_dwordx4 v[172:175], v7, s[16:19], s37 offen offset:3072 sc1
    v_cvt_pk_bf16_f32 v38, v44, v45
    v_exp_f32 v47, v47
    v_mfma_f32_32x32x16_bf16 v[64:79], v[216:219], v[32:35], v[64:79]
    v_cvt_pk_bf16_f32 v39, v46, v47
    s_barrier
    v_exp_f32 v16, v16
    v_exp_f32 v17, v17
    v_exp_f32 v18, v18
    v_mfma_f32_32x32x16_bf16 v[64:79], v[220:223], v[36:39], v[64:79]
    s_setprio 3
    ds_read_b128 v[112:115], v176 offset:0
    ds_read_b128 v[116:119], v176 offset:4096
    v_cvt_pk_bf16_f32 v16, v16, v17
    v_exp_f32 v19, v19
    v_exp_f32 v20, v20
    v_mfma_f32_32x32x16_bf16 v[32:47], v[208:211], v[238:241], 0
    ds_read_b128 v[208:211], v4 offset:46080
    v_cvt_pk_bf16_f32 v17, v18, v19
    v_exp_f32 v21, v21
    v_exp_f32 v22, v22
    v_cvt_pk_bf16_f32 v18, v20, v21
    v_mfma_f32_32x32x8_bf16 v[32:47], v[212:213], v[242:243], v[32:47]
    s_mov_b64 exec, s[34:35]
    ds_read_b64 v[212:213], v5 offset:47104
    s_mov_b64 exec, s[32:33]
    ds_read_b128 v[216:219], v6 offset:47360
    ds_read_b128 v[220:223], v6 offset:48000
    s_mov_b64 exec, -1
    v_exp_f32 v23, v23
    v_exp_f32 v24, v24
    v_cvt_pk_bf16_f32 v19, v22, v23
    s_waitcnt vmcnt(13) lgkmcnt(5)
    v_mfma_f32_32x32x16_bf16 v[80:95], v[144:147], v[112:115], v[80:95]
    ds_read_b128 v[120:123], v177 offset:0
    ds_read_b128 v[124:127], v177 offset:4096
    v_exp_f32 v25, v25
    v_exp_f32 v26, v26
    v_cvt_pk_bf16_f32 v20, v24, v25
    v_exp_f32 v27, v27
    s_waitcnt lgkmcnt(6)
    v_mfma_f32_32x32x16_bf16 v[96:111], v[144:147], v[116:119], v[96:111]
    ds_read_b128 v[112:115], v178 offset:0
    s_mov_b32 s37, 40960
    buffer_load_dwordx4 v[144:147], v7, s[16:19], s37 offen offset:0 sc1
    v_exp_f32 v28, v28
    v_cvt_pk_bf16_f32 v21, v26, v27
    v_exp_f32 v29, v29
    v_exp_f32 v30, v30
    s_waitcnt vmcnt(12) lgkmcnt(2)
    v_mfma_f32_32x32x16_bf16 v[80:95], v[148:151], v[120:123], v[80:95]
    ds_read_b128 v[116:119], v178 offset:4096
    v_cvt_pk_bf16_f32 v22, v28, v29
    v_exp_f32 v31, v31
    v_mfma_f32_32x32x16_bf16 v[48:63], v[224:227], v[16:19], v[48:63]
    v_cvt_pk_bf16_f32 v23, v30, v31
    v_exp_f32 v32, v32
    v_exp_f32 v33, v33
    v_exp_f32 v34, v34
    v_mfma_f32_32x32x16_bf16 v[48:63], v[228:231], v[20:23], v[48:63]
    s_add_u32 m0, s65, 65536
    s_mov_b32 s39, 1536
    buffer_load_dwordx4 v9, s[20:23], s39 offen lds
    v_cvt_pk_bf16_f32 v32, v32, v33
    v_exp_f32 v35, v35
    v_exp_f32 v36, v36
    v_mfma_f32_32x32x16_bf16 v[16:31], v[208:211], v[232:235], 0
    s_add_u32 m0, s65, 66560
    s_mov_b32 s39, 34304
    buffer_load_dwordx4 v10, s[20:23], s39 offen lds
    v_cvt_pk_bf16_f32 v33, v34, v35
    v_exp_f32 v37, v37
    v_exp_f32 v38, v38
    v_cvt_pk_bf16_f32 v34, v36, v37
    v_mfma_f32_32x32x8_bf16 v[16:31], v[212:213], v[236:237], v[16:31]
    v_exp_f32 v39, v39
    v_exp_f32 v40, v40
    v_cvt_pk_bf16_f32 v35, v38, v39
    s_waitcnt lgkmcnt(2)
    v_mfma_f32_32x32x16_bf16 v[96:111], v[148:151], v[124:127], v[96:111]
    ds_read_b128 v[120:123], v179 offset:0
    s_mov_b32 s37, 40960
    buffer_load_dwordx4 v[148:151], v7, s[16:19], s37 offen offset:1024 sc1
    v_exp_f32 v41, v41
    v_exp_f32 v42, v42
    v_cvt_pk_bf16_f32 v36, v40, v41
    v_exp_f32 v43, v43
    s_waitcnt vmcnt(13) lgkmcnt(2)
    v_mfma_f32_32x32x16_bf16 v[80:95], v[152:155], v[112:115], v[80:95]
    ds_read_b128 v[124:127], v179 offset:4096
    v_exp_f32 v44, v44
    v_cvt_pk_bf16_f32 v37, v42, v43
    v_exp_f32 v45, v45
    v_exp_f32 v46, v46
    s_waitcnt lgkmcnt(2)
    v_mfma_f32_32x32x16_bf16 v[96:111], v[152:155], v[116:119], v[96:111]
    ds_read_b128 v[112:115], v176 offset:8192
    s_mov_b32 s37, 40960
    buffer_load_dwordx4 v[152:155], v7, s[16:19], s37 offen offset:2048 sc1
    v_cvt_pk_bf16_f32 v38, v44, v45
    v_exp_f32 v47, v47
    v_mfma_f32_32x32x16_bf16 v[64:79], v[224:227], v[32:35], v[64:79]
    v_cvt_pk_bf16_f32 v39, v46, v47
    v_exp_f32 v16, v16
    v_exp_f32 v17, v17
    v_exp_f32 v18, v18
    v_mfma_f32_32x32x16_bf16 v[64:79], v[228:231], v[36:39], v[64:79]
    s_setprio 2
    s_add_u32 m0, s65, 67584
    s_mov_b32 s39, 67072
    buffer_load_dwordx4 v9, s[20:23], s39 offen lds
    v_cvt_pk_bf16_f32 v16, v16, v17
    v_exp_f32 v19, v19
    v_exp_f32 v20, v20
    v_mfma_f32_32x32x16_bf16 v[32:47], v[208:211], v[238:241], 0
    ds_read_b128 v[208:211], v4 offset:48640
    v_cvt_pk_bf16_f32 v17, v18, v19
    v_exp_f32 v21, v21
    v_exp_f32 v22, v22
    v_mfma_f32_32x32x8_bf16 v[32:47], v[212:213], v[242:243], v[32:47]
    s_mov_b64 exec, s[34:35]
    ds_read_b64 v[212:213], v5 offset:49664
    s_mov_b64 exec, s[32:33]
    ds_read_b128 v[224:227], v6 offset:49920
    ds_read_b128 v[228:231], v6 offset:50560
    s_mov_b64 exec, -1
    v_cvt_pk_bf16_f32 v18, v20, v21
    v_exp_f32 v23, v23
    v_exp_f32 v24, v24
    s_waitcnt vmcnt(12) lgkmcnt(6)
    v_mfma_f32_32x32x16_bf16 v[80:95], v[156:159], v[120:123], v[80:95]
    ds_read_b128 v[116:119], v176 offset:12288
    s_add_u32 m0, s65, 68608
    s_mov_b32 s39, 99840
    buffer_load_dwordx4 v10, s[20:23], s39 offen lds
    v_cvt_pk_bf16_f32 v19, v22, v23
    v_exp_f32 v25, v25
    v_exp_f32 v26, v26
    s_waitcnt lgkmcnt(6)
    v_mfma_f32_32x32x16_bf16 v[96:111], v[156:159], v[124:127], v[96:111]
    ds_read_b128 v[120:123], v177 offset:8192
    s_mov_b32 s37, 40960
    buffer_load_dwordx4 v[156:159], v7, s[16:19], s37 offen offset:3072 sc1
    v_cvt_pk_bf16_f32 v20, v24, v25
    v_exp_f32 v27, v27
    v_exp_f32 v28, v28
    s_waitcnt vmcnt(13) lgkmcnt(6)
    v_mfma_f32_32x32x16_bf16 v[80:95], v[160:163], v[112:115], v[80:95]
    ds_read_b128 v[124:127], v177 offset:12288
    s_cmp_ge_u32 s30, 4
    s_cbranch_scc1 K2_ND1G
    s_cmp_eq_u32 s97, 0
    s_cbranch_scc1 K2_ND1G
    s_waitcnt vmcnt(0)
    v_mov_b32 v244, s98
    s_mov_b64 exec, 1
    buffer_store_dword v14, v244, s[16:19], 0 offen sc1
    s_mov_b64 exec, -1
K2_ND1G:
    v_cvt_pk_bf16_f32 v21, v26, v27
    v_exp_f32 v29, v29
    v_exp_f32 v30, v30
    s_waitcnt lgkmcnt(2)
    v_mfma_f32_32x32x16_bf16 v[96:111], v[160:163], v[116:119], v[96:111]
    ds_read_b128 v[112:115], v178 offset:8192
    s_mov_b32 s37, 45056
    buffer_load_dwordx4 v[160:163], v7, s[16:19], s37 offen offset:0 sc1
    v_cvt_pk_bf16_f32 v22, v28, v29
    v_exp_f32 v31, v31
    v_mfma_f32_32x32x16_bf16 v[48:63], v[216:219], v[16:19], v[48:63]
    v_cvt_pk_bf16_f32 v23, v30, v31
    v_exp_f32 v32, v32
    v_exp_f32 v33, v33
    v_exp_f32 v34, v34
    v_mfma_f32_32x32x16_bf16 v[48:63], v[220:223], v[20:23], v[48:63]
    s_setprio 1
    v_cvt_pk_bf16_f32 v32, v32, v33
    v_exp_f32 v35, v35
    v_exp_f32 v36, v36
    v_mfma_f32_32x32x16_bf16 v[16:31], v[208:211], v[232:235], 0
    v_cvt_pk_bf16_f32 v33, v34, v35
    v_exp_f32 v37, v37
    v_exp_f32 v38, v38
    v_cvt_pk_bf16_f32 v34, v36, v37
    v_mfma_f32_32x32x8_bf16 v[16:31], v[212:213], v[236:237], v[16:31]
    v_exp_f32 v39, v39
    v_exp_f32 v40, v40
    v_cvt_pk_bf16_f32 v35, v38, v39
    s_waitcnt vmcnt(13) lgkmcnt(2)
    v_mfma_f32_32x32x16_bf16 v[80:95], v[164:167], v[120:123], v[80:95]
    ds_read_b128 v[116:119], v178 offset:12288
    v_exp_f32 v41, v41
    v_exp_f32 v42, v42
    v_cvt_pk_bf16_f32 v36, v40, v41
    v_exp_f32 v43, v43
    s_waitcnt lgkmcnt(2)
    v_mfma_f32_32x32x16_bf16 v[96:111], v[164:167], v[124:127], v[96:111]
    ds_read_b128 v[120:123], v179 offset:8192
    s_mov_b32 s37, 45056
    buffer_load_dwordx4 v[164:167], v7, s[16:19], s37 offen offset:1024 sc1
    v_exp_f32 v44, v44
    v_cvt_pk_bf16_f32 v37, v42, v43
    v_exp_f32 v45, v45
    v_exp_f32 v46, v46
    s_waitcnt vmcnt(11) lgkmcnt(2)
    v_mfma_f32_32x32x16_bf16 v[80:95], v[168:171], v[112:115], v[80:95]
    ds_read_b128 v[124:127], v179 offset:12288
    v_cvt_pk_bf16_f32 v38, v44, v45
    v_exp_f32 v47, v47
    v_mfma_f32_32x32x16_bf16 v[64:79], v[216:219], v[32:35], v[64:79]
    v_cvt_pk_bf16_f32 v39, v46, v47
    v_exp_f32 v16, v16
    v_exp_f32 v17, v17
    v_exp_f32 v18, v18
    v_mfma_f32_32x32x16_bf16 v[64:79], v[220:223], v[36:39], v[64:79]
    s_setprio 0
    s_add_u32 m0, s64, 30720
    s_add_u32 s39, s66, 69120
    buffer_load_dwordx4 v11, s[16:19], s39 offen sc1 lds
    v_cvt_pk_bf16_f32 v16, v16, v17
    v_exp_f32 v19, v19
    v_exp_f32 v20, v20
    v_mfma_f32_32x32x16_bf16 v[32:47], v[208:211], v[238:241], 0
    ds_read_b128 v[208:211], v4 offset:51200
    v_cvt_pk_bf16_f32 v17, v18, v19
    v_exp_f32 v21, v21
    v_exp_f32 v22, v22
    v_cvt_pk_bf16_f32 v18, v20, v21
    v_mfma_f32_32x32x8_bf16 v[32:47], v[212:213], v[242:243], v[32:47]
    s_mov_b64 exec, s[34:35]
    ds_read_b64 v[212:213], v5 offset:52224
    s_mov_b64 exec, s[32:33]
    ds_read_b128 v[216:219], v6 offset:52480
    ds_read_b128 v[220:223], v6 offset:53120
    s_mov_b64 exec, -1
    v_exp_f32 v23, v23
    v_exp_f32 v24, v24
    v_cvt_pk_bf16_f32 v19, v22, v23
    s_waitcnt lgkmcnt(6)
    v_mfma_f32_32x32x16_bf16 v[96:111], v[168:171], v[116:119], v[96:111]
    s_mov_b32 s37, 45056
    buffer_load_dwordx4 v[168:171], v7, s[16:19], s37 offen offset:2048 sc1
    v_exp_f32 v25, v25
    v_exp_f32 v26, v26
    v_cvt_pk_bf16_f32 v20, v24, v25
    v_exp_f32 v27, v27
    s_waitcnt vmcnt(12) lgkmcnt(5)
    v_mfma_f32_32x32x16_bf16 v[80:95], v[172:175], v[120:123], v[80:95]
    s_add_u32 m0, s64, 30720
    s_add_u32 s39, s66, 69120
    s_mov_b64 exec, s[68:69]
    buffer_load_dwordx4 v11, s[16:19], s39 offen offset:1024 lds
    s_mov_b64 exec, -1
    v_exp_f32 v28, v28
    v_cvt_pk_bf16_f32 v21, v26, v27
    v_exp_f32 v29, v29
    v_exp_f32 v30, v30
    s_waitcnt lgkmcnt(4)
    v_mfma_f32_32x32x16_bf16 v[96:111], v[172:175], v[124:127], v[96:111]
    s_mov_b32 s37, 45056
    buffer_load_dwordx4 v[172:175], v7, s[16:19], s37 offen offset:3072 sc1
    v_cvt_pk_bf16_f32 v22, v28, v29
    v_exp_f32 v31, v31
    v_mfma_f32_32x32x16_bf16 v[48:63], v[224:227], v[16:19], v[48:63]
    v_cvt_pk_bf16_f32 v23, v30, v31
    s_waitcnt lgkmcnt(0)
    s_barrier
    v_exp_f32 v32, v32
    v_exp_f32 v33, v33
    v_exp_f32 v34, v34
    v_mfma_f32_32x32x16_bf16 v[48:63], v[228:231], v[20:23], v[48:63]
    s_setprio 3
    ds_read_b128 v[112:115], v176 offset:32768
    ds_read_b128 v[116:119], v176 offset:36864
    v_cvt_pk_bf16_f32 v32, v32, v33
    v_exp_f32 v35, v35
    v_exp_f32 v36, v36
    v_mfma_f32_32x32x16_bf16 v[16:31], v[208:211], v[232:235], 0
    v_cvt_pk_bf16_f32 v33, v34, v35
    v_exp_f32 v37, v37
    v_exp_f32 v38, v38
    v_cvt_pk_bf16_f32 v34, v36, v37
    v_mfma_f32_32x32x8_bf16 v[16:31], v[212:213], v[236:237], v[16:31]
    v_exp_f32 v39, v39
    v_exp_f32 v40, v40
    v_cvt_pk_bf16_f32 v35, v38, v39
    s_waitcnt vmcnt(13) lgkmcnt(1)
    v_mfma_f32_32x32x16_bf16 v[80:95], v[144:147], v[112:115], v[80:95]
    ds_read_b128 v[120:123], v177 offset:32768
    ds_read_b128 v[124:127], v177 offset:36864
    v_exp_f32 v41, v41
    v_exp_f32 v42, v42
    v_cvt_pk_bf16_f32 v36, v40, v41
    v_exp_f32 v43, v43
    s_waitcnt lgkmcnt(2)
    v_mfma_f32_32x32x16_bf16 v[96:111], v[144:147], v[116:119], v[96:111]
    ds_read_b128 v[112:115], v178 offset:32768
    s_mov_b32 s37, 49152
    buffer_load_dwordx4 v[144:147], v7, s[16:19], s37 offen offset:0 sc1
    v_exp_f32 v44, v44
    v_cvt_pk_bf16_f32 v37, v42, v43
    v_exp_f32 v45, v45
    v_exp_f32 v46, v46
    s_waitcnt vmcnt(11) lgkmcnt(2)
    v_mfma_f32_32x32x16_bf16 v[80:95], v[148:151], v[120:123], v[80:95]
    ds_read_b128 v[116:119], v178 offset:36864
    v_cvt_pk_bf16_f32 v38, v44, v45
    v_exp_f32 v47, v47
    v_mfma_f32_32x32x16_bf16 v[64:79], v[224:227], v[32:35], v[64:79]
    v_cvt_pk_bf16_f32 v39, v46, v47
    v_exp_f32 v16, v16
    v_exp_f32 v17, v17
    v_exp_f32 v18, v18
    v_mfma_f32_32x32x16_bf16 v[64:79], v[228:231], v[36:39], v[64:79]
    s_add_u32 m0, s65, 0
    s_mov_b32 s39, 1792
    buffer_load_dwordx4 v9, s[20:23], s39 offen lds
    v_cvt_pk_bf16_f32 v16, v16, v17
    v_exp_f32 v19, v19
    v_exp_f32 v20, v20
    v_mfma_f32_32x32x16_bf16 v[32:47], v[208:211], v[238:241], 0
    ds_read_b128 v[208:211], v4 offset:0
    v_cvt_pk_bf16_f32 v17, v18, v19
    v_exp_f32 v21, v21
    v_exp_f32 v22, v22
    v_cvt_pk_bf16_f32 v18, v20, v21
    v_mfma_f32_32x32x8_bf16 v[32:47], v[212:213], v[242:243], v[32:47]
    s_mov_b64 exec, s[34:35]
    ds_read_b64 v[212:213], v5 offset:1024
    s_mov_b64 exec, s[32:33]
    ds_read_b128 v[224:227], v6 offset:1280
    ds_read_b128 v[228:231], v6 offset:1920
    s_mov_b64 exec, -1
    v_exp_f32 v23, v23
    v_exp_f32 v24, v24
    v_cvt_pk_bf16_f32 v19, v22, v23
    s_waitcnt lgkmcnt(6)
    v_mfma_f32_32x32x16_bf16 v[96:111], v[148:151], v[124:127], v[96:111]
    ds_read_b128 v[120:123], v179 offset:32768
    s_mov_b32 s37, 49152
    buffer_load_dwordx4 v[148:151], v7, s[16:19], s37 offen offset:1024 sc1
    v_exp_f32 v25, v25
    v_exp_f32 v26, v26
    v_cvt_pk_bf16_f32 v20, v24, v25
    v_exp_f32 v27, v27
    s_waitcnt vmcnt(12) lgkmcnt(6)
    v_mfma_f32_32x32x16_bf16 v[80:95], v[152:155], v[112:115], v[80:95]
    ds_read_b128 v[124:127], v179 offset:36864
    s_add_u32 m0, s65, 1024
    s_mov_b32 s39, 34560
    buffer_load_dwordx4 v10, s[20:23], s39 offen lds
    v_exp_f32 v28, v28
    v_cvt_pk_bf16_f32 v21, v26, v27
    v_exp_f32 v29, v29
    v_exp_f32 v30, v30
    s_waitcnt lgkmcnt(6)
    v_mfma_f32_32x32x16_bf16 v[96:111], v[152:155], v[116:119], v[96:111]
    ds_read_b128 v[112:115], v176 offset:40960
    s_mov_b32 s37, 49152
    buffer_load_dwordx4 v[152:155], v7, s[16:19], s37 offen offset:2048 sc1
    v_cvt_pk_bf16_f32 v22, v28, v29
    v_exp_f32 v31, v31
    v_mfma_f32_32x32x16_bf16 v[48:63], v[216:219], v[16:19], v[48:63]
    v_cvt_pk_bf16_f32 v23, v30, v31
    v_exp_f32 v32, v32
    v_exp_f32 v33, v33
    v_exp_f32 v34, v34
    v_mfma_f32_32x32x16_bf16 v[48:63], v[220:223], v[20:23], v[48:63]
    s_setprio 2
    s_waitcnt lgkmcnt(5)
    s_add_u32 m0, s65, 2048
    s_mov_b32 s39, 67328
    buffer_load_dwordx4 v9, s[20:23], s39 offen lds
    v_cvt_pk_bf16_f32 v32, v32, v33
    v_exp_f32 v35, v35
    v_exp_f32 v36, v36
    v_mfma_f32_32x32x16_bf16 v[16:31], v[208:211], v[232:235], 0
    s_add_u32 m0, s65, 3072
    s_mov_b32 s39, 100096
    buffer_load_dwordx4 v10, s[20:23], s39 offen lds
    v_cvt_pk_bf16_f32 v33, v34, v35
    v_exp_f32 v37, v37
    v_exp_f32 v38, v38
    v_mfma_f32_32x32x8_bf16 v[16:31], v[212:213], v[236:237], v[16:31]
    s_waitcnt lgkmcnt(3)
    v_cvt_pk_bf16_f32 v34, v36, v37
    v_exp_f32 v39, v39
    v_exp_f32 v40, v40
    s_waitcnt vmcnt(13) lgkmcnt(2)
    v_mfma_f32_32x32x16_bf16 v[80:95], v[156:159], v[120:123], v[80:95]
    ds_read_b128 v[116:119], v176 offset:45056
    v_cvt_pk_bf16_f32 v35, v38, v39
    v_exp_f32 v41, v41
    v_exp_f32 v42, v42
    s_waitcnt lgkmcnt(2)
    v_mfma_f32_32x32x16_bf16 v[96:111], v[156:159], v[124:127], v[96:111]
    ds_read_b128 v[120:123], v177 offset:40960
    s_mov_b32 s37, 49152
    buffer_load_dwordx4 v[156:159], v7, s[16:19], s37 offen offset:3072 sc1
    v_cvt_pk_bf16_f32 v36, v40, v41
    v_exp_f32 v43, v43
    v_exp_f32 v44, v44
    s_waitcnt vmcnt(13) lgkmcnt(2)
    v_mfma_f32_32x32x16_bf16 v[80:95], v[160:163], v[112:115], v[80:95]
    ds_read_b128 v[124:127], v177 offset:45056
    v_cvt_pk_bf16_f32 v37, v42, v43
    v_exp_f32 v45, v45
    v_exp_f32 v46, v46
    s_waitcnt lgkmcnt(2)
    v_mfma_f32_32x32x16_bf16 v[96:111], v[160:163], v[116:119], v[96:111]
    ds_read_b128 v[112:115], v178 offset:40960
    s_mov_b32 s37, 53248
    buffer_load_dwordx4 v[160:163], v7, s[16:19], s37 offen offset:0 sc1
    v_cvt_pk_bf16_f32 v38, v44, v45
    v_exp_f32 v47, v47
    v_mfma_f32_32x32x16_bf16 v[64:79], v[216:219], v[32:35], v[64:79]
    v_cvt_pk_bf16_f32 v39, v46, v47
    v_exp_f32 v16, v16
    v_exp_f32 v17, v17
    v_exp_f32 v18, v18
    v_mfma_f32_32x32x16_bf16 v[64:79], v[220:223], v[36:39], v[64:79]
    s_setprio 1
    v_cvt_pk_bf16_f32 v16, v16, v17
    v_exp_f32 v19, v19
    v_exp_f32 v20, v20
    v_mfma_f32_32x32x16_bf16 v[32:47], v[208:211], v[238:241], 0
    ds_read_b128 v[208:211], v4 offset:2560
    v_cvt_pk_bf16_f32 v17, v18, v19
    v_exp_f32 v21, v21
    v_exp_f32 v22, v22
    v_cvt_pk_bf16_f32 v18, v20, v21
    v_mfma_f32_32x32x8_bf16 v[32:47], v[212:213], v[242:243], v[32:47]
    s_mov_b64 exec, s[34:35]
    ds_read_b64 v[212:213], v5 offset:3584
    s_mov_b64 exec, s[32:33]
    ds_read_b128 v[216:219], v6 offset:3840
    ds_read_b128 v[220:223], v6 offset:4480
    s_mov_b64 exec, -1
    v_exp_f32 v23, v23
    v_exp_f32 v24, v24
    v_cvt_pk_bf16_f32 v19, v22, v23
    s_waitcnt vmcnt(13) lgkmcnt(6)
    v_mfma_f32_32x32x16_bf16 v[80:95], v[164:167], v[120:123], v[80:95]
    ds_read_b128 v[116:119], v178 offset:45056
    v_exp_f32 v25, v25
    v_exp_f32 v26, v26
    v_cvt_pk_bf16_f32 v20, v24, v25
    v_exp_f32 v27, v27
    s_waitcnt lgkmcnt(6)
    v_mfma_f32_32x32x16_bf16 v[96:111], v[164:167], v[124:127], v[96:111]
    ds_read_b128 v[120:123], v179 offset:40960
    s_mov_b32 s37, 53248
    buffer_load_dwordx4 v[164:167], v7, s[16:19], s37 offen offset:1024 sc1
    v_exp_f32 v28, v28
    v_cvt_pk_bf16_f32 v21, v26, v27
    v_exp_f32 v29, v29
    v_exp_f32 v30, v30
    s_waitcnt vmcnt(12) lgkmcnt(6)
    v_mfma_f32_32x32x16_bf16 v[80:95], v[168:171], v[112:115], v[80:95]
    ds_read_b128 v[124:127], v179 offset:45056
    v_cvt_pk_bf16_f32 v22, v28, v29
    v_exp_f32 v31, v31
    v_mfma_f32_32x32x16_bf16 v[48:63], v[224:227], v[16:19], v[48:63]
    v_cvt_pk_bf16_f32 v23, v30, v31
    v_exp_f32 v32, v32
    v_exp_f32 v33, v33
    v_exp_f32 v34, v34
    v_mfma_f32_32x32x16_bf16 v[48:63], v[228:231], v[20:23], v[48:63]
    s_setprio 0
    s_waitcnt lgkmcnt(5)
    v_cvt_pk_bf16_f32 v32, v32, v33
    v_exp_f32 v35, v35
    v_exp_f32 v36, v36
    v_mfma_f32_32x32x16_bf16 v[16:31], v[208:211], v[232:235], 0
    v_cvt_pk_bf16_f32 v33, v34, v35
    v_exp_f32 v37, v37
    v_exp_f32 v38, v38
    v_cvt_pk_bf16_f32 v34, v36, v37
    v_mfma_f32_32x32x8_bf16 v[16:31], v[212:213], v[236:237], v[16:31]
    s_waitcnt lgkmcnt(3)
    v_exp_f32 v39, v39
    v_exp_f32 v40, v40
    v_cvt_pk_bf16_f32 v35, v38, v39
    s_waitcnt lgkmcnt(2)
    v_mfma_f32_32x32x16_bf16 v[96:111], v[168:171], v[116:119], v[96:111]
    s_mov_b32 s37, 53248
    buffer_load_dwordx4 v[168:171], v7, s[16:19], s37 offen offset:2048 sc1
    v_exp_f32 v41, v41
    v_exp_f32 v42, v42
    v_cvt_pk_bf16_f32 v36, v40, v41
    v_exp_f32 v43, v43
    s_waitcnt vmcnt(11) lgkmcnt(1)
    v_mfma_f32_32x32x16_bf16 v[80:95], v[172:175], v[120:123], v[80:95]
    v_exp_f32 v44, v44
    v_cvt_pk_bf16_f32 v37, v42, v43
    v_exp_f32 v45, v45
    v_exp_f32 v46, v46
    s_waitcnt lgkmcnt(0)
    v_mfma_f32_32x32x16_bf16 v[96:111], v[172:175], v[124:127], v[96:111]
    s_mov_b32 s37, 53248
    buffer_load_dwordx4 v[172:175], v7, s[16:19], s37 offen offset:3072 sc1
    v_cvt_pk_bf16_f32 v38, v44, v45
    v_exp_f32 v47, v47
    v_mfma_f32_32x32x16_bf16 v[64:79], v[224:227], v[32:35], v[64:79]
    v_cvt_pk_bf16_f32 v39, v46, v47
    s_barrier
    v_exp_f32 v16, v16
    v_exp_f32 v17, v17
    v_exp_f32 v18, v18
    v_mfma_f32_32x32x16_bf16 v[64:79], v[228:231], v[36:39], v[64:79]
    s_setprio 3
    ds_read_b128 v[112:115], v180 offset:0
    ds_read_b128 v[116:119], v180 offset:4096
    v_cvt_pk_bf16_f32 v16, v16, v17
    v_exp_f32 v19, v19
    v_exp_f32 v20, v20
    v_mfma_f32_32x32x16_bf16 v[32:47], v[208:211], v[238:241], 0
    ds_read_b128 v[208:211], v4 offset:5120
    v_cvt_pk_bf16_f32 v17, v18, v19
    v_exp_f32 v21, v21
    v_exp_f32 v22, v22
    v_cvt_pk_bf16_f32 v18, v20, v21
    v_mfma_f32_32x32x8_bf16 v[32:47], v[212:213], v[242:243], v[32:47]
    s_mov_b64 exec, s[34:35]
    ds_read_b64 v[212:213], v5 offset:6144
    s_mov_b64 exec, s[32:33]
    ds_read_b128 v[224:227], v6 offset:6400
    ds_read_b128 v[228:231], v6 offset:7040
    s_mov_b64 exec, -1
    v_exp_f32 v23, v23
    v_exp_f32 v24, v24
    v_cvt_pk_bf16_f32 v19, v22, v23
    s_waitcnt vmcnt(11) lgkmcnt(5)
    v_mfma_f32_32x32x16_bf16 v[80:95], v[144:147], v[112:115], v[80:95]
    ds_read_b128 v[120:123], v181 offset:0
    ds_read_b128 v[124:127], v181 offset:4096
    v_exp_f32 v25, v25
    v_exp_f32 v26, v26
    v_cvt_pk_bf16_f32 v20, v24, v25
    v_exp_f32 v27, v27
    s_waitcnt lgkmcnt(6)
    v_mfma_f32_32x32x16_bf16 v[96:111], v[144:147], v[116:119], v[96:111]
    ds_read_b128 v[112:115], v182 offset:0
    s_mov_b32 s37, 57344
    buffer_load_dwordx4 v[144:147], v7, s[16:19], s37 offen offset:0 sc1
    v_exp_f32 v28, v28
    v_cvt_pk_bf16_f32 v21, v26, v27
    v_exp_f32 v29, v29
    v_exp_f32 v30, v30
    s_waitcnt vmcnt(10) lgkmcnt(2)
    v_mfma_f32_32x32x16_bf16 v[80:95], v[148:151], v[120:123], v[80:95]
    ds_read_b128 v[116:119], v182 offset:4096
    v_cvt_pk_bf16_f32 v22, v28, v29
    v_exp_f32 v31, v31
    v_mfma_f32_32x32x16_bf16 v[48:63], v[216:219], v[16:19], v[48:63]
    v_cvt_pk_bf16_f32 v23, v30, v31
    v_exp_f32 v32, v32
    v_exp_f32 v33, v33
    v_exp_f32 v34, v34
    v_mfma_f32_32x32x16_bf16 v[48:63], v[220:223], v[20:23], v[48:63]
    v_cvt_pk_bf16_f32 v32, v32, v33
    v_exp_f32 v35, v35
    v_exp_f32 v36, v36
    v_mfma_f32_32x32x16_bf16 v[16:31], v[208:211], v[232:235], 0
    v_cvt_pk_bf16_f32 v33, v34, v35
    v_exp_f32 v37, v37
    v_exp_f32 v38, v38
    v_cvt_pk_bf16_f32 v34, v36, v37
    v_mfma_f32_32x32x8_bf16 v[16:31], v[212:213], v[236:237], v[16:31]
    v_exp_f32 v39, v39
    v_exp_f32 v40, v40
    v_cvt_pk_bf16_f32 v35, v38, v39
    s_waitcnt lgkmcnt(2)
    v_mfma_f32_32x32x16_bf16 v[96:111], v[148:151], v[124:127], v[96:111]
    ds_read_b128 v[120:123], v183 offset:0
    s_mov_b32 s37, 57344
    buffer_load_dwordx4 v[148:151], v7, s[16:19], s37 offen offset:1024 sc1
    v_exp_f32 v41, v41
    v_exp_f32 v42, v42
    v_cvt_pk_bf16_f32 v36, v40, v41
    v_exp_f32 v43, v43
    s_waitcnt vmcnt(9) lgkmcnt(2)
    v_mfma_f32_32x32x16_bf16 v[80:95], v[152:155], v[112:115], v[80:95]
    ds_read_b128 v[124:127], v183 offset:4096
    v_exp_f32 v44, v44
    v_cvt_pk_bf16_f32 v37, v42, v43
    v_exp_f32 v45, v45
    v_exp_f32 v46, v46
    s_waitcnt lgkmcnt(2)
    v_mfma_f32_32x32x16_bf16 v[96:111], v[152:155], v[116:119], v[96:111]
    ds_read_b128 v[112:115], v180 offset:8192
    s_mov_b32 s37, 57344
    buffer_load_dwordx4 v[152:155], v7, s[16:19], s37 offen offset:2048 sc1
    v_cvt_pk_bf16_f32 v38, v44, v45
    v_exp_f32 v47, v47
    v_mfma_f32_32x32x16_bf16 v[64:79], v[216:219], v[32:35], v[64:79]
    v_cvt_pk_bf16_f32 v39, v46, v47
    v_exp_f32 v16, v16
    v_exp_f32 v17, v17
    v_exp_f32 v18, v18
    v_mfma_f32_32x32x16_bf16 v[64:79], v[220:223], v[36:39], v[64:79]
    s_setprio 2
    s_cmp_lg_u32 s30, 4
    s_cbranch_scc1 K2_F3IG
    v_add_u32 v12, 3087360, v11
    buffer_load_dwordx4 v[248:251], v12, s[16:19], 0 offen offset:0 sc1
    buffer_load_dword v252, v8, s[16:19], 0 offen offset:0 sc1
K2_F3IG:
    v_cvt_pk_bf16_f32 v16, v16, v17
    v_exp_f32 v19, v19
    v_exp_f32 v20, v20
    v_mfma_f32_32x32x16_bf16 v[32:47], v[208:211], v[238:241], 0
    ds_read_b128 v[208:211], v4 offset:15360
    v_cvt_pk_bf16_f32 v17, v18, v19
    v_exp_f32 v21, v21
    v_exp_f32 v22, v22
    v_mfma_f32_32x32x8_bf16 v[32:47], v[212:213], v[242:243], v[32:47]
    s_mov_b64 exec, s[34:35]
    ds_read_b64 v[212:213], v5 offset:16384
    s_mov_b64 exec, s[32:33]
    ds_read_b128 v[216:219], v6 offset:16640
    ds_read_b128 v[220:223], v6 offset:17280
    s_mov_b64 exec, -1
    v_cvt_pk_bf16_f32 v18, v20, v21
    v_exp_f32 v23, v23
    v_exp_f32 v24, v24
    s_waitcnt vmcnt(7) lgkmcnt(6)
    v_mfma_f32_32x32x16_bf16 v[80:95], v[156:159], v[120:123], v[80:95]
    ds_read_b128 v[116:119], v180 offset:12288
    v_cvt_pk_bf16_f32 v19, v22, v23
    v_exp_f32 v25, v25
    v_exp_f32 v26, v26
    s_waitcnt lgkmcnt(6)
    v_mfma_f32_32x32x16_bf16 v[96:111], v[156:159], v[124:127], v[96:111]
    ds_read_b128 v[120:123], v181 offset:8192
    s_mov_b32 s37, 57344
    buffer_load_dwordx4 v[156:159], v7, s[16:19], s37 offen offset:3072 sc1
    v_cvt_pk_bf16_f32 v20, v24, v25
    v_exp_f32 v27, v27
    v_exp_f32 v28, v28
    s_waitcnt vmcnt(7) lgkmcnt(6)
    v_mfma_f32_32x32x16_bf16 v[80:95], v[160:163], v[112:115], v[80:95]
    ds_read_b128 v[124:127], v181 offset:12288
    v_cvt_pk_bf16_f32 v21, v26, v27
    v_exp_f32 v29, v29
    v_exp_f32 v30, v30
    s_waitcnt lgkmcnt(2)
    v_mfma_f32_32x32x16_bf16 v[96:111], v[160:163], v[116:119], v[96:111]
    ds_read_b128 v[112:115], v182 offset:8192
    s_mov_b32 s37, 61440
    buffer_load_dwordx4 v[160:163], v7, s[16:19], s37 offen offset:0 sc1
    v_cvt_pk_bf16_f32 v22, v28, v29
    v_exp_f32 v31, v31
    v_mfma_f32_32x32x16_bf16 v[48:63], v[224:227], v[16:19], v[48:63]
    v_cvt_pk_bf16_f32 v23, v30, v31
    v_exp_f32 v32, v32
    v_exp_f32 v33, v33
    v_exp_f32 v34, v34
    v_mfma_f32_32x32x16_bf16 v[48:63], v[228:231], v[20:23], v[48:63]
    s_setprio 1
    s_add_u32 m0, s64, 46080
    s_add_u32 s39, s66, 76800
    buffer_load_dwordx4 v11, s[16:19], s39 offen sc1 lds
    v_cvt_pk_bf16_f32 v32, v32, v33
    v_exp_f32 v35, v35
    v_exp_f32 v36, v36
    v_mfma_f32_32x32x16_bf16 v[16:31], v[208:211], v[232:235], 0
    s_add_u32 m0, s64, 46080
    s_add_u32 s39, s66, 76800
    s_mov_b64 exec, s[68:69]
    buffer_load_dwordx4 v11, s[16:19], s39 offen offset:1024 lds
    s_mov_b64 exec, -1
    v_cvt_pk_bf16_f32 v33, v34, v35
    v_exp_f32 v37, v37
    v_exp_f32 v38, v38
    v_cvt_pk_bf16_f32 v34, v36, v37
    v_mfma_f32_32x32x8_bf16 v[16:31], v[212:213], v[236:237], v[16:31]
    v_exp_f32 v39, v39
    v_exp_f32 v40, v40
    v_cvt_pk_bf16_f32 v35, v38, v39
    s_waitcnt vmcnt(9) lgkmcnt(2)
    v_mfma_f32_32x32x16_bf16 v[80:95], v[164:167], v[120:123], v[80:95]
    ds_read_b128 v[116:119], v182 offset:12288
    v_exp_f32 v41, v41
    v_exp_f32 v42, v42
    v_cvt_pk_bf16_f32 v36, v40, v41
    v_exp_f32 v43, v43
    s_waitcnt lgkmcnt(2)
    v_mfma_f32_32x32x16_bf16 v[96:111], v[164:167], v[124:127], v[96:111]
    ds_read_b128 v[120:123], v183 offset:8192
    s_mov_b32 s37, 61440
    buffer_load_dwordx4 v[164:167], v7, s[16:19], s37 offen offset:1024 sc1
    v_exp_f32 v44, v44
    v_cvt_pk_bf16_f32 v37, v42, v43
    v_exp_f32 v45, v45
    v_exp_f32 v46, v46
    s_waitcnt vmcnt(9) lgkmcnt(2)
    v_mfma_f32_32x32x16_bf16 v[80:95], v[168:171], v[112:115], v[80:95]
    ds_read_b128 v[124:127], v183 offset:12288
    v_cvt_pk_bf16_f32 v38, v44, v45
    v_exp_f32 v47, v47
    v_mfma_f32_32x32x16_bf16 v[64:79], v[224:227], v[32:35], v[64:79]
    v_cvt_pk_bf16_f32 v39, v46, v47
    v_exp_f32 v16, v16
    v_exp_f32 v17, v17
    v_exp_f32 v18, v18
    v_mfma_f32_32x32x16_bf16 v[64:79], v[228:231], v[36:39], v[64:79]
    s_setprio 0
    v_cvt_pk_bf16_f32 v16, v16, v17
    v_exp_f32 v19, v19
    v_exp_f32 v20, v20
    v_mfma_f32_32x32x16_bf16 v[32:47], v[208:211], v[238:241], 0
    ds_read_b128 v[208:211], v4 offset:17920
    v_cvt_pk_bf16_f32 v17, v18, v19
    v_exp_f32 v21, v21
    v_exp_f32 v22, v22
    v_cvt_pk_bf16_f32 v18, v20, v21
    v_mfma_f32_32x32x8_bf16 v[32:47], v[212:213], v[242:243], v[32:47]
    s_mov_b64 exec, s[34:35]
    ds_read_b64 v[212:213], v5 offset:18944
    s_mov_b64 exec, s[32:33]
    ds_read_b128 v[224:227], v6 offset:19200
    ds_read_b128 v[228:231], v6 offset:19840
    s_mov_b64 exec, -1
    v_exp_f32 v23, v23
    v_exp_f32 v24, v24
    v_cvt_pk_bf16_f32 v19, v22, v23
    s_waitcnt lgkmcnt(6)
    v_mfma_f32_32x32x16_bf16 v[96:111], v[168:171], v[116:119], v[96:111]
    s_mov_b32 s37, 61440
    buffer_load_dwordx4 v[168:171], v7, s[16:19], s37 offen offset:2048 sc1
    v_exp_f32 v25, v25
    v_exp_f32 v26, v26
    v_cvt_pk_bf16_f32 v20, v24, v25
    v_exp_f32 v27, v27
    s_waitcnt vmcnt(9) lgkmcnt(5)
    v_mfma_f32_32x32x16_bf16 v[80:95], v[172:175], v[120:123], v[80:95]
    v_exp_f32 v28, v28
    v_cvt_pk_bf16_f32 v21, v26, v27
    v_exp_f32 v29, v29
    v_exp_f32 v30, v30
    s_waitcnt lgkmcnt(4)
    v_mfma_f32_32x32x16_bf16 v[96:111], v[172:175], v[124:127], v[96:111]
    s_mov_b32 s37, 61440
    buffer_load_dwordx4 v[172:175], v7, s[16:19], s37 offen offset:3072 sc1
    v_cvt_pk_bf16_f32 v22, v28, v29
    v_exp_f32 v31, v31
    v_mfma_f32_32x32x16_bf16 v[48:63], v[216:219], v[16:19], v[48:63]
    v_cvt_pk_bf16_f32 v23, v30, v31
    s_cmp_lg_u32 s30, 4
    s_cbranch_scc1 K2_F3OKG
    s_waitcnt vmcnt(7)
    v_and_b32 v248, v248, v249
    v_and_b32 v248, v248, v250
    v_and_b32 v248, v248, v251
    v_and_b32 v248, v248, v252
    v_cmp_ne_u32 vcc, 1, v248
    s_cbranch_vccz K2_F3OKG
K2_F3SPG:
    s_cmp_eq_u32 s96, 0
    s_cbranch_scc1 K2_F3OKG
    s_sub_u32 s96, s96, 1
    s_sleep 12
    s_mov_b64 exec, vcc
    v_add_u32 v12, 3087360, v11
    buffer_load_dwordx4 v[248:251], v12, s[16:19], 0 offen offset:0 sc1
    buffer_load_dword v252, v8, s[16:19], 0 offen offset:0 sc1
    s_waitcnt vmcnt(0)
    v_and_b32 v248, v248, v249
    v_and_b32 v248, v248, v250
    v_and_b32 v248, v248, v251
    v_and_b32 v248, v248, v252
    v_cmp_ne_u32 vcc, 1, v248
    s_mov_b64 exec, -1
    s_cbranch_vccnz K2_F3SPG
K2_F3OKG:
    s_waitcnt lgkmcnt(0)
    s_barrier
    v_exp_f32 v32, v32
    v_exp_f32 v33, v33
    v_exp_f32 v34, v34
    v_mfma_f32_32x32x16_bf16 v[48:63], v[220:223], v[20:23], v[48:63]
    s_setprio 3
    ds_read_b128 v[112:115], v176 offset:4096
    ds_read_b128 v[116:119], v177 offset:4096
    v_cvt_pk_bf16_f32 v32, v32, v33
    v_exp_f32 v35, v35
    v_exp_f32 v36, v36
    v_mfma_f32_32x32x16_bf16 v[16:31], v[208:211], v[232:235], 0
    buffer_load_dword v190, v215, s[16:19], s101 offen sc1
    v_cvt_pk_bf16_f32 v33, v34, v35
    v_exp_f32 v37, v37
    v_exp_f32 v38, v38
    v_cvt_pk_bf16_f32 v34, v36, v37
    v_mfma_f32_32x32x8_bf16 v[16:31], v[212:213], v[236:237], v[16:31]
    buffer_load_dwordx4 v[200:203], v11, s[16:19], s14 offen sc1
    v_exp_f32 v39, v39
    v_exp_f32 v40, v40
    v_cvt_pk_bf16_f32 v35, v38, v39
    s_waitcnt vmcnt(11) lgkmcnt(1)
    v_mfma_f32_32x32x16_bf16 v[96:111], v[144:147], v[112:115], v[96:111]
    ds_read_b128 v[120:123], v178 offset:4096
    ds_read_b128 v[124:127], v179 offset:4096
    v_exp_f32 v41, v41
    v_exp_f32 v42, v42
    v_cvt_pk_bf16_f32 v36, v40, v41
    v_exp_f32 v43, v43
    s_waitcnt vmcnt(10) lgkmcnt(2)
    v_mfma_f32_32x32x16_bf16 v[96:111], v[148:151], v[116:119], v[96:111]
    ds_read_b128 v[112:115], v176 offset:12288
    v_exp_f32 v44, v44
    v_cvt_pk_bf16_f32 v37, v42, v43
    v_exp_f32 v45, v45
    v_exp_f32 v46, v46
    s_waitcnt vmcnt(9) lgkmcnt(2)
    v_mfma_f32_32x32x16_bf16 v[96:111], v[152:155], v[120:123], v[96:111]
    ds_read_b128 v[116:119], v177 offset:12288
    v_cvt_pk_bf16_f32 v38, v44, v45
    v_exp_f32 v47, v47
    v_mfma_f32_32x32x16_bf16 v[64:79], v[216:219], v[32:35], v[64:79]
    v_cvt_pk_bf16_f32 v39, v46, v47
    v_exp_f32 v16, v16
    v_exp_f32 v17, v17
    v_exp_f32 v18, v18
    v_mfma_f32_32x32x16_bf16 v[64:79], v[220:223], v[36:39], v[64:79]
    buffer_load_dwordx4 v[204:207], v11, s[16:19], s14 offen offset:1024 sc1
    v_cvt_pk_bf16_f32 v16, v16, v17
    v_exp_f32 v19, v19
    v_exp_f32 v20, v20
    v_mfma_f32_32x32x16_bf16 v[32:47], v[208:211], v[238:241], 0
    ds_read_b128 v[208:211], v4 offset:20480
    v_cvt_pk_bf16_f32 v17, v18, v19
    v_exp_f32 v21, v21
    v_exp_f32 v22, v22
    v_cvt_pk_bf16_f32 v18, v20, v21
    v_mfma_f32_32x32x8_bf16 v[32:47], v[212:213], v[242:243], v[32:47]
    s_mov_b64 exec, s[34:35]
    ds_read_b64 v[212:213], v5 offset:21504
    s_mov_b64 exec, s[32:33]
    ds_read_b128 v[216:219], v6 offset:21760
    ds_read_b128 v[220:223], v6 offset:22400
    s_mov_b64 exec, -1
    v_exp_f32 v23, v23
    v_exp_f32 v24, v24
    v_cvt_pk_bf16_f32 v19, v22, v23
    s_waitcnt vmcnt(9) lgkmcnt(6)
    v_mfma_f32_32x32x16_bf16 v[96:111], v[156:159], v[124:127], v[96:111]
    ds_read_b128 v[120:123], v178 offset:12288
    buffer_load_ushort v188, v191, s[24:27], s15 offen
    v_exp_f32 v25, v25
    v_exp_f32 v26, v26
    v_cvt_pk_bf16_f32 v20, v24, v25
    v_exp_f32 v27, v27
    s_waitcnt vmcnt(9) lgkmcnt(6)
    v_mfma_f32_32x32x16_bf16 v[96:111], v[160:163], v[112:115], v[96:111]
    ds_read_b128 v[124:127], v179 offset:12288
    s_xor_b32 s5, s30, 4
    s_lshl_b32 s5, s5, 12
    s_add_u32 s5, s5, 131072
    v_add_u32 v13, s5, v11
    s_lshl_b32 s5, s30, 12
    s_add_u32 s5, s5, 131072
    v_add_u32 v184, s5, v11
    s_mul_i32 s5, s67, 245760
    s_add_u32 s5, s5, 16777216
    s_add_u32 s40, s12, s5
    s_addc_u32 s41, s13, 0
    s_mov_b32 s42, 245760
    s_mov_b32 s43, 0x00020000
    v_exp_f32 v28, v28
    v_cvt_pk_bf16_f32 v21, v26, v27
    v_exp_f32 v29, v29
    v_exp_f32 v30, v30
    s_waitcnt vmcnt(6) lgkmcnt(6)
    v_mfma_f32_32x32x16_bf16 v[96:111], v[164:167], v[116:119], v[96:111]
    ds_read_b128 v[112:115], v176 offset:0
    v_cvt_pk_bf16_f32 v22, v28, v29
    v_exp_f32 v31, v31
    v_mfma_f32_32x32x16_bf16 v[48:63], v[224:227], v[16:19], v[48:63]
    v_cvt_pk_bf16_f32 v23, v30, v31
    v_exp_f32 v32, v32
    v_exp_f32 v33, v33
    v_exp_f32 v34, v34
    v_mfma_f32_32x32x16_bf16 v[48:63], v[228:231], v[20:23], v[48:63]
    s_setprio 2
    s_waitcnt lgkmcnt(5)
    buffer_load_dword v189, v215, s[16:19], s100 offen sc1
    v_cvt_pk_bf16_f32 v32, v32, v33
    v_exp_f32 v35, v35
    v_exp_f32 v36, v36
    v_mfma_f32_32x32x16_bf16 v[16:31], v[208:211], v[232:235], 0
    v_cvt_pk_bf16_f32 v33, v34, v35
    v_exp_f32 v37, v37
    v_exp_f32 v38, v38
    v_mfma_f32_32x32x8_bf16 v[16:31], v[212:213], v[236:237], v[16:31]
    s_waitcnt lgkmcnt(3)
    v_cvt_pk_bf16_f32 v34, v36, v37
    v_exp_f32 v39, v39
    v_exp_f32 v40, v40
    s_waitcnt vmcnt(6) lgkmcnt(2)
    v_mfma_f32_32x32x16_bf16 v[96:111], v[168:171], v[120:123], v[96:111]
    ds_read_b128 v[116:119], v177 offset:0
    v_cvt_pk_bf16_f32 v35, v38, v39
    v_exp_f32 v41, v41
    v_exp_f32 v42, v42
    s_waitcnt vmcnt(5) lgkmcnt(2)
    v_mfma_f32_32x32x16_bf16 v[96:111], v[172:175], v[124:127], v[96:111]
    ds_read_b128 v[120:123], v178 offset:0
    v_cvt_pk_bf16_f32 v36, v40, v41
    v_exp_f32 v43, v43
    v_exp_f32 v44, v44
    s_waitcnt lgkmcnt(2)
    v_mfma_f32_32x32x16_bf16 v[80:95], v[144:147], v[112:115], v[80:95]
    ds_read_b128 v[124:127], v179 offset:0
    v_cvt_pk_bf16_f32 v37, v42, v43
    v_exp_f32 v45, v45
    v_exp_f32 v46, v46
    s_waitcnt lgkmcnt(2)
    v_mfma_f32_32x32x16_bf16 v[80:95], v[148:151], v[116:119], v[80:95]
    ds_read_b128 v[112:115], v176 offset:8192
    v_cvt_pk_bf16_f32 v38, v44, v45
    v_exp_f32 v47, v47
    v_mfma_f32_32x32x16_bf16 v[64:79], v[224:227], v[32:35], v[64:79]
    v_cvt_pk_bf16_f32 v39, v46, v47
    v_exp_f32 v16, v16
    v_exp_f32 v17, v17
    v_exp_f32 v18, v18
    v_mfma_f32_32x32x16_bf16 v[64:79], v[228:231], v[36:39], v[64:79]
    s_setprio 1
    v_cvt_pk_bf16_f32 v16, v16, v17
    v_exp_f32 v19, v19
    v_exp_f32 v20, v20
    v_mfma_f32_32x32x16_bf16 v[32:47], v[208:211], v[238:241], 0
    ds_read_b128 v[208:211], v4 offset:30720
    v_cvt_pk_bf16_f32 v17, v18, v19
    v_exp_f32 v21, v21
    v_exp_f32 v22, v22
    v_cvt_pk_bf16_f32 v18, v20, v21
    v_mfma_f32_32x32x8_bf16 v[32:47], v[212:213], v[242:243], v[32:47]
    s_mov_b64 exec, s[34:35]
    ds_read_b64 v[212:213], v5 offset:31744
    s_mov_b64 exec, s[32:33]
    ds_read_b128 v[224:227], v6 offset:32000
    ds_read_b128 v[228:231], v6 offset:32640
    s_mov_b64 exec, -1
    v_exp_f32 v23, v23
    v_exp_f32 v24, v24
    v_cvt_pk_bf16_f32 v19, v22, v23
    s_waitcnt lgkmcnt(6)
    v_mfma_f32_32x32x16_bf16 v[80:95], v[152:155], v[120:123], v[80:95]
    ds_read_b128 v[116:119], v177 offset:8192
    v_exp_f32 v25, v25
    v_exp_f32 v26, v26
    v_cvt_pk_bf16_f32 v20, v24, v25
    v_exp_f32 v27, v27
    s_waitcnt lgkmcnt(6)
    v_mfma_f32_32x32x16_bf16 v[80:95], v[156:159], v[124:127], v[80:95]
    ds_read_b128 v[120:123], v178 offset:8192
    v_exp_f32 v28, v28
    v_cvt_pk_bf16_f32 v21, v26, v27
    v_exp_f32 v29, v29
    v_exp_f32 v30, v30
    s_waitcnt lgkmcnt(6)
    v_mfma_f32_32x32x16_bf16 v[80:95], v[160:163], v[112:115], v[80:95]
    ds_read_b128 v[124:127], v179 offset:8192
    v_cvt_pk_bf16_f32 v22, v28, v29
    v_exp_f32 v31, v31
    v_mfma_f32_32x32x16_bf16 v[48:63], v[216:219], v[16:19], v[48:63]
    v_cvt_pk_bf16_f32 v23, v30, v31
    v_exp_f32 v32, v32
    v_exp_f32 v33, v33
    v_exp_f32 v34, v34
    v_mfma_f32_32x32x16_bf16 v[48:63], v[220:223], v[20:23], v[48:63]
    s_setprio 0
    s_waitcnt lgkmcnt(5)
    ds_write_b128 v13, v[96:99] offset:0
    v_cvt_pk_bf16_f32 v32, v32, v33
    v_exp_f32 v35, v35
    v_exp_f32 v36, v36
    v_mfma_f32_32x32x16_bf16 v[16:31], v[208:211], v[232:235], 0
    ds_write_b128 v13, v[100:103] offset:1024
    v_cvt_pk_bf16_f32 v33, v34, v35
    v_exp_f32 v37, v37
    v_exp_f32 v38, v38
    v_cvt_pk_bf16_f32 v34, v36, v37
    v_mfma_f32_32x32x8_bf16 v[16:31], v[212:213], v[236:237], v[16:31]
    s_waitcnt lgkmcnt(5)
    ds_write_b128 v13, v[104:107] offset:2048
    v_exp_f32 v39, v39
    v_exp_f32 v40, v40
    v_cvt_pk_bf16_f32 v35, v38, v39
    s_waitcnt lgkmcnt(5)
    v_mfma_f32_32x32x16_bf16 v[80:95], v[164:167], v[116:119], v[80:95]
    ds_write_b128 v13, v[108:111] offset:3072
    v_exp_f32 v41, v41
    v_exp_f32 v42, v42
    v_cvt_pk_bf16_f32 v36, v40, v41
    v_exp_f32 v43, v43
    s_waitcnt lgkmcnt(5)
    v_mfma_f32_32x32x16_bf16 v[80:95], v[168:171], v[120:123], v[80:95]
    v_exp_f32 v44, v44
    v_cvt_pk_bf16_f32 v37, v42, v43
    v_exp_f32 v45, v45
    v_exp_f32 v46, v46
    s_waitcnt lgkmcnt(4)
    v_mfma_f32_32x32x16_bf16 v[80:95], v[172:175], v[124:127], v[80:95]
    v_cvt_pk_bf16_f32 v38, v44, v45
    v_exp_f32 v47, v47
    v_mfma_f32_32x32x16_bf16 v[64:79], v[216:219], v[32:35], v[64:79]
    v_cvt_pk_bf16_f32 v39, v46, v47
    s_waitcnt lgkmcnt(0)
    s_barrier
    v_exp_f32 v16, v16
    v_exp_f32 v17, v17
    v_exp_f32 v18, v18
    v_mfma_f32_32x32x16_bf16 v[64:79], v[220:223], v[36:39], v[64:79]
    s_setprio 3
    ds_read_b128 v[96:99], v184 offset:0
    ds_read_b128 v[100:103], v184 offset:1024
    ds_read_b128 v[104:107], v184 offset:2048
    ds_read_b128 v[108:111], v184 offset:3072
    v_cvt_pk_bf16_f32 v16, v16, v17
    v_exp_f32 v19, v19
    v_exp_f32 v20, v20
    v_cvt_pk_bf16_f32 v17, v18, v19
    v_exp_f32 v21, v21
    v_mfma_f32_32x32x16_bf16 v[32:47], v[208:211], v[238:241], 0
    ds_read_b128 v[208:211], v4 offset:33280
    v_exp_f32 v22, v22
    v_cvt_pk_bf16_f32 v18, v20, v21
    v_exp_f32 v23, v23
    v_exp_f32 v24, v24
    v_cvt_pk_bf16_f32 v19, v22, v23
    v_mfma_f32_32x32x8_bf16 v[32:47], v[212:213], v[242:243], v[32:47]
    s_mov_b64 exec, s[34:35]
    ds_read_b64 v[212:213], v5 offset:34304
    s_mov_b64 exec, s[32:33]
    ds_read_b128 v[216:219], v6 offset:34560
    ds_read_b128 v[220:223], v6 offset:35200
    s_mov_b64 exec, -1
    v_exp_f32 v25, v25
    v_exp_f32 v26, v26
    v_cvt_pk_bf16_f32 v20, v24, v25
    v_exp_f32 v27, v27
    v_exp_f32 v28, v28
    v_cvt_pk_bf16_f32 v21, v26, v27
    v_exp_f32 v29, v29
    v_exp_f32 v30, v30
    v_cvt_pk_bf16_f32 v22, v28, v29
    v_exp_f32 v31, v31
    v_mfma_f32_32x32x16_bf16 v[48:63], v[224:227], v[16:19], v[48:63]
    s_waitcnt vmcnt(0)
    s_cmp_ge_u32 s60, 27
    s_cbranch_scc1 K2_NOU
    v_sub_f32 v244, 1.0, v189
    v_lshlrev_b32 v188, 16, v188
    v_mov_b32 v245, v244
    v_mul_f32 v246, v188, v244
    v_mov_b32 v247, v246
    v_lshlrev_b32 v144, 16, v200
    v_and_b32 v145, 0xffff0000, v200
    v_lshlrev_b32 v146, 16, v201
    v_and_b32 v147, 0xffff0000, v201
    v_lshlrev_b32 v148, 16, v202
    v_and_b32 v149, 0xffff0000, v202
    v_lshlrev_b32 v150, 16, v203
    v_and_b32 v151, 0xffff0000, v203
    v_lshlrev_b32 v152, 16, v204
    v_and_b32 v153, 0xffff0000, v204
    v_lshlrev_b32 v154, 16, v205
    v_and_b32 v155, 0xffff0000, v205
    v_lshlrev_b32 v156, 16, v206
    v_and_b32 v157, 0xffff0000, v206
    v_lshlrev_b32 v158, 16, v207
    v_and_b32 v159, 0xffff0000, v207
    s_mul_i32 s5, s62, 94
    s_lshl_b32 s6, s60, 1
    s_add_u32 s5, s5, s6
    s_lshl_b32 s5, s5, 10
    s_add_u32 s5, s5, 10526720
    s_waitcnt lgkmcnt(4)
    v_pk_add_f32 v[80:81], v[80:81], v[96:97]
    v_pk_add_f32 v[82:83], v[82:83], v[98:99]
    v_pk_add_f32 v[84:85], v[84:85], v[100:101]
    v_pk_add_f32 v[86:87], v[86:87], v[102:103]
    v_pk_add_f32 v[88:89], v[88:89], v[104:105]
    v_pk_add_f32 v[90:91], v[90:91], v[106:107]
    v_pk_add_f32 v[92:93], v[92:93], v[108:109]
    v_pk_add_f32 v[94:95], v[94:95], v[110:111]
    v_pk_fma_f32 v[80:81], v[80:81], v[244:245], v[246:247]
    v_pk_fma_f32 v[82:83], v[82:83], v[244:245], v[246:247]
    v_pk_fma_f32 v[84:85], v[84:85], v[244:245], v[246:247]
    v_pk_fma_f32 v[86:87], v[86:87], v[244:245], v[246:247]
    v_pk_fma_f32 v[88:89], v[88:89], v[244:245], v[246:247]
    v_pk_fma_f32 v[90:91], v[90:91], v[244:245], v[246:247]
    v_pk_fma_f32 v[92:93], v[92:93], v[244:245], v[246:247]
    v_pk_fma_f32 v[94:95], v[94:95], v[244:245], v[246:247]
    v_pk_mul_f32 v[80:81], v[80:81], v[144:145]
    v_pk_mul_f32 v[82:83], v[82:83], v[146:147]
    v_pk_mul_f32 v[84:85], v[84:85], v[148:149]
    v_pk_mul_f32 v[86:87], v[86:87], v[150:151]
    v_pk_mul_f32 v[88:89], v[88:89], v[152:153]
    v_pk_mul_f32 v[90:91], v[90:91], v[154:155]
    v_pk_mul_f32 v[92:93], v[92:93], v[156:157]
    v_pk_mul_f32 v[94:95], v[94:95], v[158:159]
    v_cvt_pk_bf16_f32 v96, v80, v81
    v_cvt_pk_bf16_f32 v97, v82, v83
    v_cvt_pk_bf16_f32 v98, v84, v85
    v_cvt_pk_bf16_f32 v99, v86, v87
    v_cvt_pk_bf16_f32 v100, v88, v89
    v_cvt_pk_bf16_f32 v101, v90, v91
    v_cvt_pk_bf16_f32 v102, v92, v93
    v_cvt_pk_bf16_f32 v103, v94, v95
    buffer_store_dwordx4 v[96:99], v11, s[16:19], s5 offen sc1
    buffer_store_dwordx4 v[100:103], v11, s[16:19], s5 offen offset:1024 sc1
K2_NOU:
    v_cvt_pk_bf16_f32 v23, v30, v31
    v_exp_f32 v32, v32
    v_exp_f32 v33, v33
    v_exp_f32 v34, v34
    v_mfma_f32_32x32x16_bf16 v[48:63], v[228:231], v[20:23], v[48:63]
    s_setprio 2
    s_waitcnt lgkmcnt(2)
    s_mul_i32 s5, s30, 7680
    s_add_u32 m0, s5, 61440
    s_add_u32 s6, s5, 102400
    buffer_load_dwordx4 v11, s[40:43], s6 offen sc1 lds
    v_cvt_pk_bf16_f32 v32, v32, v33
    v_exp_f32 v35, v35
    v_exp_f32 v36, v36
    v_cvt_pk_bf16_f32 v33, v34, v35
    v_exp_f32 v37, v37
    v_mfma_f32_32x32x16_bf16 v[16:31], v[208:211], v[232:235], 0
    s_mul_i32 s5, s30, 7680
    s_add_u32 m0, s5, 62464
    s_add_u32 s6, s5, 103424
    buffer_load_dwordx4 v11, s[40:43], s6 offen sc1 lds
    v_exp_f32 v38, v38
    v_cvt_pk_bf16_f32 v34, v36, v37
    v_exp_f32 v39, v39
    v_exp_f32 v40, v40
    v_cvt_pk_bf16_f32 v35, v38, v39
    v_mfma_f32_32x32x8_bf16 v[16:31], v[212:213], v[236:237], v[16:31]
    s_waitcnt lgkmcnt(0)
    s_mul_i32 s5, s30, 7680
    s_add_u32 m0, s5, 63488
    s_add_u32 s6, s5, 104448
    buffer_load_dwordx4 v11, s[40:43], s6 offen sc1 lds
    v_exp_f32 v41, v41
    v_exp_f32 v42, v42
    v_cvt_pk_bf16_f32 v36, v40, v41
    v_exp_f32 v43, v43
    v_exp_f32 v44, v44
    v_cvt_pk_bf16_f32 v37, v42, v43
    v_exp_f32 v45, v45
    v_exp_f32 v46, v46
    v_cvt_pk_bf16_f32 v38, v44, v45
    v_exp_f32 v47, v47
    v_mfma_f32_32x32x16_bf16 v[64:79], v[224:227], v[32:35], v[64:79]
    v_cvt_pk_bf16_f32 v39, v46, v47
    v_exp_f32 v16, v16
    v_exp_f32 v17, v17
    v_exp_f32 v18, v18
    v_mfma_f32_32x32x16_bf16 v[64:79], v[228:231], v[36:39], v[64:79]
    s_setprio 1
    s_mul_i32 s5, s30, 7680
    s_add_u32 m0, s5, 64512
    s_add_u32 s6, s5, 105472
    buffer_load_dwordx4 v11, s[40:43], s6 offen sc1 lds
    v_cvt_pk_bf16_f32 v16, v16, v17
    v_exp_f32 v19, v19
    v_exp_f32 v20, v20
    v_cvt_pk_bf16_f32 v17, v18, v19
    v_exp_f32 v21, v21
    v_mfma_f32_32x32x16_bf16 v[32:47], v[208:211], v[238:241], 0
    ds_read_b128 v[208:211], v4 offset:35840
    v_exp_f32 v22, v22
    v_cvt_pk_bf16_f32 v18, v20, v21
    v_exp_f32 v23, v23
    v_exp_f32 v24, v24
    v_cvt_pk_bf16_f32 v19, v22, v23
    v_mfma_f32_32x32x8_bf16 v[32:47], v[212:213], v[242:243], v[32:47]
    s_mov_b64 exec, s[34:35]
    ds_read_b64 v[212:213], v5 offset:36864
    s_mov_b64 exec, s[32:33]
    ds_read_b128 v[224:227], v6 offset:37120
    ds_read_b128 v[228:231], v6 offset:37760
    s_mov_b64 exec, -1
    v_exp_f32 v25, v25
    v_exp_f32 v26, v26
    v_cvt_pk_bf16_f32 v20, v24, v25
    v_exp_f32 v27, v27
    v_exp_f32 v28, v28
    v_cvt_pk_bf16_f32 v21, v26, v27
    v_exp_f32 v29, v29
    v_exp_f32 v30, v30
    v_cvt_pk_bf16_f32 v22, v28, v29
    v_exp_f32 v31, v31
    v_mfma_f32_32x32x16_bf16 v[48:63], v[216:219], v[16:19], v[48:63]
    s_mul_i32 s5, s30, 7680
    s_add_u32 m0, s5, 65536
    s_add_u32 s6, s5, 106496
    buffer_load_dwordx4 v11, s[40:43], s6 offen sc1 lds
    s_mul_i32 s5, s30, 7680
    s_add_u32 m0, s5, 66560
    s_add_u32 s6, s5, 107520
    buffer_load_dwordx4 v11, s[40:43], s6 offen sc1 lds
    v_cvt_pk_bf16_f32 v23, v30, v31
    v_exp_f32 v32, v32
    v_exp_f32 v33, v33
    v_exp_f32 v34, v34
    v_mfma_f32_32x32x16_bf16 v[48:63], v[220:223], v[20:23], v[48:63]
    s_setprio 0
    s_waitcnt lgkmcnt(2)
    s_mul_i32 s5, s30, 7680
    s_add_u32 m0, s5, 67584
    s_add_u32 s6, s5, 108544
    buffer_load_dwordx4 v11, s[40:43], s6 offen sc1 lds
    v_cvt_pk_bf16_f32 v32, v32, v33
    v_exp_f32 v35, v35
    v_exp_f32 v36, v36
    v_cvt_pk_bf16_f32 v33, v34, v35
    v_exp_f32 v37, v37
    v_mfma_f32_32x32x16_bf16 v[16:31], v[208:211], v[232:235], 0
    s_mul_i32 s5, s30, 7680
    s_add_u32 m0, s5, 68608
    s_add_u32 s6, s5, 109568
    s_mov_b32 exec_lo, 0xffffffff
    s_mov_b32 exec_hi, 0x0
    buffer_load_dwordx4 v11, s[40:43], s6 offen sc1 lds
    s_mov_b64 exec, -1
    v_exp_f32 v38, v38
    v_cvt_pk_bf16_f32 v34, v36, v37
    v_exp_f32 v39, v39
    v_exp_f32 v40, v40
    v_cvt_pk_bf16_f32 v35, v38, v39
    v_mfma_f32_32x32x8_bf16 v[16:31], v[212:213], v[236:237], v[16:31]
    s_waitcnt lgkmcnt(0)
    v_exp_f32 v41, v41
    v_exp_f32 v42, v42
    v_cvt_pk_bf16_f32 v36, v40, v41
    v_exp_f32 v43, v43
    v_exp_f32 v44, v44
    v_cvt_pk_bf16_f32 v37, v42, v43
    v_exp_f32 v45, v45
    v_exp_f32 v46, v46
    v_cvt_pk_bf16_f32 v38, v44, v45
    v_exp_f32 v47, v47
    v_mfma_f32_32x32x16_bf16 v[64:79], v[216:219], v[32:35], v[64:79]
    v_cvt_pk_bf16_f32 v39, v46, v47
    s_barrier
    v_exp_f32 v16, v16
    v_exp_f32 v17, v17
    v_exp_f32 v18, v18
    v_mfma_f32_32x32x16_bf16 v[64:79], v[220:223], v[36:39], v[64:79]
    s_setprio 3
    s_waitcnt vmcnt(8)
    s_mov_b64 exec, 1
    buffer_store_dword v14, v15, s[16:19], 0 offen sc1
    s_mov_b64 exec, -1
    v_cvt_pk_bf16_f32 v16, v16, v17
    v_exp_f32 v19, v19
    v_exp_f32 v20, v20
    v_cvt_pk_bf16_f32 v17, v18, v19
    v_exp_f32 v21, v21
    v_mfma_f32_32x32x16_bf16 v[32:47], v[208:211], v[238:241], 0
    ds_read_b128 v[208:211], v4 offset:46080
    v_exp_f32 v22, v22
    v_cvt_pk_bf16_f32 v18, v20, v21
    v_exp_f32 v23, v23
    v_exp_f32 v24, v24
    v_cvt_pk_bf16_f32 v19, v22, v23
    v_mfma_f32_32x32x8_bf16 v[32:47], v[212:213], v[242:243], v[32:47]
    s_mov_b64 exec, s[34:35]
    ds_read_b64 v[212:213], v5 offset:47104
    s_mov_b64 exec, s[32:33]
    ds_read_b128 v[216:219], v6 offset:47360
    ds_read_b128 v[220:223], v6 offset:48000
    s_mov_b64 exec, -1
    v_exp_f32 v25, v25
    v_exp_f32 v26, v26
    v_cvt_pk_bf16_f32 v20, v24, v25
    v_exp_f32 v27, v27
    v_exp_f32 v28, v28
    v_cvt_pk_bf16_f32 v21, v26, v27
    v_exp_f32 v29, v29
    v_exp_f32 v30, v30
    v_cvt_pk_bf16_f32 v22, v28, v29
    v_exp_f32 v31, v31
    v_mfma_f32_32x32x16_bf16 v[48:63], v[224:227], v[16:19], v[48:63]
    s_mul_i32 s5, s30, 5120
    s_add_u32 m0, s5, 0
    s_add_u32 s6, s5, 163840
    buffer_load_dwordx4 v11, s[40:43], s6 offen sc1 lds
    s_mul_i32 s5, s30, 5120
    s_add_u32 m0, s5, 1024
    s_add_u32 s6, s5, 164864
    buffer_load_dwordx4 v11, s[40:43], s6 offen sc1 lds
    s_mul_i32 s5, s30, 5120
    s_add_u32 m0, s5, 2048
    s_add_u32 s6, s5, 165888
    buffer_load_dwordx4 v11, s[40:43], s6 offen sc1 lds
    v_cvt_pk_bf16_f32 v23, v30, v31
    v_exp_f32 v32, v32
    v_exp_f32 v33, v33
    v_exp_f32 v34, v34
    v_mfma_f32_32x32x16_bf16 v[48:63], v[228:231], v[20:23], v[48:63]
    s_setprio 2
    s_waitcnt lgkmcnt(2)
    s_mul_i32 s5, s30, 5120
    s_add_u32 m0, s5, 3072
    s_add_u32 s6, s5, 166912
    buffer_load_dwordx4 v11, s[40:43], s6 offen sc1 lds
    v_cvt_pk_bf16_f32 v32, v32, v33
    v_exp_f32 v35, v35
    v_exp_f32 v36, v36
    v_cvt_pk_bf16_f32 v33, v34, v35
    v_exp_f32 v37, v37
    v_mfma_f32_32x32x16_bf16 v[16:31], v[208:211], v[232:235], 0
    s_mul_i32 s5, s30, 5120
    s_add_u32 m0, s5, 4096
    s_add_u32 s6, s5, 167936
    buffer_load_dwordx4 v11, s[40:43], s6 offen sc1 lds
    v_exp_f32 v38, v38
    v_cvt_pk_bf16_f32 v34, v36, v37
    v_exp_f32 v39, v39
    v_exp_f32 v40, v40
    v_cvt_pk_bf16_f32 v35, v38, v39
    v_mfma_f32_32x32x8_bf16 v[16:31], v[212:213], v[236:237], v[16:31]
    s_waitcnt lgkmcnt(0)
    s_lshl_b32 s62, s36, 1
    s_add_u32 s62, s62, s48
    s_mul_i32 s5, s62, 96256
    s_lshl_b32 s6, s46, 11
    s_add_u32 s5, s5, s6
    s_add_u32 s5, s5, 10485760
    v_and_b32 v246, 15, v1
    s_lshl_b32 s6, s47, 4
    v_add_u32 v246, s6, v246
    v_lshrrev_b32 v247, 4, v1
    v_lshl_add_u32 v244, v247, 9, s5
    v_lshl_add_u32 v9, v246, 4, v244
    v_lshl_add_u32 v10, v246, 3, v244
    s_lshl_b32 s5, s62, 5
    v_add_u32 v244, s5, v246
    s_movk_i32 s6, 1280
    v_mul_lo_u32 v244, v244, s6
    v_lshl_add_u32 v244, v247, 3, v244
    s_mul_i32 s5, s67, 160
    v_add_u32 v7, s5, v244
    s_mul_i32 s5, s46, 5120
    s_add_u32 s5, s5, 61440
    v_add_u32 v186, s5, v11
    v_lshrrev_b32 v244, 3, v1
    v_min_u32 v244, 6, v244
    v_lshlrev_b32 v244, 10, v244
    v_and_b32 v245, 7, v1
    v_lshl_add_u32 v244, v245, 2, v244
    s_lshl_b32 s5, s36, 5
    s_add_u32 s5, s5, 3080192
    v_add_u32 v191, s5, v244
    s_lshl_b32 s5, s36, 8
    s_add_u32 s5, s5, 3088384
    v_lshl_add_u32 v185, v1, 2, s5
    s_lshl_b32 s5, s28, 8
    s_add_u32 s5, s5, 3088384
    s_lshl_b32 s6, s29, 3
    s_add_u32 s6, s6, s30
    s_lshl_b32 s6, s6, 2
    s_add_u32 s5, s5, s6
    v_mov_b32 v15, s5
    v_exp_f32 v41, v41
    v_exp_f32 v42, v42
    v_cvt_pk_bf16_f32 v36, v40, v41
    v_exp_f32 v43, v43
    v_exp_f32 v44, v44
    v_cvt_pk_bf16_f32 v37, v42, v43
    v_exp_f32 v45, v45
    v_exp_f32 v46, v46
    v_cvt_pk_bf16_f32 v38, v44, v45
    v_exp_f32 v47, v47
    v_mfma_f32_32x32x16_bf16 v[64:79], v[224:227], v[32:35], v[64:79]
    v_cvt_pk_bf16_f32 v39, v46, v47
    v_exp_f32 v16, v16
    v_exp_f32 v17, v17
    v_exp_f32 v18, v18
    v_mfma_f32_32x32x16_bf16 v[64:79], v[228:231], v[36:39], v[64:79]
    s_setprio 1
    v_cvt_pk_bf16_f32 v16, v16, v17
    v_exp_f32 v19, v19
    v_exp_f32 v20, v20
    v_cvt_pk_bf16_f32 v17, v18, v19
    v_exp_f32 v21, v21
    v_mfma_f32_32x32x16_bf16 v[32:47], v[208:211], v[238:241], 0
    ds_read_b128 v[208:211], v4 offset:48640
    v_exp_f32 v22, v22
    v_cvt_pk_bf16_f32 v18, v20, v21
    v_exp_f32 v23, v23
    v_exp_f32 v24, v24
    v_cvt_pk_bf16_f32 v19, v22, v23
    v_mfma_f32_32x32x8_bf16 v[32:47], v[212:213], v[242:243], v[32:47]
    s_mov_b64 exec, s[34:35]
    ds_read_b64 v[212:213], v5 offset:49664
    s_mov_b64 exec, s[32:33]
    ds_read_b128 v[224:227], v6 offset:49920
    ds_read_b128 v[228:231], v6 offset:50560
    s_mov_b64 exec, -1
    v_exp_f32 v25, v25
    v_exp_f32 v26, v26
    v_cvt_pk_bf16_f32 v20, v24, v25
    v_exp_f32 v27, v27
    v_exp_f32 v28, v28
    v_cvt_pk_bf16_f32 v21, v26, v27
    v_exp_f32 v29, v29
    v_exp_f32 v30, v30
    v_cvt_pk_bf16_f32 v22, v28, v29
    v_exp_f32 v31, v31
    v_mfma_f32_32x32x16_bf16 v[48:63], v[216:219], v[16:19], v[48:63]
    v_cvt_pk_bf16_f32 v23, v30, v31
    s_waitcnt vmcnt(5) lgkmcnt(0)
    s_barrier
    v_exp_f32 v32, v32
    v_exp_f32 v33, v33
    v_exp_f32 v34, v34
    v_mfma_f32_32x32x16_bf16 v[48:63], v[220:223], v[20:23], v[48:63]
    s_setprio 3
    ds_read_b128 v[80:83], v186 offset:0
    ds_read_b128 v[84:87], v186 offset:1024
    ds_read_b128 v[88:91], v186 offset:2048
    ds_read_b128 v[92:95], v186 offset:3072
    ds_read_b128 v[96:99], v186 offset:4096
    v_cvt_pk_bf16_f32 v32, v32, v33
    v_exp_f32 v35, v35
    v_exp_f32 v36, v36
    v_cvt_pk_bf16_f32 v33, v34, v35
    v_exp_f32 v37, v37
    v_mfma_f32_32x32x16_bf16 v[16:31], v[208:211], v[232:235], 0
    ds_read_b128 v[100:103], v186 offset:10240
    ds_read_b128 v[104:107], v186 offset:11264
    ds_read_b128 v[108:111], v186 offset:12288
    ds_read_b128 v[112:115], v186 offset:13312
    ds_read_b128 v[116:119], v186 offset:14336
    v_exp_f32 v38, v38
    v_cvt_pk_bf16_f32 v34, v36, v37
    v_exp_f32 v39, v39
    v_exp_f32 v40, v40
    v_cvt_pk_bf16_f32 v35, v38, v39
    v_mfma_f32_32x32x8_bf16 v[16:31], v[212:213], v[236:237], v[16:31]
    v_exp_f32 v41, v41
    v_exp_f32 v42, v42
    v_cvt_pk_bf16_f32 v36, v40, v41
    v_exp_f32 v43, v43
    v_exp_f32 v44, v44
    v_cvt_pk_bf16_f32 v37, v42, v43
    v_exp_f32 v45, v45
    v_exp_f32 v46, v46
    v_cvt_pk_bf16_f32 v38, v44, v45
    v_exp_f32 v47, v47
    v_mfma_f32_32x32x16_bf16 v[64:79], v[216:219], v[32:35], v[64:79]
    v_cvt_pk_bf16_f32 v39, v46, v47
    v_exp_f32 v16, v16
    v_exp_f32 v17, v17
    v_exp_f32 v18, v18
    v_mfma_f32_32x32x16_bf16 v[64:79], v[220:223], v[36:39], v[64:79]
    s_setprio 2
    s_cmp_lg_u32 s30, 4
    s_cbranch_scc1 K2_F4IG
    buffer_load_dword v248, v191, s[16:19], 0 offen offset:0 sc1
K2_F4IG:
    v_cvt_pk_bf16_f32 v16, v16, v17
    v_exp_f32 v19, v19
    v_exp_f32 v20, v20
    v_cvt_pk_bf16_f32 v17, v18, v19
    v_exp_f32 v21, v21
    v_mfma_f32_32x32x16_bf16 v[32:47], v[208:211], v[238:241], 0
    ds_read_b128 v[120:123], v186 offset:20480
    ds_read_b128 v[124:127], v186 offset:21504
    ds_read_b128 v[128:131], v186 offset:22528
    ds_read_b128 v[132:135], v186 offset:23552
    ds_read_b128 v[136:139], v186 offset:24576
    v_exp_f32 v22, v22
    v_cvt_pk_bf16_f32 v18, v20, v21
    v_exp_f32 v23, v23
    v_exp_f32 v24, v24
    v_cvt_pk_bf16_f32 v19, v22, v23
    v_mfma_f32_32x32x8_bf16 v[32:47], v[212:213], v[242:243], v[32:47]
    ds_read_b128 v[140:143], v186 offset:30720
    ds_read_b128 v[144:147], v186 offset:31744
    ds_read_b128 v[148:151], v186 offset:32768
    ds_read_b128 v[152:155], v186 offset:33792
    ds_read_b128 v[156:159], v186 offset:34816
    v_exp_f32 v25, v25
    v_exp_f32 v26, v26
    v_cvt_pk_bf16_f32 v20, v24, v25
    v_exp_f32 v27, v27
    v_exp_f32 v28, v28
    v_cvt_pk_bf16_f32 v21, v26, v27
    v_exp_f32 v29, v29
    v_exp_f32 v30, v30
    v_cvt_pk_bf16_f32 v22, v28, v29
    v_exp_f32 v31, v31
    v_mfma_f32_32x32x16_bf16 v[48:63], v[224:227], v[16:19], v[48:63]
    v_cvt_pk_bf16_f32 v23, v30, v31
    v_exp_f32 v32, v32
    v_exp_f32 v33, v33
    v_exp_f32 v34, v34
    v_mfma_f32_32x32x16_bf16 v[48:63], v[228:231], v[20:23], v[48:63]
    s_setprio 1
    ds_read_b128 v[160:163], v186 offset:40960
    ds_read_b128 v[164:167], v186 offset:41984
    ds_read_b128 v[168:171], v186 offset:43008
    ds_read_b128 v[172:175], v186 offset:44032
    ds_read_b128 v[176:179], v186 offset:45056
    v_cvt_pk_bf16_f32 v32, v32, v33
    v_exp_f32 v35, v35
    v_exp_f32 v36, v36
    v_cvt_pk_bf16_f32 v33, v34, v35
    v_exp_f32 v37, v37
    v_exp_f32 v38, v38
    v_cvt_pk_bf16_f32 v34, v36, v37
    v_exp_f32 v39, v39
    v_exp_f32 v40, v40
    v_cvt_pk_bf16_f32 v35, v38, v39
    v_exp_f32 v41, v41
    v_exp_f32 v42, v42
    v_cvt_pk_bf16_f32 v36, v40, v41
    v_exp_f32 v43, v43
    v_exp_f32 v44, v44
    v_cvt_pk_bf16_f32 v37, v42, v43
    v_exp_f32 v45, v45
    v_exp_f32 v46, v46
    v_cvt_pk_bf16_f32 v38, v44, v45
    v_exp_f32 v47, v47
    v_mfma_f32_32x32x16_bf16 v[64:79], v[224:227], v[32:35], v[64:79]
    ds_write_b128 v13, v[48:51] offset:0
    ds_write_b128 v13, v[52:55] offset:1024
    ds_write_b128 v13, v[56:59] offset:2048
    ds_write_b128 v13, v[60:63] offset:3072
    v_cvt_pk_bf16_f32 v39, v46, v47
    s_cmp_lg_u32 s30, 4
    s_cbranch_scc1 K2_F4OKG
    s_waitcnt vmcnt(0)
    v_cmp_ne_u32 vcc, 1, v248
    s_cmp_eq_u64 vcc, 0
    s_cselect_b32 s5, 1, 0
    v_mov_b32 v248, s5
    v_mov_b32 v249, 122880
    ds_write_b32 v249, v248
    s_waitcnt lgkmcnt(0)
K2_F4OKG:
    s_waitcnt vmcnt(0) lgkmcnt(0)
    s_branch K2_EPI
K2_NOG:
    s_nop 9
    v_exp_f32 v16, v16
    v_exp_f32 v17, v17
    v_exp_f32 v18, v18
    s_setprio 3
    s_waitcnt lgkmcnt(0)
    s_mov_b32 s20, s8
    s_mov_b32 s21, s9
    s_mov_b32 s22, 8388608
    s_mov_b32 s23, 0x00020000
    s_mov_b32 s24, s10
    s_mov_b32 s25, s11
    s_mov_b32 s26, 4096
    s_mov_b32 s27, 0x00020000
    s_lshl_b32 s65, s30, 12
    s_add_u32 s65, s65, 61440
    s_xor_b32 s5, s47, s46
    s_lshl_b32 s7, s28, 1
    s_add_u32 s5, s5, s7
    s_lshl_b32 s5, s5, 17
    s_lshl_b32 s7, s46, 11
    s_add_u32 s5, s5, s7
    s_lshl_b32 s7, s48, 7
    s_add_u32 s5, s5, s7
    v_lshrrev_b32 v12, 3, v1
    v_lshlrev_b32 v12, 12, v12
    v_lshrrev_b32 v15, 4, v1
    v_and_b32 v9, 7, v1
    v_xor_b32 v9, v9, v15
    v_lshl_add_u32 v9, v9, 4, v12
    v_add_u32 v9, s5, v9
    v_xor_b32 v10, 64, v9
    s_lshl_b32 s5, s29, 2
    s_and_b32 s61, s30, 3
    s_add_u32 s60, s5, s61
    s_lshl_b32 s7, s46, 16
    s_add_u32 s7, s7, 18874368
    s_min_u32 s5, s60, 26
    s_lshl_b32 s5, s5, 17
    s_add_u32 s5, s5, s7
    v_add_u32 v7, s5, v11
    s_lshl_b32 s62, s28, 1
    s_add_u32 s62, s62, s46
    s_mul_i32 s14, s62, 54
    s_min_u32 s5, s60, 26
    s_lshl_b32 s5, s5, 1
    s_add_u32 s14, s14, s5
    s_lshl_b32 s14, s14, 10
    s_add_u32 s14, s14, 3145728
    s_lshl_b32 s15, s62, 6
    s_lshl_b32 s100, s62, 7
    s_add_u32 s100, s100, 2883584
    s_lshl_b32 s101, s50, 7
    s_add_u32 s101, s101, 2883584
    v_lshlrev_b32 v191, 1, v2
    v_lshlrev_b32 v215, 2, v2
    v_cvt_pk_bf16_f32 v16, v16, v17
    v_exp_f32 v19, v19
    v_exp_f32 v20, v20
    v_cvt_pk_bf16_f32 v17, v18, v19
    v_exp_f32 v21, v21
    v_mfma_f32_32x32x16_bf16 v[32:47], v[208:211], v[238:241], 0
    ds_read_b128 v[208:211], v4 offset:17920
    v_exp_f32 v22, v22
    v_cvt_pk_bf16_f32 v18, v20, v21
    v_exp_f32 v23, v23
    v_exp_f32 v24, v24
    v_cvt_pk_bf16_f32 v19, v22, v23
    v_mfma_f32_32x32x8_bf16 v[32:47], v[212:213], v[242:243], v[32:47]
    s_mov_b64 exec, s[34:35]
    ds_read_b64 v[212:213], v5 offset:18944
    s_mov_b64 exec, s[32:33]
    ds_read_b128 v[224:227], v6 offset:19200
    ds_read_b128 v[228:231], v6 offset:19840
    s_mov_b64 exec, -1
    v_exp_f32 v25, v25
    v_exp_f32 v26, v26
    v_cvt_pk_bf16_f32 v20, v24, v25
    v_exp_f32 v27, v27
    v_exp_f32 v28, v28
    v_cvt_pk_bf16_f32 v21, v26, v27
    v_exp_f32 v29, v29
    v_exp_f32 v30, v30
    v_cvt_pk_bf16_f32 v22, v28, v29
    v_exp_f32 v31, v31
    v_mfma_f32_32x32x16_bf16 v[48:63], v[216:219], v[16:19], 0
    s_lshl_b32 s5, s46, 14
    s_add_u32 s5, s5, 61440
    v_bfe_u32 v12, v2, 1, 3
    v_xor_b32 v12, v12, v3
    v_lshlrev_b32 v12, 4, v12
    v_lshl_add_u32 v12, v2, 7, v12
    v_xor_b32 v176, 0, v12
    v_add_u32 v176, s5, v176
    v_add_u32 v180, 0x10000, v176
    v_xor_b32 v177, 32, v12
    v_add_u32 v177, s5, v177
    v_add_u32 v181, 0x10000, v177
    v_xor_b32 v178, 64, v12
    v_add_u32 v178, s5, v178
    v_add_u32 v182, 0x10000, v178
    v_xor_b32 v179, 96, v12
    v_add_u32 v179, s5, v179
    v_add_u32 v183, 0x10000, v179
    s_lshl_b32 s5, s29, 5
    s_add_u32 s6, s5, s28
    s_lshl_b32 s6, s6, 3
    s_add_u32 s6, s6, s30
    s_lshl_b32 s6, s6, 2
    s_add_u32 s6, s6, 3080192
    v_mov_b32 v15, s6
    v_mov_b32 v14, 1
    v_cvt_pk_bf16_f32 v23, v30, v31
    v_exp_f32 v32, v32
    v_exp_f32 v33, v33
    v_exp_f32 v34, v34
    v_mfma_f32_32x32x16_bf16 v[48:63], v[220:223], v[20:23], v[48:63]
    s_setprio 2
    s_waitcnt lgkmcnt(2)
    s_mov_b32 s24, s20
    s_mov_b32 s25, s21
    s_mov_b32 s26, s22
    s_mov_b32 s27, s23
    v_cvt_pk_bf16_f32 v32, v32, v33
    v_exp_f32 v35, v35
    v_exp_f32 v36, v36
    v_cvt_pk_bf16_f32 v33, v34, v35
    v_exp_f32 v37, v37
    v_mfma_f32_32x32x16_bf16 v[16:31], v[208:211], v[232:235], 0
    s_waitcnt vmcnt(0)
    s_cmp_ge_u32 s30, 4
    s_cbranch_scc1 K2_ND0N
    s_cmp_eq_u32 s97, 0
    s_cbranch_scc0 K2_ND0N
    v_mov_b32 v244, s98
    s_mov_b64 exec, 1
    buffer_store_dword v14, v244, s[16:19], 0 offen sc1
    s_mov_b64 exec, -1
K2_ND0N:
    v_exp_f32 v38, v38
    v_cvt_pk_bf16_f32 v34, v36, v37
    v_exp_f32 v39, v39
    v_exp_f32 v40, v40
    v_cvt_pk_bf16_f32 v35, v38, v39
    v_mfma_f32_32x32x8_bf16 v[16:31], v[212:213], v[236:237], v[16:31]
    s_waitcnt lgkmcnt(0)
    v_exp_f32 v41, v41
    v_exp_f32 v42, v42
    v_cvt_pk_bf16_f32 v36, v40, v41
    v_exp_f32 v43, v43
    v_exp_f32 v44, v44
    v_cvt_pk_bf16_f32 v37, v42, v43
    v_exp_f32 v45, v45
    v_exp_f32 v46, v46
    v_cvt_pk_bf16_f32 v38, v44, v45
    v_exp_f32 v47, v47
    v_mfma_f32_32x32x16_bf16 v[64:79], v[216:219], v[32:35], 0
    v_cvt_pk_bf16_f32 v39, v46, v47
    v_exp_f32 v16, v16
    v_exp_f32 v17, v17
    v_exp_f32 v18, v18
    v_mfma_f32_32x32x16_bf16 v[64:79], v[220:223], v[36:39], v[64:79]
    s_setprio 1
    s_cmp_lg_u32 s30, 4
    s_cbranch_scc1 K2_KVIN
    v_add_u32 v12, 3100672, v11
    buffer_load_dwordx4 v[248:251], v12, s[16:19], 0 offen offset:0 sc1
K2_KVIN:
    v_cvt_pk_bf16_f32 v16, v16, v17
    v_exp_f32 v19, v19
    v_exp_f32 v20, v20
    v_cvt_pk_bf16_f32 v17, v18, v19
    v_exp_f32 v21, v21
    v_mfma_f32_32x32x16_bf16 v[32:47], v[208:211], v[238:241], 0
    ds_read_b128 v[208:211], v4 offset:20480
    v_exp_f32 v22, v22
    v_cvt_pk_bf16_f32 v18, v20, v21
    v_exp_f32 v23, v23
    v_exp_f32 v24, v24
    v_cvt_pk_bf16_f32 v19, v22, v23
    v_mfma_f32_32x32x8_bf16 v[32:47], v[212:213], v[242:243], v[32:47]
    s_mov_b64 exec, s[34:35]
    ds_read_b64 v[212:213], v5 offset:21504
    s_mov_b64 exec, s[32:33]
    ds_read_b128 v[216:219], v6 offset:21760
    ds_read_b128 v[220:223], v6 offset:22400
    s_mov_b64 exec, -1
    v_exp_f32 v25, v25
    v_exp_f32 v26, v26
    v_cvt_pk_bf16_f32 v20, v24, v25
    v_exp_f32 v27, v27
    v_exp_f32 v28, v28
    v_cvt_pk_bf16_f32 v21, v26, v27
    v_exp_f32 v29, v29
    v_exp_f32 v30, v30
    v_cvt_pk_bf16_f32 v22, v28, v29
    v_exp_f32 v31, v31
    v_mfma_f32_32x32x16_bf16 v[48:63], v[224:227], v[16:19], v[48:63]
    v_cvt_pk_bf16_f32 v23, v30, v31
    v_exp_f32 v32, v32
    v_exp_f32 v33, v33
    v_exp_f32 v34, v34
    v_mfma_f32_32x32x16_bf16 v[48:63], v[228:231], v[20:23], v[48:63]
    s_setprio 0
    s_waitcnt lgkmcnt(2)
    v_cvt_pk_bf16_f32 v32, v32, v33
    v_exp_f32 v35, v35
    v_exp_f32 v36, v36
    v_cvt_pk_bf16_f32 v33, v34, v35
    v_exp_f32 v37, v37
    v_mfma_f32_32x32x16_bf16 v[16:31], v[208:211], v[232:235], 0
    v_exp_f32 v38, v38
    v_cvt_pk_bf16_f32 v34, v36, v37
    v_exp_f32 v39, v39
    v_exp_f32 v40, v40
    v_cvt_pk_bf16_f32 v35, v38, v39
    v_mfma_f32_32x32x8_bf16 v[16:31], v[212:213], v[236:237], v[16:31]
    s_waitcnt lgkmcnt(0)
    v_exp_f32 v41, v41
    v_exp_f32 v42, v42
    v_cvt_pk_bf16_f32 v36, v40, v41
    v_exp_f32 v43, v43
    v_exp_f32 v44, v44
    v_cvt_pk_bf16_f32 v37, v42, v43
    v_exp_f32 v45, v45
    v_exp_f32 v46, v46
    v_cvt_pk_bf16_f32 v38, v44, v45
    v_exp_f32 v47, v47
    v_mfma_f32_32x32x16_bf16 v[64:79], v[224:227], v[32:35], v[64:79]
    v_cvt_pk_bf16_f32 v39, v46, v47
    s_cmp_lg_u32 s30, 4
    s_cbranch_scc1 K2_KVOKN
    s_waitcnt vmcnt(0)
    v_and_b32 v248, v248, v249
    v_and_b32 v248, v248, v250
    v_and_b32 v248, v248, v251
    v_cmp_ne_u32 vcc, 1, v248
    s_cbranch_vccz K2_KVOKN
K2_KVSPN:
    s_cmp_eq_u32 s96, 0
    s_cbranch_scc1 K2_KVOKN
    s_sub_u32 s96, s96, 1
    s_sleep 12
    s_mov_b64 exec, vcc
    v_add_u32 v12, 3100672, v11
    buffer_load_dwordx4 v[248:251], v12, s[16:19], 0 offen offset:0 sc1
    s_waitcnt vmcnt(0)
    v_and_b32 v248, v248, v249
    v_and_b32 v248, v248, v250
    v_and_b32 v248, v248, v251
    v_cmp_ne_u32 vcc, 1, v248
    s_mov_b64 exec, -1
    s_cbranch_vccnz K2_KVSPN
K2_KVOKN:
    s_barrier
    v_exp_f32 v16, v16
    v_exp_f32 v17, v17
    v_exp_f32 v18, v18
    v_mfma_f32_32x32x16_bf16 v[64:79], v[228:231], v[36:39], v[64:79]
    s_setprio 3
    s_add_u32 m0, s64, 46080
    s_add_u32 s39, s66, 15360
    buffer_load_dwordx4 v11, s[16:19], s39 offen sc1 lds
    v_cvt_pk_bf16_f32 v16, v16, v17
    v_exp_f32 v19, v19
    v_exp_f32 v20, v20
    v_cvt_pk_bf16_f32 v17, v18, v19
    v_exp_f32 v21, v21
    v_mfma_f32_32x32x16_bf16 v[32:47], v[208:211], v[238:241], 0
    ds_read_b128 v[208:211], v4 offset:30720
    v_exp_f32 v22, v22
    v_cvt_pk_bf16_f32 v18, v20, v21
    v_exp_f32 v23, v23
    v_exp_f32 v24, v24
    v_cvt_pk_bf16_f32 v19, v22, v23
    v_mfma_f32_32x32x8_bf16 v[32:47], v[212:213], v[242:243], v[32:47]
    s_mov_b64 exec, s[34:35]
    ds_read_b64 v[212:213], v5 offset:31744
    s_mov_b64 exec, s[32:33]
    ds_read_b128 v[224:227], v6 offset:32000
    ds_read_b128 v[228:231], v6 offset:32640
    s_mov_b64 exec, -1
    v_exp_f32 v25, v25
    v_exp_f32 v26, v26
    v_cvt_pk_bf16_f32 v20, v24, v25
    v_exp_f32 v27, v27
    v_exp_f32 v28, v28
    v_cvt_pk_bf16_f32 v21, v26, v27
    v_exp_f32 v29, v29
    v_exp_f32 v30, v30
    v_cvt_pk_bf16_f32 v22, v28, v29
    v_exp_f32 v31, v31
    v_mfma_f32_32x32x16_bf16 v[48:63], v[216:219], v[16:19], v[48:63]
    s_add_u32 m0, s64, 46080
    s_add_u32 s39, s66, 15360
    s_mov_b64 exec, s[68:69]
    buffer_load_dwordx4 v11, s[16:19], s39 offen offset:1024 lds
    s_mov_b64 exec, -1
    s_add_u32 m0, s64, 0
    s_add_u32 s39, s66, 23040
    buffer_load_dwordx4 v11, s[16:19], s39 offen sc1 lds
    s_add_u32 m0, s64, 0
    s_add_u32 s39, s66, 23040
    s_mov_b64 exec, s[68:69]
    buffer_load_dwordx4 v11, s[16:19], s39 offen offset:1024 lds
    s_mov_b64 exec, -1
    v_cvt_pk_bf16_f32 v23, v30, v31
    v_exp_f32 v32, v32
    v_exp_f32 v33, v33
    v_exp_f32 v34, v34
    v_mfma_f32_32x32x16_bf16 v[48:63], v[220:223], v[20:23], v[48:63]
    s_waitcnt lgkmcnt(2)
    v_lshrrev_b32 v245, 2, v1
    v_lshlrev_b32 v245, 11, v245
    v_and_b32 v246, 3, v1
    v_lshl_add_u32 v245, v246, 7, v245
    s_lshl_b32 s5, s28, 3
    s_add_u32 s5, s5, s30
    s_lshl_b32 s5, s5, 15
    s_add_u32 s5, s5, 1024
    v_add_u32 v245, s5, v245
    buffer_load_dword v214, v245, s[24:27], 0 offen
    v_cvt_pk_bf16_f32 v32, v32, v33
    v_exp_f32 v35, v35
    v_exp_f32 v36, v36
    v_cvt_pk_bf16_f32 v33, v34, v35
    v_exp_f32 v37, v37
    v_mfma_f32_32x32x16_bf16 v[16:31], v[208:211], v[232:235], 0
    v_exp_f32 v38, v38
    v_cvt_pk_bf16_f32 v34, v36, v37
    v_exp_f32 v39, v39
    v_exp_f32 v40, v40
    v_cvt_pk_bf16_f32 v35, v38, v39
    v_mfma_f32_32x32x8_bf16 v[16:31], v[212:213], v[236:237], v[16:31]
    s_waitcnt lgkmcnt(0)
    v_exp_f32 v41, v41
    v_exp_f32 v42, v42
    v_cvt_pk_bf16_f32 v36, v40, v41
    v_exp_f32 v43, v43
    v_exp_f32 v44, v44
    v_cvt_pk_bf16_f32 v37, v42, v43
    v_exp_f32 v45, v45
    v_exp_f32 v46, v46
    v_cvt_pk_bf16_f32 v38, v44, v45
    v_exp_f32 v47, v47
    v_mfma_f32_32x32x16_bf16 v[64:79], v[216:219], v[32:35], v[64:79]
    v_cvt_pk_bf16_f32 v39, v46, v47
    v_exp_f32 v16, v16
    v_exp_f32 v17, v17
    v_exp_f32 v18, v18
    v_mfma_f32_32x32x16_bf16 v[64:79], v[220:223], v[36:39], v[64:79]
    s_setprio 2
    v_cvt_pk_bf16_f32 v16, v16, v17
    v_exp_f32 v19, v19
    v_exp_f32 v20, v20
    v_cvt_pk_bf16_f32 v17, v18, v19
    v_exp_f32 v21, v21
    v_mfma_f32_32x32x16_bf16 v[32:47], v[208:211], v[238:241], 0
    ds_read_b128 v[208:211], v4 offset:33280
    v_exp_f32 v22, v22
    v_cvt_pk_bf16_f32 v18, v20, v21
    v_exp_f32 v23, v23
    v_exp_f32 v24, v24
    v_cvt_pk_bf16_f32 v19, v22, v23
    v_mfma_f32_32x32x8_bf16 v[32:47], v[212:213], v[242:243], v[32:47]
    s_mov_b64 exec, s[34:35]
    ds_read_b64 v[212:213], v5 offset:34304
    s_mov_b64 exec, s[32:33]
    ds_read_b128 v[216:219], v6 offset:34560
    ds_read_b128 v[220:223], v6 offset:35200
    s_mov_b64 exec, -1
    v_exp_f32 v25, v25
    v_exp_f32 v26, v26
    v_cvt_pk_bf16_f32 v20, v24, v25
    v_exp_f32 v27, v27
    v_exp_f32 v28, v28
    v_cvt_pk_bf16_f32 v21, v26, v27
    v_exp_f32 v29, v29
    v_exp_f32 v30, v30
    v_cvt_pk_bf16_f32 v22, v28, v29
    v_exp_f32 v31, v31
    v_mfma_f32_32x32x16_bf16 v[48:63], v[224:227], v[16:19], v[48:63]
    v_cvt_pk_bf16_f32 v23, v30, v31
    v_exp_f32 v32, v32
    v_exp_f32 v33, v33
    v_exp_f32 v34, v34
    v_mfma_f32_32x32x16_bf16 v[48:63], v[228:231], v[20:23], v[48:63]
    s_setprio 1
    s_waitcnt lgkmcnt(2)
    v_cvt_pk_bf16_f32 v32, v32, v33
    v_exp_f32 v35, v35
    v_exp_f32 v36, v36
    v_cvt_pk_bf16_f32 v33, v34, v35
    v_exp_f32 v37, v37
    v_mfma_f32_32x32x16_bf16 v[16:31], v[208:211], v[232:235], 0
    v_exp_f32 v38, v38
    v_cvt_pk_bf16_f32 v34, v36, v37
    v_exp_f32 v39, v39
    v_exp_f32 v40, v40
    v_cvt_pk_bf16_f32 v35, v38, v39
    v_mfma_f32_32x32x8_bf16 v[16:31], v[212:213], v[236:237], v[16:31]
    s_waitcnt lgkmcnt(0)
    v_exp_f32 v41, v41
    v_exp_f32 v42, v42
    v_cvt_pk_bf16_f32 v36, v40, v41
    v_exp_f32 v43, v43
    v_exp_f32 v44, v44
    v_cvt_pk_bf16_f32 v37, v42, v43
    v_exp_f32 v45, v45
    v_exp_f32 v46, v46
    v_cvt_pk_bf16_f32 v38, v44, v45
    v_exp_f32 v47, v47
    v_mfma_f32_32x32x16_bf16 v[64:79], v[224:227], v[32:35], v[64:79]
    s_cmp_eq_u32 s97, 0
    s_cbranch_scc1 K2_Z1_7N
    s_add_u32 s5, s97, 7168
    buffer_store_dwordx4 v[200:203], v11, s[16:19], s5 offen sc1
K2_Z1_7N:
    v_cvt_pk_bf16_f32 v39, v46, v47
    v_exp_f32 v16, v16
    v_exp_f32 v17, v17
    v_exp_f32 v18, v18
    v_mfma_f32_32x32x16_bf16 v[64:79], v[228:231], v[36:39], v[64:79]
    s_add_u32 m0, s64, 15360
    s_add_u32 s39, s66, 30720
    buffer_load_dwordx4 v11, s[16:19], s39 offen sc1 lds
    v_cvt_pk_bf16_f32 v16, v16, v17
    v_exp_f32 v19, v19
    v_exp_f32 v20, v20
    v_cvt_pk_bf16_f32 v17, v18, v19
    v_exp_f32 v21, v21
    v_mfma_f32_32x32x16_bf16 v[32:47], v[208:211], v[238:241], 0
    ds_read_b128 v[208:211], v4 offset:35840
    v_exp_f32 v22, v22
    v_cvt_pk_bf16_f32 v18, v20, v21
    v_exp_f32 v23, v23
    v_exp_f32 v24, v24
    v_cvt_pk_bf16_f32 v19, v22, v23
    v_mfma_f32_32x32x8_bf16 v[32:47], v[212:213], v[242:243], v[32:47]
    s_mov_b64 exec, s[34:35]
    ds_read_b64 v[212:213], v5 offset:36864
    s_mov_b64 exec, s[32:33]
    ds_read_b128 v[224:227], v6 offset:37120
    ds_read_b128 v[228:231], v6 offset:37760
    s_mov_b64 exec, -1
    v_exp_f32 v25, v25
    v_exp_f32 v26, v26
    v_cvt_pk_bf16_f32 v20, v24, v25
    v_exp_f32 v27, v27
    v_exp_f32 v28, v28
    v_cvt_pk_bf16_f32 v21, v26, v27
    v_exp_f32 v29, v29
    v_exp_f32 v30, v30
    v_cvt_pk_bf16_f32 v22, v28, v29
    v_exp_f32 v31, v31
    v_mfma_f32_32x32x16_bf16 v[48:63], v[216:219], v[16:19], v[48:63]
    s_add_u32 m0, s64, 15360
    s_add_u32 s39, s66, 30720
    s_mov_b64 exec, s[68:69]
    buffer_load_dwordx4 v11, s[16:19], s39 offen offset:1024 lds
    s_mov_b64 exec, -1
    v_cvt_pk_bf16_f32 v23, v30, v31
    v_exp_f32 v32, v32
    v_exp_f32 v33, v33
    v_exp_f32 v34, v34
    v_mfma_f32_32x32x16_bf16 v[48:63], v[220:223], v[20:23], v[48:63]
    s_setprio 0
    s_waitcnt lgkmcnt(2)
    v_cvt_pk_bf16_f32 v32, v32, v33
    v_exp_f32 v35, v35
    v_exp_f32 v36, v36
    v_cvt_pk_bf16_f32 v33, v34, v35
    v_exp_f32 v37, v37
    v_mfma_f32_32x32x16_bf16 v[16:31], v[208:211], v[232:235], 0
    v_exp_f32 v38, v38
    v_cvt_pk_bf16_f32 v34, v36, v37
    v_exp_f32 v39, v39
    v_exp_f32 v40, v40
    v_cvt_pk_bf16_f32 v35, v38, v39
    v_mfma_f32_32x32x8_bf16 v[16:31], v[212:213], v[236:237], v[16:31]
    s_waitcnt lgkmcnt(0)
    v_exp_f32 v41, v41
    v_exp_f32 v42, v42
    v_cvt_pk_bf16_f32 v36, v40, v41
    v_exp_f32 v43, v43
    v_exp_f32 v44, v44
    v_cvt_pk_bf16_f32 v37, v42, v43
    v_exp_f32 v45, v45
    v_exp_f32 v46, v46
    v_cvt_pk_bf16_f32 v38, v44, v45
    v_exp_f32 v47, v47
    v_mfma_f32_32x32x16_bf16 v[64:79], v[216:219], v[32:35], v[64:79]
    v_cvt_pk_bf16_f32 v39, v46, v47
    s_waitcnt vmcnt(5)
    s_barrier
    v_exp_f32 v16, v16
    v_exp_f32 v17, v17
    v_exp_f32 v18, v18
    v_mfma_f32_32x32x16_bf16 v[64:79], v[220:223], v[36:39], v[64:79]
    s_setprio 3
    s_load_dwordx2 s[8:9], s[0:1], 32
    s_load_dwordx2 s[10:11], s[0:1], 72
    s_lshl_b32 s7, s28, 3
    s_add_u32 s7, s7, s30
    s_min_u32 s7, s7, 234
    s_mul_i32 s60, s7, 52429
    s_lshr_b32 s60, s60, 18
    s_mul_i32 s5, s60, 5
    s_sub_u32 s61, s7, s5
    v_lshrrev_b32 v160, 4, v1
    v_and_b32 v161, 15, v1
    s_lshl_b32 s5, s61, 8
    v_lshl_add_u32 v161, v161, 4, s5
    s_movk_i32 s5, 1280
    v_mad_u32_u24 v161, v160, s5, v161
    s_mul_i32 s14, s60, 40
    s_mov_b32 s15, 4
    s_mov_b32 s63, 4
    s_cmp_lt_u32 s60, 16
    s_cbranch_scc1 K2_RP1
    s_mul_i32 s14, s60, 160
    s_sub_u32 s14, s14, 2544
    s_mov_b32 s15, 20
    s_mov_b32 s63, 0
    s_cmp_lt_u32 s60, 20
    s_cbranch_scc1 K2_RP1
    s_lshl_b32 s14, s60, 5
    s_sub_u32 s14, s14, 640
    s_mov_b32 s15, 4
K2_RP1:
    s_waitcnt lgkmcnt(0)
    s_cmp_lt_u32 s60, 20
    s_cselect_b32 s20, s8, s10
    s_cselect_b32 s21, s9, s11
    s_mov_b32 s22, 1105920
    s_cselect_b32 s22, 819200, s22
    s_lshl_b32 s65, s30, 13
    s_add_u32 s65, s65, 61440
    v_bfe_u32 v162, v1, 2, 2
    v_lshl_add_u32 v162, v160, 3, v162
    v_lshlrev_b32 v162, 8, v162
    v_and_b32 v163, 3, v1
    v_lshl_add_u32 v162, v163, 3, v162
    v_add_u32 v162, s65, v162
    v_cvt_pk_bf16_f32 v16, v16, v17
    v_exp_f32 v19, v19
    v_exp_f32 v20, v20
    v_cvt_pk_bf16_f32 v17, v18, v19
    v_exp_f32 v21, v21
    v_mfma_f32_32x32x16_bf16 v[32:47], v[208:211], v[238:241], 0
    ds_read_b128 v[208:211], v4 offset:46080
    v_exp_f32 v22, v22
    v_cvt_pk_bf16_f32 v18, v20, v21
    v_exp_f32 v23, v23
    v_exp_f32 v24, v24
    v_cvt_pk_bf16_f32 v19, v22, v23
    v_mfma_f32_32x32x8_bf16 v[32:47], v[212:213], v[242:243], v[32:47]
    s_mov_b64 exec, s[34:35]
    ds_read_b64 v[212:213], v5 offset:47104
    s_mov_b64 exec, s[32:33]
    ds_read_b128 v[216:219], v6 offset:47360
    ds_read_b128 v[220:223], v6 offset:48000
    s_mov_b64 exec, -1
    v_exp_f32 v25, v25
    v_exp_f32 v26, v26
    v_cvt_pk_bf16_f32 v20, v24, v25
    v_exp_f32 v27, v27
    v_exp_f32 v28, v28
    v_cvt_pk_bf16_f32 v21, v26, v27
    v_exp_f32 v29, v29
    v_exp_f32 v30, v30
    v_cvt_pk_bf16_f32 v22, v28, v29
    v_exp_f32 v31, v31
    v_mfma_f32_32x32x16_bf16 v[48:63], v[224:227], v[16:19], v[48:63]
    s_cmp_eq_u32 s97, 0
    s_cbranch_scc1 K2_Z1_8N
    s_add_u32 s5, s97, 8192
    buffer_store_dwordx4 v[204:207], v11, s[16:19], s5 offen sc1
K2_Z1_8N:
    v_cvt_pk_bf16_f32 v23, v30, v31
    v_exp_f32 v32, v32
    v_exp_f32 v33, v33
    v_exp_f32 v34, v34
    v_mfma_f32_32x32x16_bf16 v[48:63], v[228:231], v[20:23], v[48:63]
    s_setprio 2
    s_waitcnt lgkmcnt(2)
    s_mul_i32 s5, s15, 0
    s_add_u32 s5, s5, s14
    s_mul_i32 s5, s5, 1280
    v_add_u32 v164, s5, v161
    s_add_u32 m0, s65, 0
    s_nop 0
    buffer_load_dwordx4 v164, s[20:23], 0 offen lds
    v_cvt_pk_bf16_f32 v32, v32, v33
    v_exp_f32 v35, v35
    v_exp_f32 v36, v36
    v_cvt_pk_bf16_f32 v33, v34, v35
    v_exp_f32 v37, v37
    v_mfma_f32_32x32x16_bf16 v[16:31], v[208:211], v[232:235], 0
    s_mul_i32 s5, s15, 1
    s_add_u32 s5, s5, s14
    s_mul_i32 s5, s5, 1280
    v_add_u32 v164, s5, v161
    s_add_u32 m0, s65, 1024
    s_nop 0
    buffer_load_dwordx4 v164, s[20:23], 0 offen lds
    v_exp_f32 v38, v38
    v_cvt_pk_bf16_f32 v34, v36, v37
    v_exp_f32 v39, v39
    v_exp_f32 v40, v40
    v_cvt_pk_bf16_f32 v35, v38, v39
    v_mfma_f32_32x32x8_bf16 v[16:31], v[212:213], v[236:237], v[16:31]
    s_waitcnt lgkmcnt(0)
    v_exp_f32 v41, v41
    v_exp_f32 v42, v42
    v_cvt_pk_bf16_f32 v36, v40, v41
    v_exp_f32 v43, v43
    v_exp_f32 v44, v44
    v_cvt_pk_bf16_f32 v37, v42, v43
    v_exp_f32 v45, v45
    v_exp_f32 v46, v46
    v_cvt_pk_bf16_f32 v38, v44, v45
    v_exp_f32 v47, v47
    v_mfma_f32_32x32x16_bf16 v[64:79], v[224:227], v[32:35], v[64:79]
    v_cvt_pk_bf16_f32 v39, v46, v47
    v_exp_f32 v16, v16
    v_exp_f32 v17, v17
    v_exp_f32 v18, v18
    v_mfma_f32_32x32x16_bf16 v[64:79], v[228:231], v[36:39], v[64:79]
    s_setprio 1
    s_mul_i32 s5, s15, 2
    s_add_u32 s5, s5, s14
    s_mul_i32 s5, s5, 1280
    v_add_u32 v164, s5, v161
    s_add_u32 m0, s65, 2048
    s_nop 0
    buffer_load_dwordx4 v164, s[20:23], 0 offen lds
    v_cvt_pk_bf16_f32 v16, v16, v17
    v_exp_f32 v19, v19
    v_exp_f32 v20, v20
    v_cvt_pk_bf16_f32 v17, v18, v19
    v_exp_f32 v21, v21
    v_mfma_f32_32x32x16_bf16 v[32:47], v[208:211], v[238:241], 0
    ds_read_b128 v[208:211], v4 offset:48640
    v_exp_f32 v22, v22
    v_cvt_pk_bf16_f32 v18, v20, v21
    v_exp_f32 v23, v23
    v_exp_f32 v24, v24
    v_cvt_pk_bf16_f32 v19, v22, v23
    v_mfma_f32_32x32x8_bf16 v[32:47], v[212:213], v[242:243], v[32:47]
    s_mov_b64 exec, s[34:35]
    ds_read_b64 v[212:213], v5 offset:49664
    s_mov_b64 exec, s[32:33]
    ds_read_b128 v[224:227], v6 offset:49920
    ds_read_b128 v[228:231], v6 offset:50560
    s_mov_b64 exec, -1
    v_exp_f32 v25, v25
    v_exp_f32 v26, v26
    v_cvt_pk_bf16_f32 v20, v24, v25
    v_exp_f32 v27, v27
    v_exp_f32 v28, v28
    v_cvt_pk_bf16_f32 v21, v26, v27
    v_exp_f32 v29, v29
    v_exp_f32 v30, v30
    v_cvt_pk_bf16_f32 v22, v28, v29
    v_exp_f32 v31, v31
    v_mfma_f32_32x32x16_bf16 v[48:63], v[216:219], v[16:19], v[48:63]
    s_mul_i32 s5, s15, 3
    s_add_u32 s5, s5, s14
    s_mul_i32 s5, s5, 1280
    v_add_u32 v164, s5, v161
    s_add_u32 m0, s65, 3072
    s_nop 0
    buffer_load_dwordx4 v164, s[20:23], 0 offen lds
    v_cvt_pk_bf16_f32 v23, v30, v31
    v_exp_f32 v32, v32
    v_exp_f32 v33, v33
    v_exp_f32 v34, v34
    v_mfma_f32_32x32x16_bf16 v[48:63], v[220:223], v[20:23], v[48:63]
    s_setprio 0
    s_waitcnt lgkmcnt(2)
    s_add_u32 m0, s64, 30720
    s_add_u32 s39, s66, 38400
    buffer_load_dwordx4 v11, s[16:19], s39 offen sc1 lds
    v_cvt_pk_bf16_f32 v32, v32, v33
    v_exp_f32 v35, v35
    v_exp_f32 v36, v36
    v_cvt_pk_bf16_f32 v33, v34, v35
    v_exp_f32 v37, v37
    v_mfma_f32_32x32x16_bf16 v[16:31], v[208:211], v[232:235], 0
    s_add_u32 m0, s64, 30720
    s_add_u32 s39, s66, 38400
    s_mov_b64 exec, s[68:69]
    buffer_load_dwordx4 v11, s[16:19], s39 offen offset:1024 lds
    s_mov_b64 exec, -1
    v_exp_f32 v38, v38
    v_cvt_pk_bf16_f32 v34, v36, v37
    v_exp_f32 v39, v39
    v_exp_f32 v40, v40
    v_cvt_pk_bf16_f32 v35, v38, v39
    v_mfma_f32_32x32x8_bf16 v[16:31], v[212:213], v[236:237], v[16:31]
    s_waitcnt lgkmcnt(0)
    s_mul_i32 s5, s15, 4
    s_add_u32 s5, s5, s14
    s_add_u32 s5, s5, s63
    s_mul_i32 s5, s5, 1280
    v_add_u32 v164, s5, v161
    s_add_u32 m0, s65, 4096
    s_nop 0
    buffer_load_dwordx4 v164, s[20:23], 0 offen lds
    v_exp_f32 v41, v41
    v_exp_f32 v42, v42
    v_cvt_pk_bf16_f32 v36, v40, v41
    v_exp_f32 v43, v43
    v_exp_f32 v44, v44
    v_cvt_pk_bf16_f32 v37, v42, v43
    v_exp_f32 v45, v45
    v_exp_f32 v46, v46
    v_cvt_pk_bf16_f32 v38, v44, v45
    v_exp_f32 v47, v47
    v_mfma_f32_32x32x16_bf16 v[64:79], v[216:219], v[32:35], v[64:79]
    s_mul_i32 s5, s15, 5
    s_add_u32 s5, s5, s14
    s_add_u32 s5, s5, s63
    s_mul_i32 s5, s5, 1280
    v_add_u32 v164, s5, v161
    s_add_u32 m0, s65, 5120
    s_nop 0
    buffer_load_dwordx4 v164, s[20:23], 0 offen lds
    s_cmp_eq_u32 s97, 0
    s_cbranch_scc1 K2_Z1_0N
    s_add_u32 s5, s97, 0
    buffer_store_dwordx4 v[128:131], v11, s[16:19], s5 offen sc1
K2_Z1_0N:
    v_cvt_pk_bf16_f32 v39, v46, v47
    s_waitcnt vmcnt(11)
    s_barrier
    v_exp_f32 v16, v16
    v_exp_f32 v17, v17
    v_exp_f32 v18, v18
    v_mfma_f32_32x32x16_bf16 v[64:79], v[220:223], v[36:39], v[64:79]
    s_setprio 3
    s_mul_i32 s5, s15, 6
    s_add_u32 s5, s5, s14
    s_add_u32 s5, s5, s63
    s_mul_i32 s5, s5, 1280
    v_add_u32 v164, s5, v161
    s_add_u32 m0, s65, 6144
    s_nop 0
    buffer_load_dwordx4 v164, s[20:23], 0 offen lds
    v_cvt_pk_bf16_f32 v16, v16, v17
    v_exp_f32 v19, v19
    v_exp_f32 v20, v20
    v_cvt_pk_bf16_f32 v17, v18, v19
    v_exp_f32 v21, v21
    v_mfma_f32_32x32x16_bf16 v[32:47], v[208:211], v[238:241], 0
    ds_read_b128 v[208:211], v4 offset:51200
    v_exp_f32 v22, v22
    v_cvt_pk_bf16_f32 v18, v20, v21
    v_exp_f32 v23, v23
    v_exp_f32 v24, v24
    v_cvt_pk_bf16_f32 v19, v22, v23
    v_mfma_f32_32x32x8_bf16 v[32:47], v[212:213], v[242:243], v[32:47]
    s_mov_b64 exec, s[34:35]
    ds_read_b64 v[212:213], v5 offset:52224
    s_mov_b64 exec, s[32:33]
    ds_read_b128 v[216:219], v6 offset:52480
    ds_read_b128 v[220:223], v6 offset:53120
    s_mov_b64 exec, -1
    v_exp_f32 v25, v25
    v_exp_f32 v26, v26
    v_cvt_pk_bf16_f32 v20, v24, v25
    v_exp_f32 v27, v27
    v_exp_f32 v28, v28
    v_cvt_pk_bf16_f32 v21, v26, v27
    v_exp_f32 v29, v29
    v_exp_f32 v30, v30
    v_cvt_pk_bf16_f32 v22, v28, v29
    v_exp_f32 v31, v31
    v_mfma_f32_32x32x16_bf16 v[48:63], v[224:227], v[16:19], v[48:63]
    s_mul_i32 s5, s15, 7
    s_add_u32 s5, s5, s14
    s_add_u32 s5, s5, s63
    s_mul_i32 s5, s5, 1280
    v_add_u32 v164, s5, v161
    s_add_u32 m0, s65, 7168
    s_nop 0
    buffer_load_dwordx4 v164, s[20:23], 0 offen lds
    v_cvt_pk_bf16_f32 v23, v30, v31
    v_exp_f32 v32, v32
    v_exp_f32 v33, v33
    v_exp_f32 v34, v34
    v_mfma_f32_32x32x16_bf16 v[48:63], v[228:231], v[20:23], v[48:63]
    s_waitcnt lgkmcnt(2)
    v_cvt_pk_bf16_f32 v32, v32, v33
    v_exp_f32 v35, v35
    v_exp_f32 v36, v36
    v_cvt_pk_bf16_f32 v33, v34, v35
    v_exp_f32 v37, v37
    v_mfma_f32_32x32x16_bf16 v[16:31], v[208:211], v[232:235], 0
    v_exp_f32 v38, v38
    v_cvt_pk_bf16_f32 v34, v36, v37
    v_exp_f32 v39, v39
    v_exp_f32 v40, v40
    v_cvt_pk_bf16_f32 v35, v38, v39
    v_mfma_f32_32x32x8_bf16 v[16:31], v[212:213], v[236:237], v[16:31]
    s_waitcnt lgkmcnt(0)
    v_exp_f32 v41, v41
    v_exp_f32 v42, v42
    v_cvt_pk_bf16_f32 v36, v40, v41
    v_exp_f32 v43, v43
    v_exp_f32 v44, v44
    v_cvt_pk_bf16_f32 v37, v42, v43
    v_exp_f32 v45, v45
    v_exp_f32 v46, v46
    v_cvt_pk_bf16_f32 v38, v44, v45
    v_exp_f32 v47, v47
    v_mfma_f32_32x32x16_bf16 v[64:79], v[224:227], v[32:35], v[64:79]
    v_cvt_pk_bf16_f32 v39, v46, v47
    v_exp_f32 v16, v16
    v_exp_f32 v17, v17
    v_exp_f32 v18, v18
    v_mfma_f32_32x32x16_bf16 v[64:79], v[228:231], v[36:39], v[64:79]
    s_setprio 2
    v_cvt_pk_bf16_f32 v16, v16, v17
    v_exp_f32 v19, v19
    v_exp_f32 v20, v20
    v_cvt_pk_bf16_f32 v17, v18, v19
    v_exp_f32 v21, v21
    v_mfma_f32_32x32x16_bf16 v[32:47], v[208:211], v[238:241], 0
    ds_read_b128 v[208:211], v4 offset:0
    v_exp_f32 v22, v22
    v_cvt_pk_bf16_f32 v18, v20, v21
    v_exp_f32 v23, v23
    v_exp_f32 v24, v24
    v_cvt_pk_bf16_f32 v19, v22, v23
    v_mfma_f32_32x32x8_bf16 v[32:47], v[212:213], v[242:243], v[32:47]
    s_mov_b64 exec, s[34:35]
    ds_read_b64 v[212:213], v5 offset:1024
    s_mov_b64 exec, s[32:33]
    ds_read_b128 v[224:227], v6 offset:1280
    ds_read_b128 v[228:231], v6 offset:1920
    s_mov_b64 exec, -1
    v_exp_f32 v25, v25
    v_exp_f32 v26, v26
    v_cvt_pk_bf16_f32 v20, v24, v25
    v_exp_f32 v27, v27
    v_exp_f32 v28, v28
    v_cvt_pk_bf16_f32 v21, v26, v27
    v_exp_f32 v29, v29
    v_exp_f32 v30, v30
    v_cvt_pk_bf16_f32 v22, v28, v29
    v_exp_f32 v31, v31
    v_mfma_f32_32x32x16_bf16 v[48:63], v[216:219], v[16:19], v[48:63]
    s_cmp_eq_u32 s97, 0
    s_cbranch_scc1 K2_Z1_1N
    s_add_u32 s5, s97, 1024
    buffer_store_dwordx4 v[132:135], v11, s[16:19], s5 offen sc1
K2_Z1_1N:
    v_cvt_pk_bf16_f32 v23, v30, v31
    v_exp_f32 v32, v32
    v_exp_f32 v33, v33
    v_exp_f32 v34, v34
    v_mfma_f32_32x32x16_bf16 v[48:63], v[220:223], v[20:23], v[48:63]
    s_setprio 1
    s_waitcnt lgkmcnt(2)
    v_cvt_pk_bf16_f32 v32, v32, v33
    v_exp_f32 v35, v35
    v_exp_f32 v36, v36
    v_cvt_pk_bf16_f32 v33, v34, v35
    v_exp_f32 v37, v37
    v_mfma_f32_32x32x16_bf16 v[16:31], v[208:211], v[232:235], 0
    v_exp_f32 v38, v38
    v_cvt_pk_bf16_f32 v34, v36, v37
    v_exp_f32 v39, v39
    v_exp_f32 v40, v40
    v_cvt_pk_bf16_f32 v35, v38, v39
    v_mfma_f32_32x32x8_bf16 v[16:31], v[212:213], v[236:237], v[16:31]
    s_waitcnt lgkmcnt(0)
    v_exp_f32 v41, v41
    v_exp_f32 v42, v42
    v_cvt_pk_bf16_f32 v36, v40, v41
    v_exp_f32 v43, v43
    v_exp_f32 v44, v44
    v_cvt_pk_bf16_f32 v37, v42, v43
    v_exp_f32 v45, v45
    v_exp_f32 v46, v46
    v_cvt_pk_bf16_f32 v38, v44, v45
    v_exp_f32 v47, v47
    v_mfma_f32_32x32x16_bf16 v[64:79], v[216:219], v[32:35], v[64:79]
    v_cvt_pk_bf16_f32 v39, v46, v47
    v_exp_f32 v16, v16
    v_exp_f32 v17, v17
    v_exp_f32 v18, v18
    v_mfma_f32_32x32x16_bf16 v[64:79], v[220:223], v[36:39], v[64:79]
    s_setprio 0
    v_cvt_pk_bf16_f32 v16, v16, v17
    v_exp_f32 v19, v19
    v_exp_f32 v20, v20
    v_cvt_pk_bf16_f32 v17, v18, v19
    v_exp_f32 v21, v21
    v_mfma_f32_32x32x16_bf16 v[32:47], v[208:211], v[238:241], 0
    ds_read_b128 v[208:211], v4 offset:2560
    v_exp_f32 v22, v22
    v_cvt_pk_bf16_f32 v18, v20, v21
    v_exp_f32 v23, v23
    v_exp_f32 v24, v24
    v_cvt_pk_bf16_f32 v19, v22, v23
    v_mfma_f32_32x32x8_bf16 v[32:47], v[212:213], v[242:243], v[32:47]
    s_mov_b64 exec, s[34:35]
    ds_read_b64 v[212:213], v5 offset:3584
    s_mov_b64 exec, s[32:33]
    ds_read_b128 v[216:219], v6 offset:3840
    ds_read_b128 v[220:223], v6 offset:4480
    s_mov_b64 exec, -1
    v_exp_f32 v25, v25
    v_exp_f32 v26, v26
    v_cvt_pk_bf16_f32 v20, v24, v25
    v_exp_f32 v27, v27
    v_exp_f32 v28, v28
    v_cvt_pk_bf16_f32 v21, v26, v27
    v_exp_f32 v29, v29
    v_exp_f32 v30, v30
    v_cvt_pk_bf16_f32 v22, v28, v29
    v_exp_f32 v31, v31
    v_mfma_f32_32x32x16_bf16 v[48:63], v[224:227], v[16:19], v[48:63]
    v_cvt_pk_bf16_f32 v23, v30, v31
    s_waitcnt vmcnt(10) lgkmcnt(0)
    s_barrier
    v_exp_f32 v32, v32
    v_exp_f32 v33, v33
    v_exp_f32 v34, v34
    v_mfma_f32_32x32x16_bf16 v[48:63], v[228:231], v[20:23], v[48:63]
    s_setprio 3
    v_cvt_pk_bf16_f32 v32, v32, v33
    v_exp_f32 v35, v35
    v_exp_f32 v36, v36
    v_cvt_pk_bf16_f32 v33, v34, v35
    v_exp_f32 v37, v37
    v_mfma_f32_32x32x16_bf16 v[16:31], v[208:211], v[232:235], 0
    v_exp_f32 v38, v38
    v_cvt_pk_bf16_f32 v34, v36, v37
    v_exp_f32 v39, v39
    v_exp_f32 v40, v40
    v_cvt_pk_bf16_f32 v35, v38, v39
    v_mfma_f32_32x32x8_bf16 v[16:31], v[212:213], v[236:237], v[16:31]
    v_exp_f32 v41, v41
    v_exp_f32 v42, v42
    v_cvt_pk_bf16_f32 v36, v40, v41
    v_exp_f32 v43, v43
    v_exp_f32 v44, v44
    v_cvt_pk_bf16_f32 v37, v42, v43
    v_exp_f32 v45, v45
    v_exp_f32 v46, v46
    v_cvt_pk_bf16_f32 v38, v44, v45
    v_exp_f32 v47, v47
    v_mfma_f32_32x32x16_bf16 v[64:79], v[224:227], v[32:35], v[64:79]
    s_cmp_eq_u32 s97, 0
    s_cbranch_scc1 K2_Z1_2N
    s_add_u32 s5, s97, 2048
    buffer_store_dwordx4 v[136:139], v11, s[16:19], s5 offen sc1
K2_Z1_2N:
    v_cvt_pk_bf16_f32 v39, v46, v47
    v_exp_f32 v16, v16
    v_exp_f32 v17, v17
    v_exp_f32 v18, v18
    v_mfma_f32_32x32x16_bf16 v[64:79], v[228:231], v[36:39], v[64:79]
    v_lshrrev_b32 v245, 2, v1
    v_lshlrev_b32 v245, 11, v245
    v_and_b32 v246, 3, v1
    v_lshl_add_u32 v245, v246, 7, v245
    s_lshl_b32 s5, s28, 3
    s_add_u32 s5, s5, s30
    s_lshl_b32 s5, s5, 15
    s_add_u32 s5, s5, 1536
    v_add_u32 v245, s5, v245
    buffer_load_dword v214, v245, s[24:27], 0 offen
    v_cvt_pk_bf16_f32 v16, v16, v17
    v_exp_f32 v19, v19
    v_exp_f32 v20, v20
    v_cvt_pk_bf16_f32 v17, v18, v19
    v_exp_f32 v21, v21
    v_mfma_f32_32x32x16_bf16 v[32:47], v[208:211], v[238:241], 0
    ds_read_b128 v[208:211], v4 offset:5120
    v_exp_f32 v22, v22
    v_cvt_pk_bf16_f32 v18, v20, v21
    v_exp_f32 v23, v23
    v_exp_f32 v24, v24
    v_cvt_pk_bf16_f32 v19, v22, v23
    v_mfma_f32_32x32x8_bf16 v[32:47], v[212:213], v[242:243], v[32:47]
    s_mov_b64 exec, s[34:35]
    ds_read_b64 v[212:213], v5 offset:6144
    s_mov_b64 exec, s[32:33]
    ds_read_b128 v[224:227], v6 offset:6400
    ds_read_b128 v[228:231], v6 offset:7040
    s_mov_b64 exec, -1
    v_exp_f32 v25, v25
    v_exp_f32 v26, v26
    v_cvt_pk_bf16_f32 v20, v24, v25
    v_exp_f32 v27, v27
    v_exp_f32 v28, v28
    v_cvt_pk_bf16_f32 v21, v26, v27
    v_exp_f32 v29, v29
    v_exp_f32 v30, v30
    v_cvt_pk_bf16_f32 v22, v28, v29
    v_exp_f32 v31, v31
    v_mfma_f32_32x32x16_bf16 v[48:63], v[216:219], v[16:19], v[48:63]
    v_cvt_pk_bf16_f32 v23, v30, v31
    v_exp_f32 v32, v32
    v_exp_f32 v33, v33
    v_exp_f32 v34, v34
    v_mfma_f32_32x32x16_bf16 v[48:63], v[220:223], v[20:23], v[48:63]
    s_setprio 2
    s_waitcnt lgkmcnt(2)
    s_waitcnt vmcnt(1)
    ds_read_b64_tr_b16 v[80:81], v162 offset:0
    ds_read_b64_tr_b16 v[82:83], v162 offset:1024
    v_cvt_pk_bf16_f32 v32, v32, v33
    v_exp_f32 v35, v35
    v_exp_f32 v36, v36
    v_cvt_pk_bf16_f32 v33, v34, v35
    v_exp_f32 v37, v37
    v_mfma_f32_32x32x16_bf16 v[16:31], v[208:211], v[232:235], 0
    ds_read_b64_tr_b16 v[84:85], v162 offset:32
    ds_read_b64_tr_b16 v[86:87], v162 offset:1056
    v_exp_f32 v38, v38
    v_cvt_pk_bf16_f32 v34, v36, v37
    v_exp_f32 v39, v39
    v_exp_f32 v40, v40
    v_cvt_pk_bf16_f32 v35, v38, v39
    v_mfma_f32_32x32x8_bf16 v[16:31], v[212:213], v[236:237], v[16:31]
    s_waitcnt lgkmcnt(4)
    ds_read_b64_tr_b16 v[88:89], v162 offset:64
    ds_read_b64_tr_b16 v[90:91], v162 offset:1088
    v_exp_f32 v41, v41
    v_exp_f32 v42, v42
    v_cvt_pk_bf16_f32 v36, v40, v41
    v_exp_f32 v43, v43
    v_exp_f32 v44, v44
    v_cvt_pk_bf16_f32 v37, v42, v43
    v_exp_f32 v45, v45
    v_exp_f32 v46, v46
    v_cvt_pk_bf16_f32 v38, v44, v45
    v_exp_f32 v47, v47
    v_mfma_f32_32x32x16_bf16 v[64:79], v[216:219], v[32:35], v[64:79]
    ds_read_b64_tr_b16 v[92:93], v162 offset:96
    ds_read_b64_tr_b16 v[94:95], v162 offset:1120
    v_cvt_pk_bf16_f32 v39, v46, v47
    v_exp_f32 v16, v16
    v_exp_f32 v17, v17
    v_exp_f32 v18, v18
    v_mfma_f32_32x32x16_bf16 v[64:79], v[220:223], v[36:39], v[64:79]
    s_setprio 1
    s_waitcnt lgkmcnt(6)
    s_lshl_b32 s5, s61, 3
    s_add_u32 s5, s5, 0
    s_mul_i32 s6, s5, 52429
    s_lshr_b32 s6, s6, 18
    s_mul_i32 s6, s6, 240640
    s_lshl_b32 s5, s5, 10
    s_add_u32 s5, s5, s6
    s_mul_i32 s6, s60, 5120
    s_add_u32 s5, s5, s6
    s_add_u32 s5, s5, 16777216
    buffer_store_dwordx4 v[80:83], v11, s[16:19], s5 offen sc1
    v_cvt_pk_bf16_f32 v16, v16, v17
    v_exp_f32 v19, v19
    v_exp_f32 v20, v20
    v_cvt_pk_bf16_f32 v17, v18, v19
    v_exp_f32 v21, v21
    v_mfma_f32_32x32x16_bf16 v[32:47], v[208:211], v[238:241], 0
    ds_read_b128 v[208:211], v4 offset:15360
    v_exp_f32 v22, v22
    v_cvt_pk_bf16_f32 v18, v20, v21
    v_exp_f32 v23, v23
    v_exp_f32 v24, v24
    v_cvt_pk_bf16_f32 v19, v22, v23
    v_mfma_f32_32x32x8_bf16 v[32:47], v[212:213], v[242:243], v[32:47]
    s_mov_b64 exec, s[34:35]
    ds_read_b64 v[212:213], v5 offset:16384
    s_mov_b64 exec, s[32:33]
    ds_read_b128 v[216:219], v6 offset:16640
    ds_read_b128 v[220:223], v6 offset:17280
    s_mov_b64 exec, -1
    v_exp_f32 v25, v25
    v_exp_f32 v26, v26
    v_cvt_pk_bf16_f32 v20, v24, v25
    v_exp_f32 v27, v27
    v_exp_f32 v28, v28
    v_cvt_pk_bf16_f32 v21, v26, v27
    v_exp_f32 v29, v29
    v_exp_f32 v30, v30
    v_cvt_pk_bf16_f32 v22, v28, v29
    v_exp_f32 v31, v31
    v_mfma_f32_32x32x16_bf16 v[48:63], v[224:227], v[16:19], v[48:63]
    s_waitcnt lgkmcnt(8)
    s_lshl_b32 s5, s61, 3
    s_add_u32 s5, s5, 1
    s_mul_i32 s6, s5, 52429
    s_lshr_b32 s6, s6, 18
    s_mul_i32 s6, s6, 240640
    s_lshl_b32 s5, s5, 10
    s_add_u32 s5, s5, s6
    s_mul_i32 s6, s60, 5120
    s_add_u32 s5, s5, s6
    s_add_u32 s5, s5, 16777216
    buffer_store_dwordx4 v[84:87], v11, s[16:19], s5 offen sc1
    s_waitcnt lgkmcnt(6)
    s_lshl_b32 s5, s61, 3
    s_add_u32 s5, s5, 2
    s_mul_i32 s6, s5, 52429
    s_lshr_b32 s6, s6, 18
    s_mul_i32 s6, s6, 240640
    s_lshl_b32 s5, s5, 10
    s_add_u32 s5, s5, s6
    s_mul_i32 s6, s60, 5120
    s_add_u32 s5, s5, s6
    s_add_u32 s5, s5, 16777216
    buffer_store_dwordx4 v[88:91], v11, s[16:19], s5 offen sc1
    s_waitcnt lgkmcnt(4)
    s_lshl_b32 s5, s61, 3
    s_add_u32 s5, s5, 3
    s_mul_i32 s6, s5, 52429
    s_lshr_b32 s6, s6, 18
    s_mul_i32 s6, s6, 240640
    s_lshl_b32 s5, s5, 10
    s_add_u32 s5, s5, s6
    s_mul_i32 s6, s60, 5120
    s_add_u32 s5, s5, s6
    s_add_u32 s5, s5, 16777216
    buffer_store_dwordx4 v[92:95], v11, s[16:19], s5 offen sc1
    ds_read_b64_tr_b16 v[96:97], v162 offset:128
    ds_read_b64_tr_b16 v[98:99], v162 offset:1152
    ds_read_b64_tr_b16 v[100:101], v162 offset:160
    ds_read_b64_tr_b16 v[102:103], v162 offset:1184
    ds_read_b64_tr_b16 v[104:105], v162 offset:192
    ds_read_b64_tr_b16 v[106:107], v162 offset:1216
    ds_read_b64_tr_b16 v[108:109], v162 offset:224
    ds_read_b64_tr_b16 v[110:111], v162 offset:1248
    s_cmp_eq_u32 s97, 0
    s_cbranch_scc1 K2_Z1_3N
    s_add_u32 s5, s97, 3072
    buffer_store_dwordx4 v[140:143], v11, s[16:19], s5 offen sc1
K2_Z1_3N:
    v_cvt_pk_bf16_f32 v23, v30, v31
    v_exp_f32 v32, v32
    v_exp_f32 v33, v33
    v_exp_f32 v34, v34
    v_mfma_f32_32x32x16_bf16 v[48:63], v[228:231], v[20:23], v[48:63]
    s_setprio 0
    s_waitcnt lgkmcnt(10)
    s_add_u32 m0, s64, 46080
    s_add_u32 s39, s66, 46080
    buffer_load_dwordx4 v11, s[16:19], s39 offen sc1 lds
    v_cvt_pk_bf16_f32 v32, v32, v33
    v_exp_f32 v35, v35
    v_exp_f32 v36, v36
    v_cvt_pk_bf16_f32 v33, v34, v35
    v_exp_f32 v37, v37
    v_mfma_f32_32x32x16_bf16 v[16:31], v[208:211], v[232:235], 0
    s_add_u32 m0, s64, 46080
    s_add_u32 s39, s66, 46080
    s_mov_b64 exec, s[68:69]
    buffer_load_dwordx4 v11, s[16:19], s39 offen offset:1024 lds
    s_mov_b64 exec, -1
    v_exp_f32 v38, v38
    v_cvt_pk_bf16_f32 v34, v36, v37
    v_exp_f32 v39, v39
    v_exp_f32 v40, v40
    v_cvt_pk_bf16_f32 v35, v38, v39
    v_mfma_f32_32x32x8_bf16 v[16:31], v[212:213], v[236:237], v[16:31]
    s_waitcnt lgkmcnt(8)
    s_waitcnt lgkmcnt(6)
    s_lshl_b32 s5, s61, 3
    s_add_u32 s5, s5, 4
    s_mul_i32 s6, s5, 52429
    s_lshr_b32 s6, s6, 18
    s_mul_i32 s6, s6, 240640
    s_lshl_b32 s5, s5, 10
    s_add_u32 s5, s5, s6
    s_mul_i32 s6, s60, 5120
    s_add_u32 s5, s5, s6
    s_add_u32 s5, s5, 16777216
    buffer_store_dwordx4 v[96:99], v11, s[16:19], s5 offen sc1
    v_exp_f32 v41, v41
    v_exp_f32 v42, v42
    v_cvt_pk_bf16_f32 v36, v40, v41
    v_exp_f32 v43, v43
    v_exp_f32 v44, v44
    v_cvt_pk_bf16_f32 v37, v42, v43
    v_exp_f32 v45, v45
    v_exp_f32 v46, v46
    v_cvt_pk_bf16_f32 v38, v44, v45
    v_exp_f32 v47, v47
    v_mfma_f32_32x32x16_bf16 v[64:79], v[224:227], v[32:35], v[64:79]
    s_waitcnt lgkmcnt(4)
    s_lshl_b32 s5, s61, 3
    s_add_u32 s5, s5, 5
    s_mul_i32 s6, s5, 52429
    s_lshr_b32 s6, s6, 18
    s_mul_i32 s6, s6, 240640
    s_lshl_b32 s5, s5, 10
    s_add_u32 s5, s5, s6
    s_mul_i32 s6, s60, 5120
    s_add_u32 s5, s5, s6
    s_add_u32 s5, s5, 16777216
    buffer_store_dwordx4 v[100:103], v11, s[16:19], s5 offen sc1
    s_waitcnt lgkmcnt(2)
    s_lshl_b32 s5, s61, 3
    s_add_u32 s5, s5, 6
    s_mul_i32 s6, s5, 52429
    s_lshr_b32 s6, s6, 18
    s_mul_i32 s6, s6, 240640
    s_lshl_b32 s5, s5, 10
    s_add_u32 s5, s5, s6
    s_mul_i32 s6, s60, 5120
    s_add_u32 s5, s5, s6
    s_add_u32 s5, s5, 16777216
    buffer_store_dwordx4 v[104:107], v11, s[16:19], s5 offen sc1
    s_waitcnt lgkmcnt(0)
    s_lshl_b32 s5, s61, 3
    s_add_u32 s5, s5, 7
    s_mul_i32 s6, s5, 52429
    s_lshr_b32 s6, s6, 18
    s_mul_i32 s6, s6, 240640
    s_lshl_b32 s5, s5, 10
    s_add_u32 s5, s5, s6
    s_mul_i32 s6, s60, 5120
    s_add_u32 s5, s5, s6
    s_add_u32 s5, s5, 16777216
    buffer_store_dwordx4 v[108:111], v11, s[16:19], s5 offen sc1
    v_cvt_pk_bf16_f32 v39, v46, v47
    s_barrier
    v_exp_f32 v16, v16
    v_exp_f32 v17, v17
    v_exp_f32 v18, v18
    v_mfma_f32_32x32x16_bf16 v[64:79], v[228:231], v[36:39], v[64:79]
    s_setprio 3
    v_cvt_pk_bf16_f32 v16, v16, v17
    v_exp_f32 v19, v19
    v_exp_f32 v20, v20
    v_cvt_pk_bf16_f32 v17, v18, v19
    v_exp_f32 v21, v21
    v_mfma_f32_32x32x16_bf16 v[32:47], v[208:211], v[238:241], 0
    ds_read_b128 v[208:211], v4 offset:17920
    v_exp_f32 v22, v22
    v_cvt_pk_bf16_f32 v18, v20, v21
    v_exp_f32 v23, v23
    v_exp_f32 v24, v24
    v_cvt_pk_bf16_f32 v19, v22, v23
    v_mfma_f32_32x32x8_bf16 v[32:47], v[212:213], v[242:243], v[32:47]
    s_mov_b64 exec, s[34:35]
    ds_read_b64 v[212:213], v5 offset:18944
    s_mov_b64 exec, s[32:33]
    ds_read_b128 v[224:227], v6 offset:19200
    ds_read_b128 v[228:231], v6 offset:19840
    s_mov_b64 exec, -1
    v_exp_f32 v25, v25
    v_exp_f32 v26, v26
    v_cvt_pk_bf16_f32 v20, v24, v25
    v_exp_f32 v27, v27
    v_exp_f32 v28, v28
    v_cvt_pk_bf16_f32 v21, v26, v27
    v_exp_f32 v29, v29
    v_exp_f32 v30, v30
    v_cvt_pk_bf16_f32 v22, v28, v29
    v_exp_f32 v31, v31
    v_mfma_f32_32x32x16_bf16 v[48:63], v[216:219], v[16:19], v[48:63]
    v_cvt_pk_bf16_f32 v23, v30, v31
    v_exp_f32 v32, v32
    v_exp_f32 v33, v33
    v_exp_f32 v34, v34
    v_mfma_f32_32x32x16_bf16 v[48:63], v[220:223], v[20:23], v[48:63]
    s_waitcnt lgkmcnt(2)
    v_cvt_pk_bf16_f32 v32, v32, v33
    v_exp_f32 v35, v35
    v_exp_f32 v36, v36
    v_cvt_pk_bf16_f32 v33, v34, v35
    v_exp_f32 v37, v37
    v_mfma_f32_32x32x16_bf16 v[16:31], v[208:211], v[232:235], 0
    v_exp_f32 v38, v38
    v_cvt_pk_bf16_f32 v34, v36, v37
    v_exp_f32 v39, v39
    v_exp_f32 v40, v40
    v_cvt_pk_bf16_f32 v35, v38, v39
    v_mfma_f32_32x32x8_bf16 v[16:31], v[212:213], v[236:237], v[16:31]
    s_waitcnt lgkmcnt(0)
    v_exp_f32 v41, v41
    v_exp_f32 v42, v42
    v_cvt_pk_bf16_f32 v36, v40, v41
    v_exp_f32 v43, v43
    v_exp_f32 v44, v44
    v_cvt_pk_bf16_f32 v37, v42, v43
    v_exp_f32 v45, v45
    v_exp_f32 v46, v46
    v_cvt_pk_bf16_f32 v38, v44, v45
    v_exp_f32 v47, v47
    v_mfma_f32_32x32x16_bf16 v[64:79], v[216:219], v[32:35], v[64:79]
    s_cmp_eq_u32 s97, 0
    s_cbranch_scc1 K2_Z1_4N
    s_add_u32 s5, s97, 4096
    buffer_store_dwordx4 v[184:187], v11, s[16:19], s5 offen sc1
K2_Z1_4N:
    v_cvt_pk_bf16_f32 v39, v46, v47
    v_exp_f32 v16, v16
    v_exp_f32 v17, v17
    v_exp_f32 v18, v18
    v_mfma_f32_32x32x16_bf16 v[64:79], v[220:223], v[36:39], v[64:79]
    s_setprio 2
    v_cvt_pk_bf16_f32 v16, v16, v17
    v_exp_f32 v19, v19
    v_exp_f32 v20, v20
    v_cvt_pk_bf16_f32 v17, v18, v19
    v_exp_f32 v21, v21
    v_mfma_f32_32x32x16_bf16 v[32:47], v[208:211], v[238:241], 0
    ds_read_b128 v[208:211], v4 offset:20480
    v_exp_f32 v22, v22
    v_cvt_pk_bf16_f32 v18, v20, v21
    v_exp_f32 v23, v23
    v_exp_f32 v24, v24
    v_cvt_pk_bf16_f32 v19, v22, v23
    v_mfma_f32_32x32x8_bf16 v[32:47], v[212:213], v[242:243], v[32:47]
    s_mov_b64 exec, s[34:35]
    ds_read_b64 v[212:213], v5 offset:21504
    s_mov_b64 exec, s[32:33]
    ds_read_b128 v[216:219], v6 offset:21760
    ds_read_b128 v[220:223], v6 offset:22400
    s_mov_b64 exec, -1
    v_exp_f32 v25, v25
    v_exp_f32 v26, v26
    v_cvt_pk_bf16_f32 v20, v24, v25
    v_exp_f32 v27, v27
    v_exp_f32 v28, v28
    v_cvt_pk_bf16_f32 v21, v26, v27
    v_exp_f32 v29, v29
    v_exp_f32 v30, v30
    v_cvt_pk_bf16_f32 v22, v28, v29
    v_exp_f32 v31, v31
    v_mfma_f32_32x32x16_bf16 v[48:63], v[224:227], v[16:19], v[48:63]
    v_cvt_pk_bf16_f32 v23, v30, v31
    v_exp_f32 v32, v32
    v_exp_f32 v33, v33
    v_exp_f32 v34, v34
    v_mfma_f32_32x32x16_bf16 v[48:63], v[228:231], v[20:23], v[48:63]
    s_setprio 1
    s_waitcnt lgkmcnt(2)
    v_cvt_pk_bf16_f32 v32, v32, v33
    v_exp_f32 v35, v35
    v_exp_f32 v36, v36
    v_cvt_pk_bf16_f32 v33, v34, v35
    v_exp_f32 v37, v37
    v_mfma_f32_32x32x16_bf16 v[16:31], v[208:211], v[232:235], 0
    v_exp_f32 v38, v38
    v_cvt_pk_bf16_f32 v34, v36, v37
    v_exp_f32 v39, v39
    v_exp_f32 v40, v40
    v_cvt_pk_bf16_f32 v35, v38, v39
    v_mfma_f32_32x32x8_bf16 v[16:31], v[212:213], v[236:237], v[16:31]
    s_waitcnt lgkmcnt(0)
    v_exp_f32 v41, v41
    v_exp_f32 v42, v42
    v_cvt_pk_bf16_f32 v36, v40, v41
    v_exp_f32 v43, v43
    v_exp_f32 v44, v44
    v_cvt_pk_bf16_f32 v37, v42, v43
    v_exp_f32 v45, v45
    v_exp_f32 v46, v46
    v_cvt_pk_bf16_f32 v38, v44, v45
    v_exp_f32 v47, v47
    v_mfma_f32_32x32x16_bf16 v[64:79], v[224:227], v[32:35], v[64:79]
    v_cvt_pk_bf16_f32 v39, v46, v47
    v_exp_f32 v16, v16
    v_exp_f32 v17, v17
    v_exp_f32 v18, v18
    v_mfma_f32_32x32x16_bf16 v[64:79], v[228:231], v[36:39], v[64:79]
    s_setprio 0
    s_add_u32 m0, s64, 0
    s_add_u32 s39, s66, 53760
    buffer_load_dwordx4 v11, s[16:19], s39 offen sc1 lds
    v_cvt_pk_bf16_f32 v16, v16, v17
    v_exp_f32 v19, v19
    v_exp_f32 v20, v20
    v_cvt_pk_bf16_f32 v17, v18, v19
    v_exp_f32 v21, v21
    v_mfma_f32_32x32x16_bf16 v[32:47], v[208:211], v[238:241], 0
    ds_read_b128 v[208:211], v4 offset:30720
    v_exp_f32 v22, v22
    v_cvt_pk_bf16_f32 v18, v20, v21
    v_exp_f32 v23, v23
    v_exp_f32 v24, v24
    v_cvt_pk_bf16_f32 v19, v22, v23
    v_mfma_f32_32x32x8_bf16 v[32:47], v[212:213], v[242:243], v[32:47]
    s_mov_b64 exec, s[34:35]
    ds_read_b64 v[212:213], v5 offset:31744
    s_mov_b64 exec, s[32:33]
    ds_read_b128 v[224:227], v6 offset:32000
    ds_read_b128 v[228:231], v6 offset:32640
    s_mov_b64 exec, -1
    v_exp_f32 v25, v25
    v_exp_f32 v26, v26
    v_cvt_pk_bf16_f32 v20, v24, v25
    v_exp_f32 v27, v27
    v_exp_f32 v28, v28
    v_cvt_pk_bf16_f32 v21, v26, v27
    v_exp_f32 v29, v29
    v_exp_f32 v30, v30
    v_cvt_pk_bf16_f32 v22, v28, v29
    v_exp_f32 v31, v31
    v_mfma_f32_32x32x16_bf16 v[48:63], v[216:219], v[16:19], v[48:63]
    s_add_u32 m0, s64, 0
    s_add_u32 s39, s66, 53760
    s_mov_b64 exec, s[68:69]
    buffer_load_dwordx4 v11, s[16:19], s39 offen offset:1024 lds
    s_mov_b64 exec, -1
    s_cmp_eq_u32 s97, 0
    s_cbranch_scc1 K2_Z1_5N
    s_add_u32 s5, s97, 5120
    buffer_store_dwordx4 v[192:195], v11, s[16:19], s5 offen sc1
K2_Z1_5N:
    v_cvt_pk_bf16_f32 v23, v30, v31
    s_waitcnt lgkmcnt(0)
    s_barrier
    v_exp_f32 v32, v32
    v_exp_f32 v33, v33
    v_exp_f32 v34, v34
    v_mfma_f32_32x32x16_bf16 v[48:63], v[220:223], v[20:23], v[48:63]
    s_setprio 3
    s_waitcnt vmcnt(2)
    s_mov_b64 exec, 1
    buffer_store_dword v14, v15, s[16:19], 0 offen sc1
    s_mov_b64 exec, -1
    s_mov_b32 s60, 28
    v_cvt_pk_bf16_f32 v32, v32, v33
    v_exp_f32 v35, v35
    v_exp_f32 v36, v36
    v_cvt_pk_bf16_f32 v33, v34, v35
    v_exp_f32 v37, v37
    v_mfma_f32_32x32x16_bf16 v[16:31], v[208:211], v[232:235], 0
    v_exp_f32 v38, v38
    v_cvt_pk_bf16_f32 v34, v36, v37
    v_exp_f32 v39, v39
    v_exp_f32 v40, v40
    v_cvt_pk_bf16_f32 v35, v38, v39
    v_mfma_f32_32x32x8_bf16 v[16:31], v[212:213], v[236:237], v[16:31]
    v_exp_f32 v41, v41
    v_exp_f32 v42, v42
    v_cvt_pk_bf16_f32 v36, v40, v41
    v_exp_f32 v43, v43
    v_exp_f32 v44, v44
    v_cvt_pk_bf16_f32 v37, v42, v43
    v_exp_f32 v45, v45
    v_exp_f32 v46, v46
    v_cvt_pk_bf16_f32 v38, v44, v45
    v_exp_f32 v47, v47
    v_mfma_f32_32x32x16_bf16 v[64:79], v[216:219], v[32:35], v[64:79]
    v_cvt_pk_bf16_f32 v39, v46, v47
    v_exp_f32 v16, v16
    v_exp_f32 v17, v17
    v_exp_f32 v18, v18
    v_mfma_f32_32x32x16_bf16 v[64:79], v[220:223], v[36:39], v[64:79]
    v_cvt_pk_bf16_f32 v16, v16, v17
    v_exp_f32 v19, v19
    v_exp_f32 v20, v20
    v_cvt_pk_bf16_f32 v17, v18, v19
    v_exp_f32 v21, v21
    v_mfma_f32_32x32x16_bf16 v[32:47], v[208:211], v[238:241], 0
    ds_read_b128 v[208:211], v4 offset:33280
    v_exp_f32 v22, v22
    v_cvt_pk_bf16_f32 v18, v20, v21
    v_exp_f32 v23, v23
    v_exp_f32 v24, v24
    v_cvt_pk_bf16_f32 v19, v22, v23
    v_mfma_f32_32x32x8_bf16 v[32:47], v[212:213], v[242:243], v[32:47]
    s_mov_b64 exec, s[34:35]
    ds_read_b64 v[212:213], v5 offset:34304
    s_mov_b64 exec, s[32:33]
    ds_read_b128 v[216:219], v6 offset:34560
    ds_read_b128 v[220:223], v6 offset:35200
    s_mov_b64 exec, -1
    v_exp_f32 v25, v25
    v_exp_f32 v26, v26
    v_cvt_pk_bf16_f32 v20, v24, v25
    v_exp_f32 v27, v27
    v_exp_f32 v28, v28
    v_cvt_pk_bf16_f32 v21, v26, v27
    v_exp_f32 v29, v29
    v_exp_f32 v30, v30
    v_cvt_pk_bf16_f32 v22, v28, v29
    v_exp_f32 v31, v31
    v_mfma_f32_32x32x16_bf16 v[48:63], v[224:227], v[16:19], v[48:63]
    v_cvt_pk_bf16_f32 v23, v30, v31
    v_exp_f32 v32, v32
    v_exp_f32 v33, v33
    v_exp_f32 v34, v34
    v_mfma_f32_32x32x16_bf16 v[48:63], v[228:231], v[20:23], v[48:63]
    s_setprio 2
    s_waitcnt lgkmcnt(2)
    v_cvt_pk_bf16_f32 v32, v32, v33
    v_exp_f32 v35, v35
    v_exp_f32 v36, v36
    v_cvt_pk_bf16_f32 v33, v34, v35
    v_exp_f32 v37, v37
    v_mfma_f32_32x32x16_bf16 v[16:31], v[208:211], v[232:235], 0
    v_exp_f32 v38, v38
    v_cvt_pk_bf16_f32 v34, v36, v37
    v_exp_f32 v39, v39
    v_exp_f32 v40, v40
    v_cvt_pk_bf16_f32 v35, v38, v39
    v_mfma_f32_32x32x8_bf16 v[16:31], v[212:213], v[236:237], v[16:31]
    s_waitcnt lgkmcnt(0)
    v_exp_f32 v41, v41
    v_exp_f32 v42, v42
    v_cvt_pk_bf16_f32 v36, v40, v41
    v_exp_f32 v43, v43
    v_exp_f32 v44, v44
    v_cvt_pk_bf16_f32 v37, v42, v43
    v_exp_f32 v45, v45
    v_exp_f32 v46, v46
    v_cvt_pk_bf16_f32 v38, v44, v45
    v_exp_f32 v47, v47
    v_mfma_f32_32x32x16_bf16 v[64:79], v[224:227], v[32:35], v[64:79]
    s_cmp_eq_u32 s97, 0
    s_cbranch_scc1 K2_Z1_6N
    s_add_u32 s5, s97, 6144
    buffer_store_dwordx4 v[196:199], v11, s[16:19], s5 offen sc1
K2_Z1_6N:
    v_cvt_pk_bf16_f32 v39, v46, v47
    v_exp_f32 v16, v16
    v_exp_f32 v17, v17
    v_exp_f32 v18, v18
    v_mfma_f32_32x32x16_bf16 v[64:79], v[228:231], v[36:39], v[64:79]
    s_setprio 1
    v_cvt_pk_bf16_f32 v16, v16, v17
    v_exp_f32 v19, v19
    v_exp_f32 v20, v20
    v_cvt_pk_bf16_f32 v17, v18, v19
    v_exp_f32 v21, v21
    v_mfma_f32_32x32x16_bf16 v[32:47], v[208:211], v[238:241], 0
    ds_read_b128 v[208:211], v4 offset:35840
    v_exp_f32 v22, v22
    v_cvt_pk_bf16_f32 v18, v20, v21
    v_exp_f32 v23, v23
    v_exp_f32 v24, v24
    v_cvt_pk_bf16_f32 v19, v22, v23
    v_mfma_f32_32x32x8_bf16 v[32:47], v[212:213], v[242:243], v[32:47]
    s_mov_b64 exec, s[34:35]
    ds_read_b64 v[212:213], v5 offset:36864
    s_mov_b64 exec, s[32:33]
    ds_read_b128 v[224:227], v6 offset:37120
    ds_read_b128 v[228:231], v6 offset:37760
    s_mov_b64 exec, -1
    v_exp_f32 v25, v25
    v_exp_f32 v26, v26
    v_cvt_pk_bf16_f32 v20, v24, v25
    v_exp_f32 v27, v27
    v_exp_f32 v28, v28
    v_cvt_pk_bf16_f32 v21, v26, v27
    v_exp_f32 v29, v29
    v_exp_f32 v30, v30
    v_cvt_pk_bf16_f32 v22, v28, v29
    v_exp_f32 v31, v31
    v_mfma_f32_32x32x16_bf16 v[48:63], v[216:219], v[16:19], v[48:63]
    v_cvt_pk_bf16_f32 v23, v30, v31
    v_exp_f32 v32, v32
    v_exp_f32 v33, v33
    v_exp_f32 v34, v34
    v_mfma_f32_32x32x16_bf16 v[48:63], v[220:223], v[20:23], v[48:63]
    s_setprio 0
    s_waitcnt lgkmcnt(2)
    s_add_u32 m0, s64, 15360
    s_add_u32 s39, s66, 61440
    buffer_load_dwordx4 v11, s[16:19], s39 offen sc1 lds
    v_cvt_pk_bf16_f32 v32, v32, v33
    v_exp_f32 v35, v35
    v_exp_f32 v36, v36
    v_cvt_pk_bf16_f32 v33, v34, v35
    v_exp_f32 v37, v37
    v_mfma_f32_32x32x16_bf16 v[16:31], v[208:211], v[232:235], 0
    s_add_u32 m0, s64, 15360
    s_add_u32 s39, s66, 61440
    s_mov_b64 exec, s[68:69]
    buffer_load_dwordx4 v11, s[16:19], s39 offen offset:1024 lds
    s_mov_b64 exec, -1
    v_exp_f32 v38, v38
    v_cvt_pk_bf16_f32 v34, v36, v37
    v_exp_f32 v39, v39
    v_exp_f32 v40, v40
    v_cvt_pk_bf16_f32 v35, v38, v39
    v_mfma_f32_32x32x8_bf16 v[16:31], v[212:213], v[236:237], v[16:31]
    s_waitcnt lgkmcnt(0)
    v_exp_f32 v41, v41
    v_exp_f32 v42, v42
    v_cvt_pk_bf16_f32 v36, v40, v41
    v_exp_f32 v43, v43
    v_exp_f32 v44, v44
    v_cvt_pk_bf16_f32 v37, v42, v43
    v_exp_f32 v45, v45
    v_exp_f32 v46, v46
    v_cvt_pk_bf16_f32 v38, v44, v45
    v_exp_f32 v47, v47
    v_mfma_f32_32x32x16_bf16 v[64:79], v[216:219], v[32:35], v[64:79]
    v_cvt_pk_bf16_f32 v39, v46, v47
    s_barrier
    v_exp_f32 v16, v16
    v_exp_f32 v17, v17
    v_exp_f32 v18, v18
    v_mfma_f32_32x32x16_bf16 v[64:79], v[220:223], v[36:39], v[64:79]
    s_setprio 3
    v_cvt_pk_bf16_f32 v16, v16, v17
    v_exp_f32 v19, v19
    v_exp_f32 v20, v20
    v_cvt_pk_bf16_f32 v17, v18, v19
    v_exp_f32 v21, v21
    v_mfma_f32_32x32x16_bf16 v[32:47], v[208:211], v[238:241], 0
    ds_read_b128 v[208:211], v4 offset:46080
    v_exp_f32 v22, v22
    v_cvt_pk_bf16_f32 v18, v20, v21
    v_exp_f32 v23, v23
    v_exp_f32 v24, v24
    v_cvt_pk_bf16_f32 v19, v22, v23
    v_mfma_f32_32x32x8_bf16 v[32:47], v[212:213], v[242:243], v[32:47]
    s_mov_b64 exec, s[34:35]
    ds_read_b64 v[212:213], v5 offset:47104
    s_mov_b64 exec, s[32:33]
    ds_read_b128 v[216:219], v6 offset:47360
    ds_read_b128 v[220:223], v6 offset:48000
    s_mov_b64 exec, -1
    v_exp_f32 v25, v25
    v_exp_f32 v26, v26
    v_cvt_pk_bf16_f32 v20, v24, v25
    v_exp_f32 v27, v27
    v_exp_f32 v28, v28
    v_cvt_pk_bf16_f32 v21, v26, v27
    v_exp_f32 v29, v29
    v_exp_f32 v30, v30
    v_cvt_pk_bf16_f32 v22, v28, v29
    v_exp_f32 v31, v31
    v_mfma_f32_32x32x16_bf16 v[48:63], v[224:227], v[16:19], v[48:63]
    v_cvt_pk_bf16_f32 v23, v30, v31
    v_exp_f32 v32, v32
    v_exp_f32 v33, v33
    v_exp_f32 v34, v34
    v_mfma_f32_32x32x16_bf16 v[48:63], v[228:231], v[20:23], v[48:63]
    s_waitcnt lgkmcnt(2)
    v_cvt_pk_bf16_f32 v32, v32, v33
    v_exp_f32 v35, v35
    v_exp_f32 v36, v36
    v_cvt_pk_bf16_f32 v33, v34, v35
    v_exp_f32 v37, v37
    v_mfma_f32_32x32x16_bf16 v[16:31], v[208:211], v[232:235], 0
    v_exp_f32 v38, v38
    v_cvt_pk_bf16_f32 v34, v36, v37
    v_exp_f32 v39, v39
    v_exp_f32 v40, v40
    v_cvt_pk_bf16_f32 v35, v38, v39
    v_mfma_f32_32x32x8_bf16 v[16:31], v[212:213], v[236:237], v[16:31]
    s_waitcnt lgkmcnt(0)
    v_exp_f32 v41, v41
    v_exp_f32 v42, v42
    v_cvt_pk_bf16_f32 v36, v40, v41
    v_exp_f32 v43, v43
    v_exp_f32 v44, v44
    v_cvt_pk_bf16_f32 v37, v42, v43
    v_exp_f32 v45, v45
    v_exp_f32 v46, v46
    v_cvt_pk_bf16_f32 v38, v44, v45
    v_exp_f32 v47, v47
    v_mfma_f32_32x32x16_bf16 v[64:79], v[224:227], v[32:35], v[64:79]
    v_cvt_pk_bf16_f32 v39, v46, v47
    v_exp_f32 v16, v16
    v_exp_f32 v17, v17
    v_exp_f32 v18, v18
    v_mfma_f32_32x32x16_bf16 v[64:79], v[228:231], v[36:39], v[64:79]
    s_setprio 2
    v_cvt_pk_bf16_f32 v16, v16, v17
    v_exp_f32 v19, v19
    v_exp_f32 v20, v20
    v_cvt_pk_bf16_f32 v17, v18, v19
    v_exp_f32 v21, v21
    v_mfma_f32_32x32x16_bf16 v[32:47], v[208:211], v[238:241], 0
    ds_read_b128 v[208:211], v4 offset:48640
    v_exp_f32 v22, v22
    v_cvt_pk_bf16_f32 v18, v20, v21
    v_exp_f32 v23, v23
    v_exp_f32 v24, v24
    v_cvt_pk_bf16_f32 v19, v22, v23
    v_mfma_f32_32x32x8_bf16 v[32:47], v[212:213], v[242:243], v[32:47]
    s_mov_b64 exec, s[34:35]
    ds_read_b64 v[212:213], v5 offset:49664
    s_mov_b64 exec, s[32:33]
    ds_read_b128 v[224:227], v6 offset:49920
    ds_read_b128 v[228:231], v6 offset:50560
    s_mov_b64 exec, -1
    v_exp_f32 v25, v25
    v_exp_f32 v26, v26
    v_cvt_pk_bf16_f32 v20, v24, v25
    v_exp_f32 v27, v27
    v_exp_f32 v28, v28
    v_cvt_pk_bf16_f32 v21, v26, v27
    v_exp_f32 v29, v29
    v_exp_f32 v30, v30
    v_cvt_pk_bf16_f32 v22, v28, v29
    v_exp_f32 v31, v31
    v_mfma_f32_32x32x16_bf16 v[48:63], v[216:219], v[16:19], v[48:63]
    s_cmp_ge_u32 s30, 4
    s_cbranch_scc1 K2_ND1N
    s_cmp_eq_u32 s97, 0
    s_cbranch_scc1 K2_ND1N
    s_waitcnt vmcnt(0)
    v_mov_b32 v244, s98
    s_mov_b64 exec, 1
    buffer_store_dword v14, v244, s[16:19], 0 offen sc1
    s_mov_b64 exec, -1
K2_ND1N:
    v_cvt_pk_bf16_f32 v23, v30, v31
    v_exp_f32 v32, v32
    v_exp_f32 v33, v33
    v_exp_f32 v34, v34
    v_mfma_f32_32x32x16_bf16 v[48:63], v[220:223], v[20:23], v[48:63]
    s_setprio 1
    s_waitcnt lgkmcnt(2)
    v_cvt_pk_bf16_f32 v32, v32, v33
    v_exp_f32 v35, v35
    v_exp_f32 v36, v36
    v_cvt_pk_bf16_f32 v33, v34, v35
    v_exp_f32 v37, v37
    v_mfma_f32_32x32x16_bf16 v[16:31], v[208:211], v[232:235], 0
    v_exp_f32 v38, v38
    v_cvt_pk_bf16_f32 v34, v36, v37
    v_exp_f32 v39, v39
    v_exp_f32 v40, v40
    v_cvt_pk_bf16_f32 v35, v38, v39
    v_mfma_f32_32x32x8_bf16 v[16:31], v[212:213], v[236:237], v[16:31]
    s_waitcnt lgkmcnt(0)
    v_exp_f32 v41, v41
    v_exp_f32 v42, v42
    v_cvt_pk_bf16_f32 v36, v40, v41
    v_exp_f32 v43, v43
    v_exp_f32 v44, v44
    v_cvt_pk_bf16_f32 v37, v42, v43
    v_exp_f32 v45, v45
    v_exp_f32 v46, v46
    v_cvt_pk_bf16_f32 v38, v44, v45
    v_exp_f32 v47, v47
    v_mfma_f32_32x32x16_bf16 v[64:79], v[216:219], v[32:35], v[64:79]
    v_cvt_pk_bf16_f32 v39, v46, v47
    v_exp_f32 v16, v16
    v_exp_f32 v17, v17
    v_exp_f32 v18, v18
    v_mfma_f32_32x32x16_bf16 v[64:79], v[220:223], v[36:39], v[64:79]
    s_setprio 0
    s_add_u32 m0, s64, 30720
    s_add_u32 s39, s66, 69120
    buffer_load_dwordx4 v11, s[16:19], s39 offen sc1 lds
    v_cvt_pk_bf16_f32 v16, v16, v17
    v_exp_f32 v19, v19
    v_exp_f32 v20, v20
    v_cvt_pk_bf16_f32 v17, v18, v19
    v_exp_f32 v21, v21
    v_mfma_f32_32x32x16_bf16 v[32:47], v[208:211], v[238:241], 0
    ds_read_b128 v[208:211], v4 offset:51200
    v_exp_f32 v22, v22
    v_cvt_pk_bf16_f32 v18, v20, v21
    v_exp_f32 v23, v23
    v_exp_f32 v24, v24
    v_cvt_pk_bf16_f32 v19, v22, v23
    v_mfma_f32_32x32x8_bf16 v[32:47], v[212:213], v[242:243], v[32:47]
    s_mov_b64 exec, s[34:35]
    ds_read_b64 v[212:213], v5 offset:52224
    s_mov_b64 exec, s[32:33]
    ds_read_b128 v[216:219], v6 offset:52480
    ds_read_b128 v[220:223], v6 offset:53120
    s_mov_b64 exec, -1
    v_exp_f32 v25, v25
    v_exp_f32 v26, v26
    v_cvt_pk_bf16_f32 v20, v24, v25
    v_exp_f32 v27, v27
    v_exp_f32 v28, v28
    v_cvt_pk_bf16_f32 v21, v26, v27
    v_exp_f32 v29, v29
    v_exp_f32 v30, v30
    v_cvt_pk_bf16_f32 v22, v28, v29
    v_exp_f32 v31, v31
    v_mfma_f32_32x32x16_bf16 v[48:63], v[224:227], v[16:19], v[48:63]
    s_add_u32 m0, s64, 30720
    s_add_u32 s39, s66, 69120
    s_mov_b64 exec, s[68:69]
    buffer_load_dwordx4 v11, s[16:19], s39 offen offset:1024 lds
    s_mov_b64 exec, -1
    v_cvt_pk_bf16_f32 v23, v30, v31
    s_waitcnt vmcnt(4) lgkmcnt(0)
    s_barrier
    v_exp_f32 v32, v32
    v_exp_f32 v33, v33
    v_exp_f32 v34, v34
    v_mfma_f32_32x32x16_bf16 v[48:63], v[228:231], v[20:23], v[48:63]
    s_setprio 3
    v_cvt_pk_bf16_f32 v32, v32, v33
    v_exp_f32 v35, v35
    v_exp_f32 v36, v36
    v_cvt_pk_bf16_f32 v33, v34, v35
    v_exp_f32 v37, v37
    v_mfma_f32_32x32x16_bf16 v[16:31], v[208:211], v[232:235], 0
    v_exp_f32 v38, v38
    v_cvt_pk_bf16_f32 v34, v36, v37
    v_exp_f32 v39, v39
    v_exp_f32 v40, v40
    v_cvt_pk_bf16_f32 v35, v38, v39
    v_mfma_f32_32x32x8_bf16 v[16:31], v[212:213], v[236:237], v[16:31]
    v_exp_f32 v41, v41
    v_exp_f32 v42, v42
    v_cvt_pk_bf16_f32 v36, v40, v41
    v_exp_f32 v43, v43
    v_exp_f32 v44, v44
    v_cvt_pk_bf16_f32 v37, v42, v43
    v_exp_f32 v45, v45
    v_exp_f32 v46, v46
    v_cvt_pk_bf16_f32 v38, v44, v45
    v_exp_f32 v47, v47
    v_mfma_f32_32x32x16_bf16 v[64:79], v[224:227], v[32:35], v[64:79]
    v_cvt_pk_bf16_f32 v39, v46, v47
    v_exp_f32 v16, v16
    v_exp_f32 v17, v17
    v_exp_f32 v18, v18
    v_mfma_f32_32x32x16_bf16 v[64:79], v[228:231], v[36:39], v[64:79]
    v_cvt_pk_bf16_f32 v16, v16, v17
    v_exp_f32 v19, v19
    v_exp_f32 v20, v20
    v_cvt_pk_bf16_f32 v17, v18, v19
    v_exp_f32 v21, v21
    v_mfma_f32_32x32x16_bf16 v[32:47], v[208:211], v[238:241], 0
    ds_read_b128 v[208:211], v4 offset:0
    v_exp_f32 v22, v22
    v_cvt_pk_bf16_f32 v18, v20, v21
    v_exp_f32 v23, v23
    v_exp_f32 v24, v24
    v_cvt_pk_bf16_f32 v19, v22, v23
    v_mfma_f32_32x32x8_bf16 v[32:47], v[212:213], v[242:243], v[32:47]
    s_mov_b64 exec, s[34:35]
    ds_read_b64 v[212:213], v5 offset:1024
    s_mov_b64 exec, s[32:33]
    ds_read_b128 v[224:227], v6 offset:1280
    ds_read_b128 v[228:231], v6 offset:1920
    s_mov_b64 exec, -1
    v_exp_f32 v25, v25
    v_exp_f32 v26, v26
    v_cvt_pk_bf16_f32 v20, v24, v25
    v_exp_f32 v27, v27
    v_exp_f32 v28, v28
    v_cvt_pk_bf16_f32 v21, v26, v27
    v_exp_f32 v29, v29
    v_exp_f32 v30, v30
    v_cvt_pk_bf16_f32 v22, v28, v29
    v_exp_f32 v31, v31
    v_mfma_f32_32x32x16_bf16 v[48:63], v[216:219], v[16:19], v[48:63]
    v_cvt_pk_bf16_f32 v23, v30, v31
    v_exp_f32 v32, v32
    v_exp_f32 v33, v33
    v_exp_f32 v34, v34
    v_mfma_f32_32x32x16_bf16 v[48:63], v[220:223], v[20:23], v[48:63]
    s_setprio 2
    s_waitcnt lgkmcnt(2)
    v_cvt_pk_bf16_f32 v32, v32, v33
    v_exp_f32 v35, v35
    v_exp_f32 v36, v36
    v_cvt_pk_bf16_f32 v33, v34, v35
    v_exp_f32 v37, v37
    v_mfma_f32_32x32x16_bf16 v[16:31], v[208:211], v[232:235], 0
    v_exp_f32 v38, v38
    v_cvt_pk_bf16_f32 v34, v36, v37
    v_exp_f32 v39, v39
    v_exp_f32 v40, v40
    v_cvt_pk_bf16_f32 v35, v38, v39
    v_mfma_f32_32x32x8_bf16 v[16:31], v[212:213], v[236:237], v[16:31]
    s_waitcnt lgkmcnt(0)
    v_exp_f32 v41, v41
    v_exp_f32 v42, v42
    v_cvt_pk_bf16_f32 v36, v40, v41
    v_exp_f32 v43, v43
    v_exp_f32 v44, v44
    v_cvt_pk_bf16_f32 v37, v42, v43
    v_exp_f32 v45, v45
    v_exp_f32 v46, v46
    v_cvt_pk_bf16_f32 v38, v44, v45
    v_exp_f32 v47, v47
    v_mfma_f32_32x32x16_bf16 v[64:79], v[216:219], v[32:35], v[64:79]
    v_cvt_pk_bf16_f32 v39, v46, v47
    v_exp_f32 v16, v16
    v_exp_f32 v17, v17
    v_exp_f32 v18, v18
    v_mfma_f32_32x32x16_bf16 v[64:79], v[220:223], v[36:39], v[64:79]
    s_setprio 1
    v_cvt_pk_bf16_f32 v16, v16, v17
    v_exp_f32 v19, v19
    v_exp_f32 v20, v20
    v_cvt_pk_bf16_f32 v17, v18, v19
    v_exp_f32 v21, v21
    v_mfma_f32_32x32x16_bf16 v[32:47], v[208:211], v[238:241], 0
    ds_read_b128 v[208:211], v4 offset:2560
    v_exp_f32 v22, v22
    v_cvt_pk_bf16_f32 v18, v20, v21
    v_exp_f32 v23, v23
    v_exp_f32 v24, v24
    v_cvt_pk_bf16_f32 v19, v22, v23
    v_mfma_f32_32x32x8_bf16 v[32:47], v[212:213], v[242:243], v[32:47]
    s_mov_b64 exec, s[34:35]
    ds_read_b64 v[212:213], v5 offset:3584
    s_mov_b64 exec, s[32:33]
    ds_read_b128 v[216:219], v6 offset:3840
    ds_read_b128 v[220:223], v6 offset:4480
    s_mov_b64 exec, -1
    v_exp_f32 v25, v25
    v_exp_f32 v26, v26
    v_cvt_pk_bf16_f32 v20, v24, v25
    v_exp_f32 v27, v27
    v_exp_f32 v28, v28
    v_cvt_pk_bf16_f32 v21, v26, v27
    v_exp_f32 v29, v29
    v_exp_f32 v30, v30
    v_cvt_pk_bf16_f32 v22, v28, v29
    v_exp_f32 v31, v31
    v_mfma_f32_32x32x16_bf16 v[48:63], v[224:227], v[16:19], v[48:63]
    v_cvt_pk_bf16_f32 v23, v30, v31
    v_exp_f32 v32, v32
    v_exp_f32 v33, v33
    v_exp_f32 v34, v34
    v_mfma_f32_32x32x16_bf16 v[48:63], v[228:231], v[20:23], v[48:63]
    s_setprio 0
    s_waitcnt lgkmcnt(2)
    v_cvt_pk_bf16_f32 v32, v32, v33
    v_exp_f32 v35, v35
    v_exp_f32 v36, v36
    v_cvt_pk_bf16_f32 v33, v34, v35
    v_exp_f32 v37, v37
    v_mfma_f32_32x32x16_bf16 v[16:31], v[208:211], v[232:235], 0
    v_exp_f32 v38, v38
    v_cvt_pk_bf16_f32 v34, v36, v37
    v_exp_f32 v39, v39
    v_exp_f32 v40, v40
    v_cvt_pk_bf16_f32 v35, v38, v39
    v_mfma_f32_32x32x8_bf16 v[16:31], v[212:213], v[236:237], v[16:31]
    s_waitcnt lgkmcnt(0)
    v_exp_f32 v41, v41
    v_exp_f32 v42, v42
    v_cvt_pk_bf16_f32 v36, v40, v41
    v_exp_f32 v43, v43
    v_exp_f32 v44, v44
    v_cvt_pk_bf16_f32 v37, v42, v43
    v_exp_f32 v45, v45
    v_exp_f32 v46, v46
    v_cvt_pk_bf16_f32 v38, v44, v45
    v_exp_f32 v47, v47
    v_mfma_f32_32x32x16_bf16 v[64:79], v[224:227], v[32:35], v[64:79]
    v_cvt_pk_bf16_f32 v39, v46, v47
    s_waitcnt vmcnt(2)
    s_barrier
    v_exp_f32 v16, v16
    v_exp_f32 v17, v17
    v_exp_f32 v18, v18
    v_mfma_f32_32x32x16_bf16 v[64:79], v[228:231], v[36:39], v[64:79]
    s_setprio 3
    v_cvt_pk_bf16_f32 v16, v16, v17
    v_exp_f32 v19, v19
    v_exp_f32 v20, v20
    v_cvt_pk_bf16_f32 v17, v18, v19
    v_exp_f32 v21, v21
    v_mfma_f32_32x32x16_bf16 v[32:47], v[208:211], v[238:241], 0
    ds_read_b128 v[208:211], v4 offset:5120
    v_exp_f32 v22, v22
    v_cvt_pk_bf16_f32 v18, v20, v21
    v_exp_f32 v23, v23
    v_exp_f32 v24, v24
    v_cvt_pk_bf16_f32 v19, v22, v23
    v_mfma_f32_32x32x8_bf16 v[32:47], v[212:213], v[242:243], v[32:47]
    s_mov_b64 exec, s[34:35]
    ds_read_b64 v[212:213], v5 offset:6144
    s_mov_b64 exec, s[32:33]
    ds_read_b128 v[224:227], v6 offset:6400
    ds_read_b128 v[228:231], v6 offset:7040
    s_mov_b64 exec, -1
    v_exp_f32 v25, v25
    v_exp_f32 v26, v26
    v_cvt_pk_bf16_f32 v20, v24, v25
    v_exp_f32 v27, v27
    v_exp_f32 v28, v28
    v_cvt_pk_bf16_f32 v21, v26, v27
    v_exp_f32 v29, v29
    v_exp_f32 v30, v30
    v_cvt_pk_bf16_f32 v22, v28, v29
    v_exp_f32 v31, v31
    v_mfma_f32_32x32x16_bf16 v[48:63], v[216:219], v[16:19], v[48:63]
    v_cvt_pk_bf16_f32 v23, v30, v31
    v_exp_f32 v32, v32
    v_exp_f32 v33, v33
    v_exp_f32 v34, v34
    v_mfma_f32_32x32x16_bf16 v[48:63], v[220:223], v[20:23], v[48:63]
    s_waitcnt lgkmcnt(2)
    v_cvt_pk_bf16_f32 v32, v32, v33
    v_exp_f32 v35, v35
    v_exp_f32 v36, v36
    v_cvt_pk_bf16_f32 v33, v34, v35
    v_exp_f32 v37, v37
    v_mfma_f32_32x32x16_bf16 v[16:31], v[208:211], v[232:235], 0
    v_exp_f32 v38, v38
    v_cvt_pk_bf16_f32 v34, v36, v37
    v_exp_f32 v39, v39
    v_exp_f32 v40, v40
    v_cvt_pk_bf16_f32 v35, v38, v39
    v_mfma_f32_32x32x8_bf16 v[16:31], v[212:213], v[236:237], v[16:31]
    s_waitcnt lgkmcnt(0)
    v_exp_f32 v41, v41
    v_exp_f32 v42, v42
    v_cvt_pk_bf16_f32 v36, v40, v41
    v_exp_f32 v43, v43
    v_exp_f32 v44, v44
    v_cvt_pk_bf16_f32 v37, v42, v43
    v_exp_f32 v45, v45
    v_exp_f32 v46, v46
    v_cvt_pk_bf16_f32 v38, v44, v45
    v_exp_f32 v47, v47
    v_mfma_f32_32x32x16_bf16 v[64:79], v[216:219], v[32:35], v[64:79]
    v_cvt_pk_bf16_f32 v39, v46, v47
    v_exp_f32 v16, v16
    v_exp_f32 v17, v17
    v_exp_f32 v18, v18
    v_mfma_f32_32x32x16_bf16 v[64:79], v[220:223], v[36:39], v[64:79]
    s_setprio 2
    s_cmp_lg_u32 s30, 4
    s_cbranch_scc1 K2_F3IN
    v_add_u32 v12, 3087360, v11
    buffer_load_dwordx4 v[248:251], v12, s[16:19], 0 offen offset:0 sc1
    buffer_load_dword v252, v8, s[16:19], 0 offen offset:0 sc1
K2_F3IN:
    v_cvt_pk_bf16_f32 v16, v16, v17
    v_exp_f32 v19, v19
    v_exp_f32 v20, v20
    v_cvt_pk_bf16_f32 v17, v18, v19
    v_exp_f32 v21, v21
    v_mfma_f32_32x32x16_bf16 v[32:47], v[208:211], v[238:241], 0
    ds_read_b128 v[208:211], v4 offset:15360
    v_exp_f32 v22, v22
    v_cvt_pk_bf16_f32 v18, v20, v21
    v_exp_f32 v23, v23
    v_exp_f32 v24, v24
    v_cvt_pk_bf16_f32 v19, v22, v23
    v_mfma_f32_32x32x8_bf16 v[32:47], v[212:213], v[242:243], v[32:47]
    s_mov_b64 exec, s[34:35]
    ds_read_b64 v[212:213], v5 offset:16384
    s_mov_b64 exec, s[32:33]
    ds_read_b128 v[216:219], v6 offset:16640
    ds_read_b128 v[220:223], v6 offset:17280
    s_mov_b64 exec, -1
    v_exp_f32 v25, v25
    v_exp_f32 v26, v26
    v_cvt_pk_bf16_f32 v20, v24, v25
    v_exp_f32 v27, v27
    v_exp_f32 v28, v28
    v_cvt_pk_bf16_f32 v21, v26, v27
    v_exp_f32 v29, v29
    v_exp_f32 v30, v30
    v_cvt_pk_bf16_f32 v22, v28, v29
    v_exp_f32 v31, v31
    v_mfma_f32_32x32x16_bf16 v[48:63], v[224:227], v[16:19], v[48:63]
    v_cvt_pk_bf16_f32 v23, v30, v31
    v_exp_f32 v32, v32
    v_exp_f32 v33, v33
    v_exp_f32 v34, v34
    v_mfma_f32_32x32x16_bf16 v[48:63], v[228:231], v[20:23], v[48:63]
    s_setprio 1
    s_waitcnt lgkmcnt(2)
    s_add_u32 m0, s64, 46080
    s_add_u32 s39, s66, 76800
    buffer_load_dwordx4 v11, s[16:19], s39 offen sc1 lds
    v_cvt_pk_bf16_f32 v32, v32, v33
    v_exp_f32 v35, v35
    v_exp_f32 v36, v36
    v_cvt_pk_bf16_f32 v33, v34, v35
    v_exp_f32 v37, v37
    v_mfma_f32_32x32x16_bf16 v[16:31], v[208:211], v[232:235], 0
    s_add_u32 m0, s64, 46080
    s_add_u32 s39, s66, 76800
    s_mov_b64 exec, s[68:69]
    buffer_load_dwordx4 v11, s[16:19], s39 offen offset:1024 lds
    s_mov_b64 exec, -1
    v_exp_f32 v38, v38
    v_cvt_pk_bf16_f32 v34, v36, v37
    v_exp_f32 v39, v39
    v_exp_f32 v40, v40
    v_cvt_pk_bf16_f32 v35, v38, v39
    v_mfma_f32_32x32x8_bf16 v[16:31], v[212:213], v[236:237], v[16:31]
    s_waitcnt lgkmcnt(0)
    v_exp_f32 v41, v41
    v_exp_f32 v42, v42
    v_cvt_pk_bf16_f32 v36, v40, v41
    v_exp_f32 v43, v43
    v_exp_f32 v44, v44
    v_cvt_pk_bf16_f32 v37, v42, v43
    v_exp_f32 v45, v45
    v_exp_f32 v46, v46
    v_cvt_pk_bf16_f32 v38, v44, v45
    v_exp_f32 v47, v47
    v_mfma_f32_32x32x16_bf16 v[64:79], v[224:227], v[32:35], v[64:79]
    v_cvt_pk_bf16_f32 v39, v46, v47
    v_exp_f32 v16, v16
    v_exp_f32 v17, v17
    v_exp_f32 v18, v18
    v_mfma_f32_32x32x16_bf16 v[64:79], v[228:231], v[36:39], v[64:79]
    s_setprio 0
    v_cvt_pk_bf16_f32 v16, v16, v17
    v_exp_f32 v19, v19
    v_exp_f32 v20, v20
    v_cvt_pk_bf16_f32 v17, v18, v19
    v_exp_f32 v21, v21
    v_mfma_f32_32x32x16_bf16 v[32:47], v[208:211], v[238:241], 0
    ds_read_b128 v[208:211], v4 offset:17920
    v_exp_f32 v22, v22
    v_cvt_pk_bf16_f32 v18, v20, v21
    v_exp_f32 v23, v23
    v_exp_f32 v24, v24
    v_cvt_pk_bf16_f32 v19, v22, v23
    v_mfma_f32_32x32x8_bf16 v[32:47], v[212:213], v[242:243], v[32:47]
    s_mov_b64 exec, s[34:35]
    ds_read_b64 v[212:213], v5 offset:18944
    s_mov_b64 exec, s[32:33]
    ds_read_b128 v[224:227], v6 offset:19200
    ds_read_b128 v[228:231], v6 offset:19840
    s_mov_b64 exec, -1
    v_exp_f32 v25, v25
    v_exp_f32 v26, v26
    v_cvt_pk_bf16_f32 v20, v24, v25
    v_exp_f32 v27, v27
    v_exp_f32 v28, v28
    v_cvt_pk_bf16_f32 v21, v26, v27
    v_exp_f32 v29, v29
    v_exp_f32 v30, v30
    v_cvt_pk_bf16_f32 v22, v28, v29
    v_exp_f32 v31, v31
    v_mfma_f32_32x32x16_bf16 v[48:63], v[216:219], v[16:19], v[48:63]
    v_cvt_pk_bf16_f32 v23, v30, v31
    s_cmp_lg_u32 s30, 4
    s_cbranch_scc1 K2_F3OKN
    s_waitcnt vmcnt(2)
    v_and_b32 v248, v248, v249
    v_and_b32 v248, v248, v250
    v_and_b32 v248, v248, v251
    v_and_b32 v248, v248, v252
    v_cmp_ne_u32 vcc, 1, v248
    s_cbranch_vccz K2_F3OKN
K2_F3SPN:
    s_cmp_eq_u32 s96, 0
    s_cbranch_scc1 K2_F3OKN
    s_sub_u32 s96, s96, 1
    s_sleep 12
    s_mov_b64 exec, vcc
    v_add_u32 v12, 3087360, v11
    buffer_load_dwordx4 v[248:251], v12, s[16:19], 0 offen offset:0 sc1
    buffer_load_dword v252, v8, s[16:19], 0 offen offset:0 sc1
    s_waitcnt vmcnt(0)
    v_and_b32 v248, v248, v249
    v_and_b32 v248, v248, v250
    v_and_b32 v248, v248, v251
    v_and_b32 v248, v248, v252
    v_cmp_ne_u32 vcc, 1, v248
    s_mov_b64 exec, -1
    s_cbranch_vccnz K2_F3SPN
K2_F3OKN:
    s_waitcnt vmcnt(2) lgkmcnt(0)
    s_barrier
    v_exp_f32 v32, v32
    v_exp_f32 v33, v33
    v_exp_f32 v34, v34
    v_mfma_f32_32x32x16_bf16 v[48:63], v[220:223], v[20:23], v[48:63]
    s_setprio 3
    buffer_load_dword v190, v215, s[16:19], s101 offen sc1
    v_cvt_pk_bf16_f32 v32, v32, v33
    v_exp_f32 v35, v35
    v_exp_f32 v36, v36
    v_cvt_pk_bf16_f32 v33, v34, v35
    v_exp_f32 v37, v37
    v_mfma_f32_32x32x16_bf16 v[16:31], v[208:211], v[232:235], 0
    v_exp_f32 v38, v38
    v_cvt_pk_bf16_f32 v34, v36, v37
    v_exp_f32 v39, v39
    v_exp_f32 v40, v40
    v_cvt_pk_bf16_f32 v35, v38, v39
    v_mfma_f32_32x32x8_bf16 v[16:31], v[212:213], v[236:237], v[16:31]
    v_exp_f32 v41, v41
    v_exp_f32 v42, v42
    v_cvt_pk_bf16_f32 v36, v40, v41
    v_exp_f32 v43, v43
    v_exp_f32 v44, v44
    v_cvt_pk_bf16_f32 v37, v42, v43
    v_exp_f32 v45, v45
    v_exp_f32 v46, v46
    v_cvt_pk_bf16_f32 v38, v44, v45
    v_exp_f32 v47, v47
    v_mfma_f32_32x32x16_bf16 v[64:79], v[216:219], v[32:35], v[64:79]
    v_cvt_pk_bf16_f32 v39, v46, v47
    v_exp_f32 v16, v16
    v_exp_f32 v17, v17
    v_exp_f32 v18, v18
    v_mfma_f32_32x32x16_bf16 v[64:79], v[220:223], v[36:39], v[64:79]
    s_xor_b32 s5, s30, 4
    s_lshl_b32 s5, s5, 12
    s_add_u32 s5, s5, 131072
    v_add_u32 v13, s5, v11
    s_lshl_b32 s5, s30, 12
    s_add_u32 s5, s5, 131072
    v_add_u32 v184, s5, v11
    s_mul_i32 s5, s67, 245760
    s_add_u32 s5, s5, 16777216
    s_add_u32 s40, s12, s5
    s_addc_u32 s41, s13, 0
    s_mov_b32 s42, 245760
    s_mov_b32 s43, 0x00020000
    v_cvt_pk_bf16_f32 v16, v16, v17
    v_exp_f32 v19, v19
    v_exp_f32 v20, v20
    v_cvt_pk_bf16_f32 v17, v18, v19
    v_exp_f32 v21, v21
    v_mfma_f32_32x32x16_bf16 v[32:47], v[208:211], v[238:241], 0
    ds_read_b128 v[208:211], v4 offset:20480
    v_exp_f32 v22, v22
    v_cvt_pk_bf16_f32 v18, v20, v21
    v_exp_f32 v23, v23
    v_exp_f32 v24, v24
    v_cvt_pk_bf16_f32 v19, v22, v23
    v_mfma_f32_32x32x8_bf16 v[32:47], v[212:213], v[242:243], v[32:47]
    s_mov_b64 exec, s[34:35]
    ds_read_b64 v[212:213], v5 offset:21504
    s_mov_b64 exec, s[32:33]
    ds_read_b128 v[216:219], v6 offset:21760
    ds_read_b128 v[220:223], v6 offset:22400
    s_mov_b64 exec, -1
    v_exp_f32 v25, v25
    v_exp_f32 v26, v26
    v_cvt_pk_bf16_f32 v20, v24, v25
    v_exp_f32 v27, v27
    v_exp_f32 v28, v28
    v_cvt_pk_bf16_f32 v21, v26, v27
    v_exp_f32 v29, v29
    v_exp_f32 v30, v30
    v_cvt_pk_bf16_f32 v22, v28, v29
    v_exp_f32 v31, v31
    v_mfma_f32_32x32x16_bf16 v[48:63], v[224:227], v[16:19], v[48:63]
    v_cvt_pk_bf16_f32 v23, v30, v31
    v_exp_f32 v32, v32
    v_exp_f32 v33, v33
    v_exp_f32 v34, v34
    v_mfma_f32_32x32x16_bf16 v[48:63], v[228:231], v[20:23], v[48:63]
    s_setprio 2
    s_waitcnt lgkmcnt(2)
    v_cvt_pk_bf16_f32 v32, v32, v33
    v_exp_f32 v35, v35
    v_exp_f32 v36, v36
    v_cvt_pk_bf16_f32 v33, v34, v35
    v_exp_f32 v37, v37
    v_mfma_f32_32x32x16_bf16 v[16:31], v[208:211], v[232:235], 0
    v_exp_f32 v38, v38
    v_cvt_pk_bf16_f32 v34, v36, v37
    v_exp_f32 v39, v39
    v_exp_f32 v40, v40
    v_cvt_pk_bf16_f32 v35, v38, v39
    v_mfma_f32_32x32x8_bf16 v[16:31], v[212:213], v[236:237], v[16:31]
    s_waitcnt lgkmcnt(0)
    v_exp_f32 v41, v41
    v_exp_f32 v42, v42
    v_cvt_pk_bf16_f32 v36, v40, v41
    v_exp_f32 v43, v43
    v_exp_f32 v44, v44
    v_cvt_pk_bf16_f32 v37, v42, v43
    v_exp_f32 v45, v45
    v_exp_f32 v46, v46
    v_cvt_pk_bf16_f32 v38, v44, v45
    v_exp_f32 v47, v47
    v_mfma_f32_32x32x16_bf16 v[64:79], v[224:227], v[32:35], v[64:79]
    v_cvt_pk_bf16_f32 v39, v46, v47
    v_exp_f32 v16, v16
    v_exp_f32 v17, v17
    v_exp_f32 v18, v18
    v_mfma_f32_32x32x16_bf16 v[64:79], v[228:231], v[36:39], v[64:79]
    s_setprio 1
    v_cvt_pk_bf16_f32 v16, v16, v17
    v_exp_f32 v19, v19
    v_exp_f32 v20, v20
    v_cvt_pk_bf16_f32 v17, v18, v19
    v_exp_f32 v21, v21
    v_mfma_f32_32x32x16_bf16 v[32:47], v[208:211], v[238:241], 0
    ds_read_b128 v[208:211], v4 offset:30720
    v_exp_f32 v22, v22
    v_cvt_pk_bf16_f32 v18, v20, v21
    v_exp_f32 v23, v23
    v_exp_f32 v24, v24
    v_cvt_pk_bf16_f32 v19, v22, v23
    v_mfma_f32_32x32x8_bf16 v[32:47], v[212:213], v[242:243], v[32:47]
    s_mov_b64 exec, s[34:35]
    ds_read_b64 v[212:213], v5 offset:31744
    s_mov_b64 exec, s[32:33]
    ds_read_b128 v[224:227], v6 offset:32000
    ds_read_b128 v[228:231], v6 offset:32640
    s_mov_b64 exec, -1
    v_exp_f32 v25, v25
    v_exp_f32 v26, v26
    v_cvt_pk_bf16_f32 v20, v24, v25
    v_exp_f32 v27, v27
    v_exp_f32 v28, v28
    v_cvt_pk_bf16_f32 v21, v26, v27
    v_exp_f32 v29, v29
    v_exp_f32 v30, v30
    v_cvt_pk_bf16_f32 v22, v28, v29
    v_exp_f32 v31, v31
    v_mfma_f32_32x32x16_bf16 v[48:63], v[216:219], v[16:19], v[48:63]
    v_cvt_pk_bf16_f32 v23, v30, v31
    v_exp_f32 v32, v32
    v_exp_f32 v33, v33
    v_exp_f32 v34, v34
    v_mfma_f32_32x32x16_bf16 v[48:63], v[220:223], v[20:23], v[48:63]
    s_setprio 0
    s_waitcnt lgkmcnt(2)
    v_cvt_pk_bf16_f32 v32, v32, v33
    v_exp_f32 v35, v35
    v_exp_f32 v36, v36
    v_cvt_pk_bf16_f32 v33, v34, v35
    v_exp_f32 v37, v37
    v_mfma_f32_32x32x16_bf16 v[16:31], v[208:211], v[232:235], 0
    v_exp_f32 v38, v38
    v_cvt_pk_bf16_f32 v34, v36, v37
    v_exp_f32 v39, v39
    v_exp_f32 v40, v40
    v_cvt_pk_bf16_f32 v35, v38, v39
    v_mfma_f32_32x32x8_bf16 v[16:31], v[212:213], v[236:237], v[16:31]
    s_waitcnt lgkmcnt(0)
    v_exp_f32 v41, v41
    v_exp_f32 v42, v42
    v_cvt_pk_bf16_f32 v36, v40, v41
    v_exp_f32 v43, v43
    v_exp_f32 v44, v44
    v_cvt_pk_bf16_f32 v37, v42, v43
    v_exp_f32 v45, v45
    v_exp_f32 v46, v46
    v_cvt_pk_bf16_f32 v38, v44, v45
    v_exp_f32 v47, v47
    v_mfma_f32_32x32x16_bf16 v[64:79], v[216:219], v[32:35], v[64:79]
    v_cvt_pk_bf16_f32 v39, v46, v47
    s_barrier
    v_exp_f32 v16, v16
    v_exp_f32 v17, v17
    v_exp_f32 v18, v18
    v_mfma_f32_32x32x16_bf16 v[64:79], v[220:223], v[36:39], v[64:79]
    s_setprio 3
    v_cvt_pk_bf16_f32 v16, v16, v17
    v_exp_f32 v19, v19
    v_exp_f32 v20, v20
    v_cvt_pk_bf16_f32 v17, v18, v19
    v_exp_f32 v21, v21
    v_mfma_f32_32x32x16_bf16 v[32:47], v[208:211], v[238:241], 0
    ds_read_b128 v[208:211], v4 offset:33280
    v_exp_f32 v22, v22
    v_cvt_pk_bf16_f32 v18, v20, v21
    v_exp_f32 v23, v23
    v_exp_f32 v24, v24
    v_cvt_pk_bf16_f32 v19, v22, v23
    v_mfma_f32_32x32x8_bf16 v[32:47], v[212:213], v[242:243], v[32:47]
    s_mov_b64 exec, s[34:35]
    ds_read_b64 v[212:213], v5 offset:34304
    s_mov_b64 exec, s[32:33]
    ds_read_b128 v[216:219], v6 offset:34560
    ds_read_b128 v[220:223], v6 offset:35200
    s_mov_b64 exec, -1
    v_exp_f32 v25, v25
    v_exp_f32 v26, v26
    v_cvt_pk_bf16_f32 v20, v24, v25
    v_exp_f32 v27, v27
    v_exp_f32 v28, v28
    v_cvt_pk_bf16_f32 v21, v26, v27
    v_exp_f32 v29, v29
    v_exp_f32 v30, v30
    v_cvt_pk_bf16_f32 v22, v28, v29
    v_exp_f32 v31, v31
    v_mfma_f32_32x32x16_bf16 v[48:63], v[224:227], v[16:19], v[48:63]
    v_cvt_pk_bf16_f32 v23, v30, v31
    v_exp_f32 v32, v32
    v_exp_f32 v33, v33
    v_exp_f32 v34, v34
    v_mfma_f32_32x32x16_bf16 v[48:63], v[228:231], v[20:23], v[48:63]
    s_setprio 2
    s_waitcnt lgkmcnt(2)
    s_mul_i32 s5, s30, 7680
    s_add_u32 m0, s5, 61440
    s_add_u32 s6, s5, 102400
    buffer_load_dwordx4 v11, s[40:43], s6 offen sc1 lds
    v_cvt_pk_bf16_f32 v32, v32, v33
    v_exp_f32 v35, v35
    v_exp_f32 v36, v36
    v_cvt_pk_bf16_f32 v33, v34, v35
    v_exp_f32 v37, v37
    v_mfma_f32_32x32x16_bf16 v[16:31], v[208:211], v[232:235], 0
    s_mul_i32 s5, s30, 7680
    s_add_u32 m0, s5, 62464
    s_add_u32 s6, s5, 103424
    buffer_load_dwordx4 v11, s[40:43], s6 offen sc1 lds
    v_exp_f32 v38, v38
    v_cvt_pk_bf16_f32 v34, v36, v37
    v_exp_f32 v39, v39
    v_exp_f32 v40, v40
    v_cvt_pk_bf16_f32 v35, v38, v39
    v_mfma_f32_32x32x8_bf16 v[16:31], v[212:213], v[236:237], v[16:31]
    s_waitcnt lgkmcnt(0)
    s_mul_i32 s5, s30, 7680
    s_add_u32 m0, s5, 63488
    s_add_u32 s6, s5, 104448
    buffer_load_dwordx4 v11, s[40:43], s6 offen sc1 lds
    v_exp_f32 v41, v41
    v_exp_f32 v42, v42
    v_cvt_pk_bf16_f32 v36, v40, v41
    v_exp_f32 v43, v43
    v_exp_f32 v44, v44
    v_cvt_pk_bf16_f32 v37, v42, v43
    v_exp_f32 v45, v45
    v_exp_f32 v46, v46
    v_cvt_pk_bf16_f32 v38, v44, v45
    v_exp_f32 v47, v47
    v_mfma_f32_32x32x16_bf16 v[64:79], v[224:227], v[32:35], v[64:79]
    v_cvt_pk_bf16_f32 v39, v46, v47
    v_exp_f32 v16, v16
    v_exp_f32 v17, v17
    v_exp_f32 v18, v18
    v_mfma_f32_32x32x16_bf16 v[64:79], v[228:231], v[36:39], v[64:79]
    s_setprio 1
    s_mul_i32 s5, s30, 7680
    s_add_u32 m0, s5, 64512
    s_add_u32 s6, s5, 105472
    buffer_load_dwordx4 v11, s[40:43], s6 offen sc1 lds
    v_cvt_pk_bf16_f32 v16, v16, v17
    v_exp_f32 v19, v19
    v_exp_f32 v20, v20
    v_cvt_pk_bf16_f32 v17, v18, v19
    v_exp_f32 v21, v21
    v_mfma_f32_32x32x16_bf16 v[32:47], v[208:211], v[238:241], 0
    ds_read_b128 v[208:211], v4 offset:35840
    v_exp_f32 v22, v22
    v_cvt_pk_bf16_f32 v18, v20, v21
    v_exp_f32 v23, v23
    v_exp_f32 v24, v24
    v_cvt_pk_bf16_f32 v19, v22, v23
    v_mfma_f32_32x32x8_bf16 v[32:47], v[212:213], v[242:243], v[32:47]
    s_mov_b64 exec, s[34:35]
    ds_read_b64 v[212:213], v5 offset:36864
    s_mov_b64 exec, s[32:33]
    ds_read_b128 v[224:227], v6 offset:37120
    ds_read_b128 v[228:231], v6 offset:37760
    s_mov_b64 exec, -1
    v_exp_f32 v25, v25
    v_exp_f32 v26, v26
    v_cvt_pk_bf16_f32 v20, v24, v25
    v_exp_f32 v27, v27
    v_exp_f32 v28, v28
    v_cvt_pk_bf16_f32 v21, v26, v27
    v_exp_f32 v29, v29
    v_exp_f32 v30, v30
    v_cvt_pk_bf16_f32 v22, v28, v29
    v_exp_f32 v31, v31
    v_mfma_f32_32x32x16_bf16 v[48:63], v[216:219], v[16:19], v[48:63]
    s_mul_i32 s5, s30, 7680
    s_add_u32 m0, s5, 65536
    s_add_u32 s6, s5, 106496
    buffer_load_dwordx4 v11, s[40:43], s6 offen sc1 lds
    s_mul_i32 s5, s30, 7680
    s_add_u32 m0, s5, 66560
    s_add_u32 s6, s5, 107520
    buffer_load_dwordx4 v11, s[40:43], s6 offen sc1 lds
    v_cvt_pk_bf16_f32 v23, v30, v31
    v_exp_f32 v32, v32
    v_exp_f32 v33, v33
    v_exp_f32 v34, v34
    v_mfma_f32_32x32x16_bf16 v[48:63], v[220:223], v[20:23], v[48:63]
    s_setprio 0
    s_waitcnt lgkmcnt(2)
    s_mul_i32 s5, s30, 7680
    s_add_u32 m0, s5, 67584
    s_add_u32 s6, s5, 108544
    buffer_load_dwordx4 v11, s[40:43], s6 offen sc1 lds
    v_cvt_pk_bf16_f32 v32, v32, v33
    v_exp_f32 v35, v35
    v_exp_f32 v36, v36
    v_cvt_pk_bf16_f32 v33, v34, v35
    v_exp_f32 v37, v37
    v_mfma_f32_32x32x16_bf16 v[16:31], v[208:211], v[232:235], 0
    s_mul_i32 s5, s30, 7680
    s_add_u32 m0, s5, 68608
    s_add_u32 s6, s5, 109568
    s_mov_b32 exec_lo, 0xffffffff
    s_mov_b32 exec_hi, 0x0
    buffer_load_dwordx4 v11, s[40:43], s6 offen sc1 lds
    s_mov_b64 exec, -1
    v_exp_f32 v38, v38
    v_cvt_pk_bf16_f32 v34, v36, v37
    v_exp_f32 v39, v39
    v_exp_f32 v40, v40
    v_cvt_pk_bf16_f32 v35, v38, v39
    v_mfma_f32_32x32x8_bf16 v[16:31], v[212:213], v[236:237], v[16:31]
    s_waitcnt lgkmcnt(0)
    v_exp_f32 v41, v41
    v_exp_f32 v42, v42
    v_cvt_pk_bf16_f32 v36, v40, v41
    v_exp_f32 v43, v43
    v_exp_f32 v44, v44
    v_cvt_pk_bf16_f32 v37, v42, v43
    v_exp_f32 v45, v45
    v_exp_f32 v46, v46
    v_cvt_pk_bf16_f32 v38, v44, v45
    v_exp_f32 v47, v47
    v_mfma_f32_32x32x16_bf16 v[64:79], v[216:219], v[32:35], v[64:79]
    v_cvt_pk_bf16_f32 v39, v46, v47
    s_waitcnt vmcnt(9)
    s_barrier
    v_exp_f32 v16, v16
    v_exp_f32 v17, v17
    v_exp_f32 v18, v18
    v_mfma_f32_32x32x16_bf16 v[64:79], v[220:223], v[36:39], v[64:79]
    s_setprio 3
    s_mul_i32 s5, s30, 5120
    s_add_u32 m0, s5, 0
    s_add_u32 s6, s5, 163840
    buffer_load_dwordx4 v11, s[40:43], s6 offen sc1 lds
    v_cvt_pk_bf16_f32 v16, v16, v17
    v_exp_f32 v19, v19
    v_exp_f32 v20, v20
    v_cvt_pk_bf16_f32 v17, v18, v19
    v_exp_f32 v21, v21
    v_mfma_f32_32x32x16_bf16 v[32:47], v[208:211], v[238:241], 0
    ds_read_b128 v[208:211], v4 offset:46080
    v_exp_f32 v22, v22
    v_cvt_pk_bf16_f32 v18, v20, v21
    v_exp_f32 v23, v23
    v_exp_f32 v24, v24
    v_cvt_pk_bf16_f32 v19, v22, v23
    v_mfma_f32_32x32x8_bf16 v[32:47], v[212:213], v[242:243], v[32:47]
    s_mov_b64 exec, s[34:35]
    ds_read_b64 v[212:213], v5 offset:47104
    s_mov_b64 exec, s[32:33]
    ds_read_b128 v[216:219], v6 offset:47360
    ds_read_b128 v[220:223], v6 offset:48000
    s_mov_b64 exec, -1
    v_exp_f32 v25, v25
    v_exp_f32 v26, v26
    v_cvt_pk_bf16_f32 v20, v24, v25
    v_exp_f32 v27, v27
    v_exp_f32 v28, v28
    v_cvt_pk_bf16_f32 v21, v26, v27
    v_exp_f32 v29, v29
    v_exp_f32 v30, v30
    v_cvt_pk_bf16_f32 v22, v28, v29
    v_exp_f32 v31, v31
    v_mfma_f32_32x32x16_bf16 v[48:63], v[224:227], v[16:19], v[48:63]
    s_mul_i32 s5, s30, 5120
    s_add_u32 m0, s5, 1024
    s_add_u32 s6, s5, 164864
    buffer_load_dwordx4 v11, s[40:43], s6 offen sc1 lds
    s_mul_i32 s5, s30, 5120
    s_add_u32 m0, s5, 2048
    s_add_u32 s6, s5, 165888
    buffer_load_dwordx4 v11, s[40:43], s6 offen sc1 lds
    v_cvt_pk_bf16_f32 v23, v30, v31
    v_exp_f32 v32, v32
    v_exp_f32 v33, v33
    v_exp_f32 v34, v34
    v_mfma_f32_32x32x16_bf16 v[48:63], v[228:231], v[20:23], v[48:63]
    s_setprio 2
    s_waitcnt lgkmcnt(2)
    s_mul_i32 s5, s30, 5120
    s_add_u32 m0, s5, 3072
    s_add_u32 s6, s5, 166912
    buffer_load_dwordx4 v11, s[40:43], s6 offen sc1 lds
    v_cvt_pk_bf16_f32 v32, v32, v33
    v_exp_f32 v35, v35
    v_exp_f32 v36, v36
    v_cvt_pk_bf16_f32 v33, v34, v35
    v_exp_f32 v37, v37
    v_mfma_f32_32x32x16_bf16 v[16:31], v[208:211], v[232:235], 0
    s_mul_i32 s5, s30, 5120
    s_add_u32 m0, s5, 4096
    s_add_u32 s6, s5, 167936
    buffer_load_dwordx4 v11, s[40:43], s6 offen sc1 lds
    v_exp_f32 v38, v38
    v_cvt_pk_bf16_f32 v34, v36, v37
    v_exp_f32 v39, v39
    v_exp_f32 v40, v40
    v_cvt_pk_bf16_f32 v35, v38, v39
    v_mfma_f32_32x32x8_bf16 v[16:31], v[212:213], v[236:237], v[16:31]
    s_waitcnt lgkmcnt(0)
    s_lshl_b32 s62, s36, 1
    s_add_u32 s62, s62, s48
    s_mul_i32 s5, s62, 96256
    s_lshl_b32 s6, s46, 11
    s_add_u32 s5, s5, s6
    s_add_u32 s5, s5, 10485760
    v_and_b32 v246, 15, v1
    s_lshl_b32 s6, s47, 4
    v_add_u32 v246, s6, v246
    v_lshrrev_b32 v247, 4, v1
    v_lshl_add_u32 v244, v247, 9, s5
    v_lshl_add_u32 v9, v246, 4, v244
    v_lshl_add_u32 v10, v246, 3, v244
    s_lshl_b32 s5, s62, 5
    v_add_u32 v244, s5, v246
    s_movk_i32 s6, 1280
    v_mul_lo_u32 v244, v244, s6
    v_lshl_add_u32 v244, v247, 3, v244
    s_mul_i32 s5, s67, 160
    v_add_u32 v7, s5, v244
    s_mul_i32 s5, s46, 5120
    s_add_u32 s5, s5, 61440
    v_add_u32 v186, s5, v11
    v_lshrrev_b32 v244, 3, v1
    v_min_u32 v244, 6, v244
    v_lshlrev_b32 v244, 10, v244
    v_and_b32 v245, 7, v1
    v_lshl_add_u32 v244, v245, 2, v244
    s_lshl_b32 s5, s36, 5
    s_add_u32 s5, s5, 3080192
    v_add_u32 v191, s5, v244
    s_lshl_b32 s5, s36, 8
    s_add_u32 s5, s5, 3088384
    v_lshl_add_u32 v185, v1, 2, s5
    s_lshl_b32 s5, s28, 8
    s_add_u32 s5, s5, 3088384
    s_lshl_b32 s6, s29, 3
    s_add_u32 s6, s6, s30
    s_lshl_b32 s6, s6, 2
    s_add_u32 s5, s5, s6
    v_mov_b32 v15, s5
    v_exp_f32 v41, v41
    v_exp_f32 v42, v42
    v_cvt_pk_bf16_f32 v36, v40, v41
    v_exp_f32 v43, v43
    v_exp_f32 v44, v44
    v_cvt_pk_bf16_f32 v37, v42, v43
    v_exp_f32 v45, v45
    v_exp_f32 v46, v46
    v_cvt_pk_bf16_f32 v38, v44, v45
    v_exp_f32 v47, v47
    v_mfma_f32_32x32x16_bf16 v[64:79], v[224:227], v[32:35], v[64:79]
    v_cvt_pk_bf16_f32 v39, v46, v47
    v_exp_f32 v16, v16
    v_exp_f32 v17, v17
    v_exp_f32 v18, v18
    v_mfma_f32_32x32x16_bf16 v[64:79], v[228:231], v[36:39], v[64:79]
    s_setprio 1
    v_cvt_pk_bf16_f32 v16, v16, v17
    v_exp_f32 v19, v19
    v_exp_f32 v20, v20
    v_cvt_pk_bf16_f32 v17, v18, v19
    v_exp_f32 v21, v21
    v_mfma_f32_32x32x16_bf16 v[32:47], v[208:211], v[238:241], 0
    ds_read_b128 v[208:211], v4 offset:48640
    v_exp_f32 v22, v22
    v_cvt_pk_bf16_f32 v18, v20, v21
    v_exp_f32 v23, v23
    v_exp_f32 v24, v24
    v_cvt_pk_bf16_f32 v19, v22, v23
    v_mfma_f32_32x32x8_bf16 v[32:47], v[212:213], v[242:243], v[32:47]
    s_mov_b64 exec, s[34:35]
    ds_read_b64 v[212:213], v5 offset:49664
    s_mov_b64 exec, s[32:33]
    ds_read_b128 v[224:227], v6 offset:49920
    ds_read_b128 v[228:231], v6 offset:50560
    s_mov_b64 exec, -1
    v_exp_f32 v25, v25
    v_exp_f32 v26, v26
    v_cvt_pk_bf16_f32 v20, v24, v25
    v_exp_f32 v27, v27
    v_exp_f32 v28, v28
    v_cvt_pk_bf16_f32 v21, v26, v27
    v_exp_f32 v29, v29
    v_exp_f32 v30, v30
    v_cvt_pk_bf16_f32 v22, v28, v29
    v_exp_f32 v31, v31
    v_mfma_f32_32x32x16_bf16 v[48:63], v[216:219], v[16:19], v[48:63]
    v_cvt_pk_bf16_f32 v23, v30, v31
    s_waitcnt vmcnt(5) lgkmcnt(0)
    s_barrier
    v_exp_f32 v32, v32
    v_exp_f32 v33, v33
    v_exp_f32 v34, v34
    v_mfma_f32_32x32x16_bf16 v[48:63], v[220:223], v[20:23], v[48:63]
    s_setprio 3
    ds_read_b128 v[80:83], v186 offset:0
    ds_read_b128 v[84:87], v186 offset:1024
    ds_read_b128 v[88:91], v186 offset:2048
    ds_read_b128 v[92:95], v186 offset:3072
    ds_read_b128 v[96:99], v186 offset:4096
    v_cvt_pk_bf16_f32 v32, v32, v33
    v_exp_f32 v35, v35
    v_exp_f32 v36, v36
    v_cvt_pk_bf16_f32 v33, v34, v35
    v_exp_f32 v37, v37
    v_mfma_f32_32x32x16_bf16 v[16:31], v[208:211], v[232:235], 0
    ds_read_b128 v[100:103], v186 offset:10240
    ds_read_b128 v[104:107], v186 offset:11264
    ds_read_b128 v[108:111], v186 offset:12288
    ds_read_b128 v[112:115], v186 offset:13312
    ds_read_b128 v[116:119], v186 offset:14336
    v_exp_f32 v38, v38
    v_cvt_pk_bf16_f32 v34, v36, v37
    v_exp_f32 v39, v39
    v_exp_f32 v40, v40
    v_cvt_pk_bf16_f32 v35, v38, v39
    v_mfma_f32_32x32x8_bf16 v[16:31], v[212:213], v[236:237], v[16:31]
    v_exp_f32 v41, v41
    v_exp_f32 v42, v42
    v_cvt_pk_bf16_f32 v36, v40, v41
    v_exp_f32 v43, v43
    v_exp_f32 v44, v44
    v_cvt_pk_bf16_f32 v37, v42, v43
    v_exp_f32 v45, v45
    v_exp_f32 v46, v46
    v_cvt_pk_bf16_f32 v38, v44, v45
    v_exp_f32 v47, v47
    v_mfma_f32_32x32x16_bf16 v[64:79], v[216:219], v[32:35], v[64:79]
    v_cvt_pk_bf16_f32 v39, v46, v47
    v_exp_f32 v16, v16
    v_exp_f32 v17, v17
    v_exp_f32 v18, v18
    v_mfma_f32_32x32x16_bf16 v[64:79], v[220:223], v[36:39], v[64:79]
    s_setprio 2
    s_cmp_lg_u32 s30, 4
    s_cbranch_scc1 K2_F4IN
    buffer_load_dword v248, v191, s[16:19], 0 offen offset:0 sc1
K2_F4IN:
    v_cvt_pk_bf16_f32 v16, v16, v17
    v_exp_f32 v19, v19
    v_exp_f32 v20, v20
    v_cvt_pk_bf16_f32 v17, v18, v19
    v_exp_f32 v21, v21
    v_mfma_f32_32x32x16_bf16 v[32:47], v[208:211], v[238:241], 0
    ds_read_b128 v[120:123], v186 offset:20480
    ds_read_b128 v[124:127], v186 offset:21504
    ds_read_b128 v[128:131], v186 offset:22528
    ds_read_b128 v[132:135], v186 offset:23552
    ds_read_b128 v[136:139], v186 offset:24576
    v_exp_f32 v22, v22
    v_cvt_pk_bf16_f32 v18, v20, v21
    v_exp_f32 v23, v23
    v_exp_f32 v24, v24
    v_cvt_pk_bf16_f32 v19, v22, v23
    v_mfma_f32_32x32x8_bf16 v[32:47], v[212:213], v[242:243], v[32:47]
    ds_read_b128 v[140:143], v186 offset:30720
    ds_read_b128 v[144:147], v186 offset:31744
    ds_read_b128 v[148:151], v186 offset:32768
    ds_read_b128 v[152:155], v186 offset:33792
    ds_read_b128 v[156:159], v186 offset:34816
    v_exp_f32 v25, v25
    v_exp_f32 v26, v26
    v_cvt_pk_bf16_f32 v20, v24, v25
    v_exp_f32 v27, v27
    v_exp_f32 v28, v28
    v_cvt_pk_bf16_f32 v21, v26, v27
    v_exp_f32 v29, v29
    v_exp_f32 v30, v30
    v_cvt_pk_bf16_f32 v22, v28, v29
    v_exp_f32 v31, v31
    v_mfma_f32_32x32x16_bf16 v[48:63], v[224:227], v[16:19], v[48:63]
    v_cvt_pk_bf16_f32 v23, v30, v31
    v_exp_f32 v32, v32
    v_exp_f32 v33, v33
    v_exp_f32 v34, v34
    v_mfma_f32_32x32x16_bf16 v[48:63], v[228:231], v[20:23], v[48:63]
    s_setprio 1
    ds_read_b128 v[160:163], v186 offset:40960
    ds_read_b128 v[164:167], v186 offset:41984
    ds_read_b128 v[168:171], v186 offset:43008
    ds_read_b128 v[172:175], v186 offset:44032
    ds_read_b128 v[176:179], v186 offset:45056
    v_cvt_pk_bf16_f32 v32, v32, v33
    v_exp_f32 v35, v35
    v_exp_f32 v36, v36
    v_cvt_pk_bf16_f32 v33, v34, v35
    v_exp_f32 v37, v37
    v_exp_f32 v38, v38
    v_cvt_pk_bf16_f32 v34, v36, v37
    v_exp_f32 v39, v39
    v_exp_f32 v40, v40
    v_cvt_pk_bf16_f32 v35, v38, v39
    v_exp_f32 v41, v41
    v_exp_f32 v42, v42
    v_cvt_pk_bf16_f32 v36, v40, v41
    v_exp_f32 v43, v43
    v_exp_f32 v44, v44
    v_cvt_pk_bf16_f32 v37, v42, v43
    v_exp_f32 v45, v45
    v_exp_f32 v46, v46
    v_cvt_pk_bf16_f32 v38, v44, v45
    v_exp_f32 v47, v47
    v_mfma_f32_32x32x16_bf16 v[64:79], v[224:227], v[32:35], v[64:79]
    ds_write_b128 v13, v[48:51] offset:0
    ds_write_b128 v13, v[52:55] offset:1024
    ds_write_b128 v13, v[56:59] offset:2048
    ds_write_b128 v13, v[60:63] offset:3072
    v_cvt_pk_bf16_f32 v39, v46, v47
    s_cmp_lg_u32 s30, 4
    s_cbranch_scc1 K2_F4OKN
    s_waitcnt vmcnt(0)
    v_cmp_ne_u32 vcc, 1, v248
    s_cmp_eq_u64 vcc, 0
    s_cselect_b32 s5, 1, 0
    v_mov_b32 v248, s5
    v_mov_b32 v249, 122880
    ds_write_b32 v249, v248
    s_waitcnt lgkmcnt(0)
K2_F4OKN:
    s_waitcnt vmcnt(0) lgkmcnt(0)
K2_EPI:
    s_nop 1
    v_mfma_f32_32x32x16_bf16 v[64:79], v[228:231], v[36:39], v[64:79]
    v_mov_b32 v12, 122880
    s_barrier
    ds_read_b32 v12, v12
    ds_read_b128 v[48:51], v184 offset:0
    ds_read_b128 v[52:55], v184 offset:1024
    ds_read_b128 v[56:59], v184 offset:2048
    ds_read_b128 v[60:63], v184 offset:3072
    s_waitcnt lgkmcnt(4)
    v_readfirstlane_b32 s49, v12
    s_nop 3
    s_cmp_eq_u32 s49, 0
    s_cbranch_scc1 K2_OFIN
    s_mov_b32 s7, 40960
    buffer_load_dwordx4 v[32:35], v9, s[16:19], s7 offen sc1
    s_mov_b32 s7, 45056
    buffer_load_dwordx4 v[36:39], v9, s[16:19], s7 offen sc1
    s_mov_b32 s7, 49152
    buffer_load_dwordx4 v[40:43], v9, s[16:19], s7 offen sc1
    s_mov_b32 s7, 53248
    buffer_load_dwordx4 v[44:47], v9, s[16:19], s7 offen sc1
    s_mov_b32 s7, 57344
    buffer_load_dwordx4 v[192:195], v9, s[16:19], s7 offen sc1
    s_mov_b32 s7, 61440
    buffer_load_dwordx4 v[196:199], v9, s[16:19], s7 offen sc1
K2_OFIN:
    s_waitcnt lgkmcnt(0)
    v_pk_add_f32 v[48:49], v[48:49], v[64:65]
    v_pk_add_f32 v[50:51], v[50:51], v[66:67]
    v_pk_add_f32 v[52:53], v[52:53], v[68:69]
    v_pk_add_f32 v[54:55], v[54:55], v[70:71]
    v_pk_add_f32 v[56:57], v[56:57], v[72:73]
    v_pk_add_f32 v[58:59], v[58:59], v[74:75]
    v_pk_add_f32 v[60:61], v[60:61], v[76:77]
    v_mov_b32 v244, v60
    v_fma_f32 v244, v48, 0, v244
    v_fma_f32 v244, v49, 0, v244
    v_fma_f32 v244, v50, 0, v244
    v_fma_f32 v244, v51, 0, v244
    v_fma_f32 v244, v52, 0, v244
    v_fma_f32 v244, v53, 0, v244
    v_fma_f32 v244, v54, 0, v244
    v_fma_f32 v244, v55, 0, v244
    v_fma_f32 v244, v56, 0, v244
    v_fma_f32 v244, v57, 0, v244
    v_fma_f32 v244, v58, 0, v244
    v_fma_f32 v244, v59, 0, v244
    s_mov_b32 s5, 0x5d800000
    v_cmp_ngt_f32 vcc, s5, v244
    s_cbranch_vccnz K2_FALLBACK
K2_OSTORE:
    v_rcp_f32 v244, v60
    s_mul_i32 s5, s50, 94
    s_lshl_b32 s5, s5, 10
    s_add_u32 s5, s5, 10485760
    v_mul_f32 v244, v244, v190
    v_mov_b32 v245, v244
    s_lshl_b32 s6, s51, 10
    s_add_u32 s6, s6, s5
    s_lshl_b32 s7, s51, 8
    s_add_u32 s7, s7, s5
    s_add_u32 s7, s7, 32768
    v_lshlrev_b32 v248, 3, v2
    v_pk_mul_f32 v[48:49], v[48:49], v[244:245]
    v_pk_mul_f32 v[50:51], v[50:51], v[244:245]
    v_pk_mul_f32 v[52:53], v[52:53], v[244:245]
    v_pk_mul_f32 v[54:55], v[54:55], v[244:245]
    v_pk_mul_f32 v[56:57], v[56:57], v[244:245]
    v_pk_mul_f32 v[58:59], v[58:59], v[244:245]
    v_cvt_pk_bf16_f32 v64, v48, v49
    v_cvt_pk_bf16_f32 v65, v50, v51
    v_cvt_pk_bf16_f32 v66, v52, v53
    v_cvt_pk_bf16_f32 v67, v54, v55
    v_cvt_pk_bf16_f32 v68, v56, v57
    v_cvt_pk_bf16_f32 v69, v58, v59
    buffer_store_dwordx4 v[64:67], v11, s[16:19], s6 offen sc1
    s_mov_b64 exec, s[34:35]
    buffer_store_dwordx2 v[68:69], v248, s[16:19], s7 offen sc1
    s_mov_b64 exec, -1
    s_load_dwordx2 s[8:9], s[0:1], 88
    s_mul_i32 s5, s46, 5120
    v_add_u32 v4, s5, v11
    v_add_u32 v5, 61440, v4
    v_add_u32 v6, 122880, v4
    v_mov_b32 v13, v185
    v_mov_b32 v220, v191
    s_and_b32 s5, s30, 3
    s_mul_i32 s5, s5, 5120
    s_add_u32 s5, s5, 20480
    v_add_u32 v8, s5, v11
    s_waitcnt lgkmcnt(0)
    s_mov_b32 s20, s8
    s_mov_b32 s21, s9
    s_mov_b32 s22, 2621440
    s_mov_b32 s23, 0x00020000
    s_cmp_lg_u32 s49, 0
    s_cbranch_scc1 K2_UJOIN
    s_waitcnt vmcnt(0)
    s_mov_b64 exec, 1
    buffer_store_dword v14, v15, s[16:19], 0 offen sc1
    s_mov_b64 exec, -1
    s_cmp_lg_u32 s30, 4
    s_cbranch_scc1 K2_UOK
K2_USPIN:
    buffer_load_dword v12, v220, s[16:19], 0 offen sc1
    s_waitcnt vmcnt(0)
    v_cmp_ne_u32 vcc, 1, v12
    s_cbranch_vccz K2_UOK
    s_cmp_eq_u32 s96, 0
    s_cbranch_scc1 K2_UOK
    s_sub_u32 s96, s96, 1
    s_sleep 8
    s_branch K2_USPIN
K2_UOK:
    s_barrier
    s_mov_b32 s7, 40960
    buffer_load_dwordx4 v[32:35], v9, s[16:19], s7 offen sc1
    s_mov_b32 s7, 45056
    buffer_load_dwordx4 v[36:39], v9, s[16:19], s7 offen sc1
    s_mov_b32 s7, 49152
    buffer_load_dwordx4 v[40:43], v9, s[16:19], s7 offen sc1
    s_mov_b32 s7, 53248
    buffer_load_dwordx4 v[44:47], v9, s[16:19], s7 offen sc1
    s_mov_b32 s7, 57344
    buffer_load_dwordx4 v[192:195], v9, s[16:19], s7 offen sc1
    s_mov_b32 s7, 61440
    buffer_load_dwordx4 v[196:199], v9, s[16:19], s7 offen sc1
    s_waitcnt vmcnt(0)
K2_UJOIN:
    s_mul_i32 s5, s30, 5120
    s_add_u32 m0, s5, 40960
    s_add_u32 s6, s5, 204800
    buffer_load_dwordx4 v11, s[40:43], s6 offen sc1 lds
    s_mul_i32 s5, s30, 5120
    s_add_u32 m0, s5, 41984
    s_add_u32 s6, s5, 205824
    buffer_load_dwordx4 v11, s[40:43], s6 offen sc1 lds
    s_mul_i32 s5, s30, 5120
    s_add_u32 m0, s5, 43008
    s_add_u32 s6, s5, 206848
    buffer_load_dwordx4 v11, s[40:43], s6 offen sc1 lds
    s_waitcnt vmcnt(10)
    v_mfma_f32_16x16x32_bf16 v[236:239], v[80:83], v[32:35], 0
    ds_read_b128 v[80:83], v5 offset:51200
    v_mfma_f32_16x16x32_bf16 v[240:243], v[84:87], v[32:35], 0
    ds_read_b128 v[84:87], v5 offset:52224
    v_mfma_f32_16x16x32_bf16 v[244:247], v[88:91], v[32:35], 0
    ds_read_b128 v[88:91], v5 offset:53248
    v_mfma_f32_16x16x32_bf16 v[248:251], v[92:95], v[32:35], 0
    ds_read_b128 v[92:95], v5 offset:54272
    v_mfma_f32_16x16x32_bf16 v[252:255], v[96:99], v[32:35], 0
    ds_read_b128 v[96:99], v5 offset:55296
    s_mul_i32 s5, s30, 5120
    s_add_u32 m0, s5, 44032
    s_add_u32 s6, s5, 207872
    buffer_load_dwordx4 v11, s[40:43], s6 offen sc1 lds
    s_mul_i32 s5, s30, 5120
    s_add_u32 m0, s5, 45056
    s_add_u32 s6, s5, 208896
    buffer_load_dwordx4 v11, s[40:43], s6 offen sc1 lds
    s_mov_b32 s7, 65536
    buffer_load_dwordx4 v[200:203], v9, s[16:19], s7 offen sc1
    s_waitcnt vmcnt(12)
    v_mfma_f32_16x16x32_bf16 v[236:239], v[100:103], v[36:39], v[236:239]
    ds_read_b128 v[100:103], v4 offset:0
    v_mfma_f32_16x16x32_bf16 v[240:243], v[104:107], v[36:39], v[240:243]
    ds_read_b128 v[104:107], v4 offset:1024
    v_mfma_f32_16x16x32_bf16 v[244:247], v[108:111], v[36:39], v[244:247]
    ds_read_b128 v[108:111], v4 offset:2048
    v_mfma_f32_16x16x32_bf16 v[248:251], v[112:115], v[36:39], v[248:251]
    ds_read_b128 v[112:115], v4 offset:3072
    v_mfma_f32_16x16x32_bf16 v[252:255], v[116:119], v[36:39], v[252:255]
    ds_read_b128 v[116:119], v4 offset:4096
    s_mov_b32 s7, 69632
    buffer_load_dwordx4 v[204:207], v9, s[16:19], s7 offen sc1
    s_mov_b32 s7, 73728
    buffer_load_dwordx4 v[16:19], v9, s[16:19], s7 offen sc1
    s_mov_b32 s7, 77824
    buffer_load_dwordx4 v[20:23], v9, s[16:19], s7 offen sc1
    s_waitcnt vmcnt(14)
    v_mfma_f32_16x16x32_bf16 v[236:239], v[120:123], v[40:43], v[236:239]
    ds_read_b128 v[120:123], v4 offset:10240
    v_mfma_f32_16x16x32_bf16 v[240:243], v[124:127], v[40:43], v[240:243]
    ds_read_b128 v[124:127], v4 offset:11264
    v_mfma_f32_16x16x32_bf16 v[244:247], v[128:131], v[40:43], v[244:247]
    ds_read_b128 v[128:131], v4 offset:12288
    v_mfma_f32_16x16x32_bf16 v[248:251], v[132:135], v[40:43], v[248:251]
    ds_read_b128 v[132:135], v4 offset:13312
    v_mfma_f32_16x16x32_bf16 v[252:255], v[136:139], v[40:43], v[252:255]
    ds_read_b128 v[136:139], v4 offset:14336
    s_mov_b32 s7, 81920
    buffer_load_dwordx4 v[24:27], v9, s[16:19], s7 offen sc1
    s_mov_b32 s7, 86016
    buffer_load_dwordx4 v[28:31], v9, s[16:19], s7 offen sc1
    s_mov_b32 s7, 90112
    buffer_load_dwordx4 v[180:183], v9, s[16:19], s7 offen sc1
    s_waitcnt vmcnt(16)
    v_mfma_f32_16x16x32_bf16 v[236:239], v[140:143], v[44:47], v[236:239]
    ds_read_b128 v[140:143], v4 offset:20480
    v_mfma_f32_16x16x32_bf16 v[240:243], v[144:147], v[44:47], v[240:243]
    ds_read_b128 v[144:147], v4 offset:21504
    v_mfma_f32_16x16x32_bf16 v[244:247], v[148:151], v[44:47], v[244:247]
    ds_read_b128 v[148:151], v4 offset:22528
    v_mfma_f32_16x16x32_bf16 v[248:251], v[152:155], v[44:47], v[248:251]
    ds_read_b128 v[152:155], v4 offset:23552
    v_mfma_f32_16x16x32_bf16 v[252:255], v[156:159], v[44:47], v[252:255]
    ds_read_b128 v[156:159], v4 offset:24576
    s_mov_b32 s7, 94208
    buffer_load_dwordx4 v[208:211], v9, s[16:19], s7 offen sc1
    s_mul_i32 s5, s30, 3840
    s_add_u32 m0, s5, 81920
    s_add_u32 s6, s5, 0
    buffer_load_dwordx4 v11, s[40:43], s6 offen sc1 lds
    s_mul_i32 s5, s30, 3840
    s_add_u32 m0, s5, 82944
    s_add_u32 s6, s5, 1024
    buffer_load_dwordx4 v11, s[40:43], s6 offen sc1 lds
    s_waitcnt vmcnt(15)
    s_mov_b64 exec, 1
    buffer_store_dword v14, v15, s[16:19], 0 offen sc1
    s_mov_b64 exec, -1
    v_mfma_f32_16x16x32_bf16 v[236:239], v[160:163], v[192:195], v[236:239]
    ds_read_b128 v[160:163], v4 offset:30720
    v_mfma_f32_16x16x32_bf16 v[240:243], v[164:167], v[192:195], v[240:243]
    ds_read_b128 v[164:167], v4 offset:31744
    v_mfma_f32_16x16x32_bf16 v[244:247], v[168:171], v[192:195], v[244:247]
    ds_read_b128 v[168:171], v4 offset:32768
    v_mfma_f32_16x16x32_bf16 v[248:251], v[172:175], v[192:195], v[248:251]
    ds_read_b128 v[172:175], v4 offset:33792
    v_mfma_f32_16x16x32_bf16 v[252:255], v[176:179], v[192:195], v[252:255]
    ds_read_b128 v[176:179], v4 offset:34816
    s_mul_i32 s5, s30, 3840
    s_add_u32 m0, s5, 83968
    s_add_u32 s6, s5, 2048
    buffer_load_dwordx4 v11, s[40:43], s6 offen sc1 lds
    s_mul_i32 s5, s30, 3840
    s_add_u32 m0, s5, 84992
    s_add_u32 s6, s5, 3072
    s_mov_b32 exec_lo, 0xffffffff
    s_mov_b32 exec_hi, 0xffff
    buffer_load_dwordx4 v11, s[40:43], s6 offen sc1 lds
    s_mov_b64 exec, -1
    s_waitcnt vmcnt(12) lgkmcnt(0)
    s_barrier
    s_mul_i32 s5, s30, 6400
    s_add_u32 m0, s5, 112640
    s_add_u32 s6, s5, 30720
    buffer_load_dwordx4 v11, s[40:43], s6 offen sc1 lds
    s_mul_i32 s5, s30, 6400
    s_add_u32 m0, s5, 113664
    s_add_u32 s6, s5, 31744
    buffer_load_dwordx4 v11, s[40:43], s6 offen sc1 lds
    s_mul_i32 s5, s30, 6400
    s_add_u32 m0, s5, 114688
    s_add_u32 s6, s5, 32768
    buffer_load_dwordx4 v11, s[40:43], s6 offen sc1 lds
    s_mul_i32 s5, s30, 6400
    s_add_u32 m0, s5, 115712
    s_add_u32 s6, s5, 33792
    buffer_load_dwordx4 v11, s[40:43], s6 offen sc1 lds
    v_mfma_f32_16x16x32_bf16 v[236:239], v[80:83], v[196:199], v[236:239]
    s_mul_i32 s5, s30, 6400
    s_add_u32 m0, s5, 116736
    s_add_u32 s6, s5, 34816
    buffer_load_dwordx4 v11, s[40:43], s6 offen sc1 lds
    ds_read_b128 v[80:83], v4 offset:40960
    v_mfma_f32_16x16x32_bf16 v[240:243], v[84:87], v[196:199], v[240:243]
    ds_read_b128 v[84:87], v4 offset:41984
    v_mfma_f32_16x16x32_bf16 v[244:247], v[88:91], v[196:199], v[244:247]
    s_mul_i32 s5, s30, 6400
    s_add_u32 m0, s5, 117760
    s_add_u32 s6, s5, 35840
    buffer_load_dwordx4 v11, s[40:43], s6 offen sc1 lds
    ds_read_b128 v[88:91], v4 offset:43008
    v_mfma_f32_16x16x32_bf16 v[248:251], v[92:95], v[196:199], v[248:251]
    ds_read_b128 v[92:95], v4 offset:44032
    v_mfma_f32_16x16x32_bf16 v[252:255], v[96:99], v[196:199], v[252:255]
    s_mul_i32 s5, s30, 6400
    s_add_u32 m0, s5, 118784
    s_add_u32 s6, s5, 36864
    s_mov_b32 exec_lo, 0xffff
    s_mov_b32 exec_hi, 0x0
    buffer_load_dwordx4 v11, s[40:43], s6 offen sc1 lds
    s_mov_b64 exec, -1
    ds_read_b128 v[96:99], v4 offset:45056
    s_waitcnt vmcnt(18)
    v_mfma_f32_16x16x32_bf16 v[236:239], v[100:103], v[200:203], v[236:239]
    s_mul_i32 s5, s30, 2560
    s_add_u32 m0, s5, 0
    s_add_u32 s6, s5, 81920
    buffer_load_dwordx4 v11, s[40:43], s6 offen sc1 lds
    ds_read_b128 v[100:103], v4 offset:51200
    v_mfma_f32_16x16x32_bf16 v[240:243], v[104:107], v[200:203], v[240:243]
    ds_read_b128 v[104:107], v4 offset:52224
    v_mfma_f32_16x16x32_bf16 v[244:247], v[108:111], v[200:203], v[244:247]
    s_mul_i32 s5, s30, 2560
    s_add_u32 m0, s5, 1024
    s_add_u32 s6, s5, 82944
    buffer_load_dwordx4 v11, s[40:43], s6 offen sc1 lds
    ds_read_b128 v[108:111], v4 offset:53248
    v_mfma_f32_16x16x32_bf16 v[248:251], v[112:115], v[200:203], v[248:251]
    ds_read_b128 v[112:115], v4 offset:54272
    v_mfma_f32_16x16x32_bf16 v[252:255], v[116:119], v[200:203], v[252:255]
    s_mul_i32 s5, s30, 2560
    s_add_u32 m0, s5, 2048
    s_add_u32 s6, s5, 83968
    s_mov_b32 exec_lo, 0xffffffff
    s_mov_b32 exec_hi, 0x0
    buffer_load_dwordx4 v11, s[40:43], s6 offen sc1 lds
    s_mov_b64 exec, -1
    ds_read_b128 v[116:119], v4 offset:55296
    s_waitcnt vmcnt(20)
    v_mfma_f32_16x16x32_bf16 v[236:239], v[120:123], v[204:207], v[236:239]
    ds_read_b128 v[120:123], v5 offset:0
    v_mfma_f32_16x16x32_bf16 v[240:243], v[124:127], v[204:207], v[240:243]
    ds_read_b128 v[124:127], v5 offset:1024
    v_mfma_f32_16x16x32_bf16 v[244:247], v[128:131], v[204:207], v[244:247]
    ds_read_b128 v[128:131], v5 offset:2048
    v_mfma_f32_16x16x32_bf16 v[248:251], v[132:135], v[204:207], v[248:251]
    ds_read_b128 v[132:135], v5 offset:3072
    v_mfma_f32_16x16x32_bf16 v[252:255], v[136:139], v[204:207], v[252:255]
    ds_read_b128 v[136:139], v5 offset:4096
    s_waitcnt vmcnt(19)
    v_mfma_f32_16x16x32_bf16 v[236:239], v[140:143], v[16:19], v[236:239]
    ds_read_b128 v[140:143], v5 offset:10240
    v_mfma_f32_16x16x32_bf16 v[240:243], v[144:147], v[16:19], v[240:243]
    ds_read_b128 v[144:147], v5 offset:11264
    v_mfma_f32_16x16x32_bf16 v[244:247], v[148:151], v[16:19], v[244:247]
    ds_read_b128 v[148:151], v5 offset:12288
    v_mfma_f32_16x16x32_bf16 v[248:251], v[152:155], v[16:19], v[248:251]
    ds_read_b128 v[152:155], v5 offset:13312
    v_mfma_f32_16x16x32_bf16 v[252:255], v[156:159], v[16:19], v[252:255]
    ds_read_b128 v[156:159], v5 offset:14336
    s_cmp_lg_u32 s30, 4
    s_cbranch_scc1 K2_NOP2
    buffer_load_dword v12, v13, s[16:19], 0 offen sc1
K2_NOP2:
    s_waitcnt vmcnt(18)
    v_mfma_f32_16x16x32_bf16 v[236:239], v[160:163], v[20:23], v[236:239]
    v_mfma_f32_16x16x32_bf16 v[240:243], v[164:167], v[20:23], v[240:243]
    v_mfma_f32_16x16x32_bf16 v[244:247], v[168:171], v[20:23], v[244:247]
    v_mfma_f32_16x16x32_bf16 v[248:251], v[172:175], v[20:23], v[248:251]
    v_mfma_f32_16x16x32_bf16 v[252:255], v[176:179], v[20:23], v[252:255]
    s_waitcnt vmcnt(17) lgkmcnt(14)
    v_mfma_f32_16x16x32_bf16 v[236:239], v[80:83], v[24:27], v[236:239]
    v_mfma_f32_16x16x32_bf16 v[240:243], v[84:87], v[24:27], v[240:243]
    v_mfma_f32_16x16x32_bf16 v[244:247], v[88:91], v[24:27], v[244:247]
    v_mfma_f32_16x16x32_bf16 v[248:251], v[92:95], v[24:27], v[248:251]
    v_mfma_f32_16x16x32_bf16 v[252:255], v[96:99], v[24:27], v[252:255]
    s_waitcnt vmcnt(16)
    v_mfma_f32_16x16x32_bf16 v[236:239], v[100:103], v[28:31], v[236:239]
    s_waitcnt lgkmcnt(13)
    v_mfma_f32_16x16x32_bf16 v[240:243], v[104:107], v[28:31], v[240:243]
    s_waitcnt lgkmcnt(12)
    v_mfma_f32_16x16x32_bf16 v[244:247], v[108:111], v[28:31], v[244:247]
    s_waitcnt lgkmcnt(11)
    v_mfma_f32_16x16x32_bf16 v[248:251], v[112:115], v[28:31], v[248:251]
    s_waitcnt lgkmcnt(10)
    v_mfma_f32_16x16x32_bf16 v[252:255], v[116:119], v[28:31], v[252:255]
    s_waitcnt vmcnt(0)
    s_cmp_lg_u32 s30, 4
    s_cbranch_scc1 K2_NOSPIN2
K2_SPIN2:
    v_cmp_ne_u32 vcc, 1, v12
    s_cbranch_vccz K2_NOSPIN2
    s_cmp_eq_u32 s96, 0
    s_cbranch_scc1 K2_NOSPIN2
    s_sub_u32 s96, s96, 1
    s_sleep 4
    buffer_load_dword v12, v13, s[16:19], 0 offen sc1
    s_waitcnt vmcnt(0)
    s_branch K2_SPIN2
K2_NOSPIN2:
    s_barrier
    s_mov_b32 s7, 0
    buffer_load_dwordx4 v[48:51], v9, s[16:19], s7 offen sc1
    s_mov_b32 s7, 4096
    buffer_load_dwordx4 v[52:55], v9, s[16:19], s7 offen sc1
    s_mov_b32 s7, 8192
    buffer_load_dwordx4 v[56:59], v9, s[16:19], s7 offen sc1
    s_mov_b32 s7, 12288
    buffer_load_dwordx4 v[60:63], v9, s[16:19], s7 offen sc1
    s_mov_b32 s7, 16384
    buffer_load_dwordx4 v[64:67], v9, s[16:19], s7 offen sc1
    ds_read_b128 v[160:163], v5 offset:20480
    ds_read_b128 v[164:167], v5 offset:21504
    ds_read_b128 v[168:171], v5 offset:22528
    ds_read_b128 v[172:175], v5 offset:23552
    ds_read_b128 v[176:179], v5 offset:24576
    ds_read_b128 v[80:83], v5 offset:30720
    ds_read_b128 v[84:87], v5 offset:31744
    ds_read_b128 v[88:91], v5 offset:32768
    ds_read_b128 v[92:95], v5 offset:33792
    ds_read_b128 v[96:99], v5 offset:34816
    ds_read_b128 v[100:103], v5 offset:40960
    ds_read_b128 v[104:107], v5 offset:41984
    ds_read_b128 v[108:111], v5 offset:43008
    ds_read_b128 v[112:115], v5 offset:44032
    ds_read_b128 v[116:119], v5 offset:45056
    s_setprio 3
    s_waitcnt lgkmcnt(14)
    v_mfma_f32_16x16x32_bf16 v[236:239], v[120:123], v[180:183], v[236:239]
    ds_read_b128 v[120:123], v5 offset:51200
    v_mfma_f32_16x16x32_bf16 v[240:243], v[124:127], v[180:183], v[240:243]
    ds_read_b128 v[124:127], v5 offset:52224
    v_mfma_f32_16x16x32_bf16 v[244:247], v[128:131], v[180:183], v[244:247]
    ds_read_b128 v[128:131], v5 offset:53248
    v_mfma_f32_16x16x32_bf16 v[248:251], v[132:135], v[180:183], v[248:251]
    ds_read_b128 v[132:135], v5 offset:54272
    v_mfma_f32_16x16x32_bf16 v[252:255], v[136:139], v[180:183], v[252:255]
    ds_read_b128 v[136:139], v5 offset:55296
    s_mov_b32 s7, 20480
    buffer_load_dwordx4 v[68:71], v9, s[16:19], s7 offen sc1
    s_cmp_eq_u32 s46, 1
    s_cbranch_scc1 K2_SKIP13
    v_mfma_f32_16x16x32_bf16 v[236:239], v[140:143], v[208:211], v[236:239]
    v_mfma_f32_16x16x32_bf16 v[240:243], v[144:147], v[208:211], v[240:243]
    v_mfma_f32_16x16x32_bf16 v[244:247], v[148:151], v[208:211], v[244:247]
    v_mfma_f32_16x16x32_bf16 v[248:251], v[152:155], v[208:211], v[248:251]
    v_mfma_f32_16x16x32_bf16 v[252:255], v[156:159], v[208:211], v[252:255]
K2_SKIP13:
    ds_read_b128 v[140:143], v6 offset:0
    ds_read_b128 v[144:147], v6 offset:1024
    ds_read_b128 v[148:151], v6 offset:2048
    ds_read_b128 v[152:155], v6 offset:3072
    ds_read_b128 v[156:159], v6 offset:4096
    s_mov_b32 s7, 24576
    buffer_load_dwordx4 v[72:75], v9, s[16:19], s7 offen sc1
    s_waitcnt vmcnt(6)
    v_mfma_f32_16x16x32_bf16 v[236:239], v[160:163], v[48:51], v[236:239]
    ds_read_b128 v[160:163], v6 offset:10240
    s_waitcnt lgkmcnt(14)
    v_mfma_f32_16x16x32_bf16 v[240:243], v[164:167], v[48:51], v[240:243]
    ds_read_b128 v[164:167], v6 offset:11264
    v_mfma_f32_16x16x32_bf16 v[244:247], v[168:171], v[48:51], v[244:247]
    ds_read_b128 v[168:171], v6 offset:12288
    v_mfma_f32_16x16x32_bf16 v[248:251], v[172:175], v[48:51], v[248:251]
    ds_read_b128 v[172:175], v6 offset:13312
    v_mfma_f32_16x16x32_bf16 v[252:255], v[176:179], v[48:51], v[252:255]
    ds_read_b128 v[176:179], v6 offset:14336
    s_mov_b32 s7, 28672
    buffer_load_dwordx4 v[76:79], v9, s[16:19], s7 offen sc1
    s_setprio 2
    s_waitcnt vmcnt(6)
    v_mfma_f32_16x16x32_bf16 v[236:239], v[80:83], v[52:55], v[236:239]
    ds_read_b128 v[80:83], v6 offset:20480
    v_mfma_f32_16x16x32_bf16 v[240:243], v[84:87], v[52:55], v[240:243]
    ds_read_b128 v[84:87], v6 offset:21504
    v_mfma_f32_16x16x32_bf16 v[244:247], v[88:91], v[52:55], v[244:247]
    ds_read_b128 v[88:91], v6 offset:22528
    v_mfma_f32_16x16x32_bf16 v[248:251], v[92:95], v[52:55], v[248:251]
    ds_read_b128 v[92:95], v6 offset:23552
    v_mfma_f32_16x16x32_bf16 v[252:255], v[96:99], v[52:55], v[252:255]
    ds_read_b128 v[96:99], v6 offset:24576
    s_mov_b32 s7, 32768
    buffer_load_dwordx2 v[212:213], v10, s[16:19], s7 offen offset:0 sc1
    buffer_load_dwordx2 v[214:215], v10, s[16:19], s7 offen offset:256 sc1
    s_waitcnt vmcnt(7)
    v_mfma_f32_16x16x32_bf16 v[236:239], v[100:103], v[56:59], v[236:239]
    ds_read_b128 v[100:103], v6 offset:30720
    v_mfma_f32_16x16x32_bf16 v[240:243], v[104:107], v[56:59], v[240:243]
    ds_read_b128 v[104:107], v6 offset:31744
    s_waitcnt lgkmcnt(14)
    v_mfma_f32_16x16x32_bf16 v[244:247], v[108:111], v[56:59], v[244:247]
    ds_read_b128 v[108:111], v6 offset:32768
    v_mfma_f32_16x16x32_bf16 v[248:251], v[112:115], v[56:59], v[248:251]
    ds_read_b128 v[112:115], v6 offset:33792
    v_mfma_f32_16x16x32_bf16 v[252:255], v[116:119], v[56:59], v[252:255]
    ds_read_b128 v[116:119], v6 offset:34816
    s_mov_b32 s7, 36864
    buffer_load_dwordx2 v[216:217], v10, s[16:19], s7 offen offset:0 sc1
    buffer_load_dwordx2 v[218:219], v10, s[16:19], s7 offen offset:256 sc1
    s_waitcnt vmcnt(8)
    v_mfma_f32_16x16x32_bf16 v[236:239], v[120:123], v[60:63], v[236:239]
    ds_read_b128 v[120:123], v4 offset:0
    v_mfma_f32_16x16x32_bf16 v[240:243], v[124:127], v[60:63], v[240:243]
    ds_read_b128 v[124:127], v4 offset:1024
    v_mfma_f32_16x16x32_bf16 v[244:247], v[128:131], v[60:63], v[244:247]
    ds_read_b128 v[128:131], v4 offset:2048
    v_mfma_f32_16x16x32_bf16 v[248:251], v[132:135], v[60:63], v[248:251]
    ds_read_b128 v[132:135], v4 offset:3072
    v_mfma_f32_16x16x32_bf16 v[252:255], v[136:139], v[60:63], v[252:255]
    ds_read_b128 v[136:139], v4 offset:4096
    s_setprio 1
    s_waitcnt vmcnt(7)
    v_mfma_f32_16x16x32_bf16 v[236:239], v[140:143], v[64:67], v[236:239]
    ds_read_b128 v[140:143], v4 offset:10240
    v_mfma_f32_16x16x32_bf16 v[240:243], v[144:147], v[64:67], v[240:243]
    ds_read_b128 v[144:147], v4 offset:11264
    v_mfma_f32_16x16x32_bf16 v[244:247], v[148:151], v[64:67], v[244:247]
    ds_read_b128 v[148:151], v4 offset:12288
    s_waitcnt lgkmcnt(14)
    v_mfma_f32_16x16x32_bf16 v[248:251], v[152:155], v[64:67], v[248:251]
    ds_read_b128 v[152:155], v4 offset:13312
    v_mfma_f32_16x16x32_bf16 v[252:255], v[156:159], v[64:67], v[252:255]
    ds_read_b128 v[156:159], v4 offset:14336
    s_waitcnt vmcnt(6)
    v_mfma_f32_16x16x32_bf16 v[236:239], v[160:163], v[68:71], v[236:239]
    v_mfma_f32_16x16x32_bf16 v[240:243], v[164:167], v[68:71], v[240:243]
    v_mfma_f32_16x16x32_bf16 v[244:247], v[168:171], v[68:71], v[244:247]
    v_mfma_f32_16x16x32_bf16 v[248:251], v[172:175], v[68:71], v[248:251]
    v_mfma_f32_16x16x32_bf16 v[252:255], v[176:179], v[68:71], v[252:255]
    s_waitcnt vmcnt(5)
    v_mfma_f32_16x16x32_bf16 v[236:239], v[80:83], v[72:75], v[236:239]
    v_mfma_f32_16x16x32_bf16 v[240:243], v[84:87], v[72:75], v[240:243]
    v_mfma_f32_16x16x32_bf16 v[244:247], v[88:91], v[72:75], v[244:247]
    v_mfma_f32_16x16x32_bf16 v[248:251], v[92:95], v[72:75], v[248:251]
    s_waitcnt lgkmcnt(14)
    v_mfma_f32_16x16x32_bf16 v[252:255], v[96:99], v[72:75], v[252:255]
    s_setprio 0
    s_waitcnt vmcnt(4)
    v_mfma_f32_16x16x32_bf16 v[236:239], v[100:103], v[76:79], v[236:239]
    s_waitcnt lgkmcnt(13)
    v_mfma_f32_16x16x32_bf16 v[240:243], v[104:107], v[76:79], v[240:243]
    s_waitcnt lgkmcnt(12)
    v_mfma_f32_16x16x32_bf16 v[244:247], v[108:111], v[76:79], v[244:247]
    s_waitcnt lgkmcnt(11)
    v_mfma_f32_16x16x32_bf16 v[248:251], v[112:115], v[76:79], v[248:251]
    s_waitcnt lgkmcnt(10)
    v_mfma_f32_16x16x32_bf16 v[252:255], v[116:119], v[76:79], v[252:255]
    s_waitcnt vmcnt(2) lgkmcnt(9)
    v_mfma_f32_16x16x32_bf16 v[236:239], v[120:123], v[212:215], v[236:239]
    s_waitcnt lgkmcnt(8)
    v_mfma_f32_16x16x32_bf16 v[240:243], v[124:127], v[212:215], v[240:243]
    s_waitcnt lgkmcnt(7)
    v_mfma_f32_16x16x32_bf16 v[244:247], v[128:131], v[212:215], v[244:247]
    s_waitcnt lgkmcnt(6)
    v_mfma_f32_16x16x32_bf16 v[248:251], v[132:135], v[212:215], v[248:251]
    s_waitcnt lgkmcnt(5)
    v_mfma_f32_16x16x32_bf16 v[252:255], v[136:139], v[212:215], v[252:255]
    s_waitcnt vmcnt(0) lgkmcnt(4)
    v_mfma_f32_16x16x32_bf16 v[236:239], v[140:143], v[216:219], v[236:239]
    s_waitcnt lgkmcnt(3)
    v_mfma_f32_16x16x32_bf16 v[240:243], v[144:147], v[216:219], v[240:243]
    s_waitcnt lgkmcnt(2)
    v_mfma_f32_16x16x32_bf16 v[244:247], v[148:151], v[216:219], v[244:247]
    s_waitcnt lgkmcnt(1)
    v_mfma_f32_16x16x32_bf16 v[248:251], v[152:155], v[216:219], v[248:251]
    s_waitcnt lgkmcnt(0)
    v_mfma_f32_16x16x32_bf16 v[252:255], v[156:159], v[216:219], v[252:255]
    s_cmp_eq_u32 s46, 1
    s_cbranch_scc1 K2_FEND
    s_barrier
    ds_read_b128 v[16:19], v8 offset:0
    ds_read_b128 v[20:23], v8 offset:1024
    ds_read_b128 v[24:27], v8 offset:2048
    ds_read_b128 v[28:31], v8 offset:3072
    ds_read_b128 v[32:35], v8 offset:4096
    s_waitcnt lgkmcnt(4)
    v_pk_add_f32 v[236:237], v[236:237], v[16:17]
    v_pk_add_f32 v[238:239], v[238:239], v[18:19]
    v_cvt_pk_bf16_f32 v236, v236, v237
    v_cvt_pk_bf16_f32 v237, v238, v239
    buffer_store_dwordx2 v[236:237], v7, s[20:23], 0 offen offset:0
    s_waitcnt lgkmcnt(3)
    v_pk_add_f32 v[240:241], v[240:241], v[20:21]
    v_pk_add_f32 v[242:243], v[242:243], v[22:23]
    v_cvt_pk_bf16_f32 v240, v240, v241
    v_cvt_pk_bf16_f32 v241, v242, v243
    buffer_store_dwordx2 v[240:241], v7, s[20:23], 0 offen offset:32
    s_waitcnt lgkmcnt(2)
    v_pk_add_f32 v[244:245], v[244:245], v[24:25]
    v_pk_add_f32 v[246:247], v[246:247], v[26:27]
    v_cvt_pk_bf16_f32 v244, v244, v245
    v_cvt_pk_bf16_f32 v245, v246, v247
    buffer_store_dwordx2 v[244:245], v7, s[20:23], 0 offen offset:64
    s_waitcnt lgkmcnt(1)
    v_pk_add_f32 v[248:249], v[248:249], v[28:29]
    v_pk_add_f32 v[250:251], v[250:251], v[30:31]
    v_cvt_pk_bf16_f32 v248, v248, v249
    v_cvt_pk_bf16_f32 v249, v250, v251
    buffer_store_dwordx2 v[248:249], v7, s[20:23], 0 offen offset:96
    s_waitcnt lgkmcnt(0)
    v_pk_add_f32 v[252:253], v[252:253], v[32:33]
    v_pk_add_f32 v[254:255], v[254:255], v[34:35]
    v_cvt_pk_bf16_f32 v252, v252, v253
    v_cvt_pk_bf16_f32 v253, v254, v255
    buffer_store_dwordx2 v[252:253], v7, s[20:23], 0 offen offset:128
    s_branch K2_FDONE
K2_FEND:
    s_nop 5
    ds_write_b128 v8, v[236:239] offset:0
    ds_write_b128 v8, v[240:243] offset:1024
    ds_write_b128 v8, v[244:247] offset:2048
    ds_write_b128 v8, v[248:251] offset:3072
    ds_write_b128 v8, v[252:255] offset:4096
    s_waitcnt lgkmcnt(0)
    s_barrier
K2_FDONE:
    s_endpgm
K2_FALLBACK:
    v_mov_b32 v244, 0
    v_cndmask_b32 v242, v242, v244, s[44:45]
    v_cndmask_b32 v243, v243, v244, s[44:45]
    v_lshlrev_b32 v5, 3, v2
    v_mul_u32_u24 v6, 20, v3
    v_add_u32 v6, v6, v2
    v_lshlrev_b32 v6, 4, v6
    v_mov_b32 v244, 0xff800000
    s_mov_b32 s54, 2621440
K2_FB1:
    buffer_load_dwordx4 v[208:211], v11, s[16:19], s54 offen sc1
    s_mov_b64 exec, s[34:35]
    buffer_load_dwordx2 v[212:213], v5, s[16:19], s54 offen offset:1024 sc1
    s_mov_b64 exec, s[32:33]
    buffer_load_dwordx4 v[216:219], v6, s[16:19], s54 offen offset:1280 sc1
    buffer_load_dwordx4 v[220:223], v6, s[16:19], s54 offen offset:1920 sc1
    s_mov_b64 exec, -1
    s_waitcnt vmcnt(0)
    v_mfma_f32_32x32x16_bf16 v[16:31], v[208:211], v[238:241], 0
    v_mfma_f32_32x32x8_bf16 v[16:31], v[212:213], v[242:243], v[16:31]
    s_nop 15
    v_max3_f32 v244, v244, v16, v17
    v_max3_f32 v244, v244, v18, v19
    v_max3_f32 v244, v244, v20, v21
    v_max3_f32 v244, v244, v22, v23
    v_max3_f32 v244, v244, v24, v25
    v_max3_f32 v244, v244, v26, v27
    v_max3_f32 v244, v244, v28, v29
    v_max3_f32 v244, v244, v30, v31
    s_add_u32 s54, s54, 2560
    s_cmp_lt_u32 s54, 2785280
    s_cbranch_scc1 K2_FB1
    v_mov_b32 v246, v244
    s_nop 1
    v_permlane32_swap_b32 v246, v244
    s_nop 1
    v_max_f32 v244, v244, v246
    v_sub_f32 v244, 0, v244
    v_and_b32 v246, 0xffff0000, v244
    v_sub_f32 v247, v244, v246
    v_and_b32 v248, 0xffff0000, v247
    v_sub_f32 v249, v247, v248
    v_lshrrev_b32 v246, 16, v246
    v_or_b32 v246, v246, v248
    v_lshrrev_b32 v249, 16, v249
    v_cndmask_b32 v242, v242, v246, s[44:45]
    v_cndmask_b32 v243, v243, v249, s[44:45]
    v_mov_b32 v48, 0
    v_mov_b32 v49, 0
    v_mov_b32 v50, 0
    v_mov_b32 v51, 0
    v_mov_b32 v52, 0
    v_mov_b32 v53, 0
    v_mov_b32 v54, 0
    v_mov_b32 v55, 0
    v_mov_b32 v56, 0
    v_mov_b32 v57, 0
    v_mov_b32 v58, 0
    v_mov_b32 v59, 0
    v_mov_b32 v60, 0
    v_mov_b32 v61, 0
    v_mov_b32 v62, 0
    v_mov_b32 v63, 0
    s_mov_b32 s54, 2621440
K2_FB2:
    buffer_load_dwordx4 v[208:211], v11, s[16:19], s54 offen sc1
    s_mov_b64 exec, s[34:35]
    buffer_load_dwordx2 v[212:213], v5, s[16:19], s54 offen offset:1024 sc1
    s_mov_b64 exec, s[32:33]
    buffer_load_dwordx4 v[216:219], v6, s[16:19], s54 offen offset:1280 sc1
    buffer_load_dwordx4 v[220:223], v6, s[16:19], s54 offen offset:1920 sc1
    s_mov_b64 exec, -1
    s_waitcnt vmcnt(0)
    v_mfma_f32_32x32x16_bf16 v[16:31], v[208:211], v[238:241], 0
    v_mfma_f32_32x32x8_bf16 v[16:31], v[212:213], v[242:243], v[16:31]
    s_nop 15
    v_exp_f32 v16, v16
    v_exp_f32 v17, v17
    v_exp_f32 v18, v18
    v_exp_f32 v19, v19
    v_exp_f32 v20, v20
    v_exp_f32 v21, v21
    v_exp_f32 v22, v22
    v_exp_f32 v23, v23
    v_exp_f32 v24, v24
    v_exp_f32 v25, v25
    v_exp_f32 v26, v26
    v_exp_f32 v27, v27
    v_exp_f32 v28, v28
    v_exp_f32 v29, v29
    v_exp_f32 v30, v30
    v_exp_f32 v31, v31
    s_nop 0
    v_cvt_pk_bf16_f32 v16, v16, v17
    v_cvt_pk_bf16_f32 v17, v18, v19
    v_cvt_pk_bf16_f32 v18, v20, v21
    v_cvt_pk_bf16_f32 v19, v22, v23
    v_cvt_pk_bf16_f32 v20, v24, v25
    v_cvt_pk_bf16_f32 v21, v26, v27
    v_cvt_pk_bf16_f32 v22, v28, v29
    v_cvt_pk_bf16_f32 v23, v30, v31
    s_nop 1
    v_mfma_f32_32x32x16_bf16 v[48:63], v[216:219], v[16:19], v[48:63]
    v_mfma_f32_32x32x16_bf16 v[48:63], v[220:223], v[20:23], v[48:63]
    s_add_u32 s54, s54, 2560
    s_cmp_lt_u32 s54, 2785280
    s_cbranch_scc1 K2_FB2
    s_nop 15
    s_branch K2_OSTORE
TEXT_END:
.section .rodata,"a"
.p2align 6
.amdhsa_kernel gated_mix__grouped_kv_mqa__mixer_gmlp__prompt_kernel
  .amdhsa_next_free_vgpr 256
  .amdhsa_next_free_sgpr 102
  .amdhsa_accum_offset 256
  .amdhsa_group_segment_fixed_size 0
  .amdhsa_kernarg_size 112
  .amdhsa_user_sgpr_count 2
  .amdhsa_user_sgpr_kernarg_segment_ptr 1
  .amdhsa_system_sgpr_workgroup_id_x 1
.end_amdhsa_kernel
```
